```python
import torch

def _softmax(x, axis=-1):
    return torch.softmax(x, dim=axis)
def _gelu(x):
    return torch.nn.functional.gelu(x, approximate="tanh")
def _silu(x):
    return torch.nn.functional.silu(x)
def _sigmoid(x):
    return torch.sigmoid(x)
def _layernorm(x, axis=-1, eps=1e-5):
    m = x.mean(dim=axis, keepdim=True)
    v = x.var(dim=axis, keepdim=True, unbiased=False)
    return (x - m) / torch.sqrt(v + eps)
def _scatter_add(tgt, idx, src, axis=0):
    return tgt.clone().index_add_(axis, idx, src)
def _segment_sum(src, seg, n):
    out = torch.zeros((n,) + src.shape[1:], dtype=src.dtype)
    return out.index_add_(0, seg, src)
def _pad(x, pw):
    flat = tuple(v for pair in reversed(pw) for v in pair)
    return torch.nn.functional.pad(x, flat)

kernel_name = 'parallel_sum__ssm_conv_s5__glu_gated_glu__prompt'

def setup_inputs():

    _w = (lambda a: (lambda t: t.to(torch.bfloat16) if t.is_floating_point() else t)(torch.as_tensor(a)))
    def _A_setup():
        B, S, D = 1, 2048, 1024
        P = D
        Lambda_re = -0.5 * (lambda _x: torch.exp(torch.as_tensor(_x)))((lambda *s: torch.randn(*s, dtype=torch.bfloat16) * 0.8)(P))
        Lambda_im = (lambda *s: torch.randn(*s, dtype=torch.bfloat16) * 0.8)(P) * 1.0
        B_re = (lambda *s: torch.randn(*s, dtype=torch.bfloat16) * 0.8)(P, D) * (D ** -0.5)
        B_im = (lambda *s: torch.randn(*s, dtype=torch.bfloat16) * 0.8)(P, D) * (D ** -0.5)
        C_re = (lambda *s: torch.randn(*s, dtype=torch.bfloat16) * 0.8)(D, P) * (P ** -0.5)
        C_im = (lambda *s: torch.randn(*s, dtype=torch.bfloat16) * 0.8)(D, P) * (P ** -0.5)
        log_dt = (lambda *s: torch.randn(*s, dtype=torch.bfloat16) * 0.8)(P) * 0.3 - 2.0
        Dskip = (lambda *s: torch.randn(*s, dtype=torch.bfloat16) * 0.8)(D)
        return {
            "x": _w((lambda *s: torch.randn(*s, dtype=torch.bfloat16) * 0.05)(B, S, D)),
            "Lambda_re": _w(Lambda_re),
            "Lambda_im": _w(Lambda_im),
            "B_re": _w(B_re),
            "B_im": _w(B_im),
            "C_re": _w(C_re),
            "C_im": _w(C_im),
            "log_dt": _w(log_dt),
            "Dskip": _w(Dskip),
        }
    _A_in = _A_setup()

    def _B_setup():
        B, S, D, F = 1, 2048, 1024, 3584
        return {
            "x": _w((lambda *s: torch.randn(*s, dtype=torch.bfloat16) * 0.05)(B, S, D)),
            "w_gate": _w((lambda *s: torch.randn(*s, dtype=torch.bfloat16) * 0.05)(D, F)),
            "w_up": _w((lambda *s: torch.randn(*s, dtype=torch.bfloat16) * 0.05)(D, F)),
            "w_down": _w((lambda *s: torch.randn(*s, dtype=torch.bfloat16) * 0.05)(F, D)),
        }
    _B_in = _B_setup()

    return {
        "A_x": _A_in["x"],
        "A_Lambda_re": _A_in["Lambda_re"],
        "A_Lambda_im": _A_in["Lambda_im"],
        "A_B_re": _A_in["B_re"],
        "A_B_im": _A_in["B_im"],
        "A_C_re": _A_in["C_re"],
        "A_C_im": _A_in["C_im"],
        "A_log_dt": _A_in["log_dt"],
        "A_Dskip": _A_in["Dskip"],
        "B_x": _B_in["x"],
        "B_w_gate": _B_in["w_gate"],
        "B_w_up": _B_in["w_up"],
        "B_w_down": _B_in["w_down"],
    }

def reference(A_x, A_Lambda_re, A_Lambda_im, A_B_re, A_B_im, A_C_re, A_C_im, A_log_dt, A_Dskip, B_x, B_w_gate, B_w_up, B_w_down):
    def _A_ref(x, Lambda_re, Lambda_im, B_re, B_im, C_re, C_im, log_dt, Dskip):
        Bsz, L, H = x.shape
        Lam = Lambda_re + 1j * Lambda_im
        Bmat = B_re + 1j * B_im
        Cmat = C_re + 1j * C_im
        dt = torch.exp(log_dt)
        Lam_bar = torch.exp(dt * Lam)
        B_bar = ((Lam_bar - 1.0) / Lam)[:, None] * Bmat
        Bu = torch.einsum("bld,pd->blp", x + 0j, B_bar)
        h = torch.zeros_like(Bu[:, 0, :])
        hs = []
        for t in range(L):
            h = Lam_bar[None, :] * h + Bu[:, t, :]
            hs.append(h)
        hseq = torch.stack(hs, 1)
        y = 2.0 * torch.einsum("blp,dp->bld", hseq, Cmat).real + x * Dskip[None, None, :]
        return y

    def _B_ref(x, w_gate, w_up, w_down):
        g = torch.einsum("bsd,df->bsf", x, w_gate)
        u = torch.einsum("bsd,df->bsf", x, w_up)
        h = _sigmoid(g) * u
        return torch.einsum("bsf,fd->bsd", h, w_down)

    x = A_x
    xn = _layernorm(x, axis=-1)
    return x + _A_ref(xn, A_Lambda_re, A_Lambda_im, A_B_re, A_B_im, A_C_re, A_C_im, A_log_dt, A_Dskip) + _B_ref(xn, B_w_gate, B_w_up, B_w_down)
```

```asm
; @launch kernel=parallel_sum__ssm_conv_s5__glu_gated_glu__prompt_kernel grid=(256,1,1) block=(256,1,1) lds=147456
.amdgcn_target "amdgcn-amd-amdhsa--gfx950"
.text
.globl parallel_sum__ssm_conv_s5__glu_gated_glu__prompt_kernel
.p2align 8
.type parallel_sum__ssm_conv_s5__glu_gated_glu__prompt_kernel,@function
parallel_sum__ssm_conv_s5__glu_gated_glu__prompt_kernel:
    s_load_dwordx2 s[60:61], s[0:1], 112
    s_load_dwordx4 s[64:67], s[0:1], 40
    v_lshrrev_b32 v22, 6, v0
    v_lshlrev_b32 v22, 12, v22
    v_bfe_u32 v23, v0, 2, 1
    v_lshl_add_u32 v22, v23, 11, v22
    v_bfe_u32 v23, v0, 3, 3
    v_lshl_add_u32 v22, v23, 6, v22
    v_and_b32_e64 v23, 3, v0
    v_lshl_add_u32 v22, v23, 4, v22
    s_lshl_b32 s34, s2, 14
    v_add_u32 v118, s34, v22
    s_cmp_ge_u32 s2, 256
    s_cbranch_scc1 L_k2_end
    s_nop 0
    s_load_dwordx4 s[40:43], s[0:1], 24
    s_load_dwordx4 s[44:47], s[0:1], 80
    s_load_dwordx2 s[48:49], s[0:1], 120
    s_load_dwordx4 s[52:55], s[0:1], 8
    s_load_dwordx2 s[56:57], s[0:1], 56
    s_load_dwordx2 s[90:91], s[0:1], 96
    s_load_dwordx2 s[50:51], s[0:1], 0
    v_lshrrev_b32 v20, 6, v0
    v_and_b32_e64 v21, 63, v0
    s_and_b32 s34, s2, 7
    s_lshr_b32 s35, s2, 3
    v_readfirstlane_b32 s31, v20
    s_and_b32 s32, s35, 7
    s_lshr_b32 s35, s35, 3
    s_lshl_b32 s34, s34, 2
    s_add_u32 s33, s34, s35
    v_bfe_u32 v22, v21, 3, 2
    v_lshlrev_b32 v22, 4, v22
    v_lshrrev_b32 v23, 5, v21
    v_lshl_add_u32 v22, v23, 2, v22
    v_bfe_u32 v23, v21, 1, 2
    v_add_u32 v22, v22, v23
    v_lshlrev_b32 v22, 5, v22
    v_and_b32_e64 v23, 1, v21
    v_lshl_add_u32 v22, v23, 4, v22
    s_lshl_b32 s34, s32, 13
    s_lshl_b32 s35, s31, 11
    s_add_u32 s34, s34, s35
    s_nop 0
    s_add_u32 s34, s34, 1048576
    v_add_u32_e64 v1, s34, v22
    v_add_u32 v2, 4294966528, v1
    v_add_u32 v3, 63488, v1
    v_add_u32 v4, 62720, v1
    v_bfe_u32 v22, v21, 4, 2
    v_bfe_u32 v23, v21, 2, 2
    v_lshl_add_u32 v23, v22, 4, v23
    v_lshlrev_b32 v23, 11, v23
    v_and_b32 v24, 3, v21
    v_xor_b32_e64 v24, v24, v22
    v_lshl_add_u32 v23, v24, 4, v23
    s_lshl_b32 s34, s32, 19
    s_lshl_b32 s35, s31, 17
    s_add_u32 s34, s34, s35
    v_add_u32 v1, s34, v23
    v_add_u32 v2, 7168, v1
    v_add_u32 v3, 14336, v1
    v_add_u32 v4, 21504, v1
    s_mov_b32 s96, 0x3f803f80
    v_lshrrev_b32 v23, 4, v21
    v_and_b32 v24, 7, v21
    v_xor_b32_e64 v24, v24, v23
    v_bfe_u32 v23, v21, 3, 2
    v_lshrrev_b32_e64 v22, 5, v21
    v_lshl_add_u32 v23, v22, 4, v23
    v_lshlrev_b32 v23, 11, v23
    v_add_u32 v23, s34, v23
    v_xor_b32_e64 v22, 4, v24
    v_lshl_add_u32 v1, v24, 4, v23
    v_lshl_add_u32 v22, v22, 4, v23
    v_add_u32 v2, 64512, v22
    v_add_u32 v3, 6144, v1
    v_add_u32 v4, 70656, v22
    v_lshrrev_b32 v22, 4, v21
    s_and_b32 s34, s31, 1
    s_lshl_b32 s34, s34, 2
    v_add_u32 v23, s34, v22
    v_bfe_u32 v24, v21, 1, 3
    v_xor_b32 v24, v24, v23
    s_lshl_b32 s34, s31, 3
    v_add_u32 v22, s34, v22
    s_movk_i32 s35, 7168
    v_mul_lo_u32 v22, v22, s35
    s_and_b32 s34, s33, 1
    v_add_u32 v27, s34, v24
    v_cmp_eq_u32 vcc, 7, v27
    s_nop 1
    v_cndmask_b32_e64 v27, v27, 0, vcc
    v_lshl_add_u32 v22, v27, 5, v22
    v_and_b32_e64 v25, 1, v21
    v_lshl_add_u32 v22, v25, 4, v22
    s_mul_i32 s34, s33, 224
    v_add_u32 v22, s34, v22
    v_cmp_eq_u32 vcc, 7, v24
    v_mov_b32 v25, 0x40000000
    s_nop 1
    v_cndmask_b32_e64 v5, v22, v25, vcc
    v_add_u32 v6, 27648, v5
    v_lshrrev_b32 v22, 2, v21
    v_lshrrev_b32 v23, 5, v21
    v_mul_u32_u24 v23, 3, v23
    v_and_b32 v24, 3, v21
    v_xor_b32 v23, v23, v24
    s_lshl_b32 s34, s33, 5
    s_and_b32 s35, s31, 1
    s_lshl_b32 s35, s35, 4
    s_add_u32 s34, s34, s35
    v_add_u32 v22, s34, v22
    v_lshlrev_b32_e64 v22, 11, v22
    v_lshl_add_u32 v7, v23, 4, v22
    v_and_b32 v22, 15, v21
    v_lshrrev_b32 v23, 4, v21
    v_lshrrev_b32 v24, 1, v23
    v_lshlrev_b32 v24, 11, v24
    v_lshl_add_u32 v24, v22, 5, v24
    v_and_b32_e64 v25, 1, v23
    v_lshl_add_u32 v24, v25, 4, v24
    s_lshl_b32 s34, s31, 12
    s_nop 0
    s_add_u32 s27, s34, 65536
    v_add_u32 v8, s27, v24
    v_lshrrev_b32 v24, 2, v22
    v_xor_b32 v24, v24, v23
    v_lshlrev_b32 v24, 4, v24
    v_lshl_add_u32 v24, v22, 6, v24
    v_add_u32 v8, s27, v24
    s_lshl_b32 s34, s31, 13
    s_add_u32 s27, s34, 65536
    v_lshrrev_b32 v24, 1, v22
    v_xor_b32 v24, v24, v23
    v_lshlrev_b32_e64 v24, 4, v24
    v_lshl_add_u32 v24, v22, 7, v24
    v_add_u32 v8, s27, v24
    v_xor_b32 v20, 64, v8
    v_lshrrev_b32 v24, 3, v22
    v_mul_u32_u24 v24, 3, v24
    v_xor_b32 v24, v24, v23
    v_lshlrev_b32 v24, 4, v24
    v_lshl_add_u32 v24, v22, 6, v24
    v_add_u32 v9, 131072, v24
    v_lshrrev_b32_e64 v24, 2, v22
    v_lshl_add_u32 v26, v23, 3, v24
    v_lshlrev_b32 v26, 8, v26
    v_and_b32 v27, 3, v21
    v_lshl_add_u32 v26, v27, 3, v26
    v_lshl_add_u32 v24, v25, 2, v24
    v_xor_b32_e64 v27, 0, v24
    v_lshl_add_u32 v10, v27, 5, v26
    v_xor_b32_e64 v27, 1, v24
    v_lshl_add_u32 v11, v27, 5, v26
    v_xor_b32_e64 v27, 2, v24
    v_lshl_add_u32 v12, v27, 5, v26
    v_xor_b32_e64 v27, 3, v24
    v_lshl_add_u32 v13, v27, 5, v26
    v_xor_b32_e64 v27, 4, v24
    v_lshl_add_u32 v14, v27, 5, v26
    v_xor_b32_e64 v27, 5, v24
    v_lshl_add_u32 v15, v27, 5, v26
    v_xor_b32_e64 v27, 6, v24
    v_lshl_add_u32 v16, v27, 5, v26
    s_lshl_b32 s28, s31, 11
    s_lshl_b32 s34, s31, 10
    s_add_u32 s29, s34, 131072
    s_sub_u32 s27, s27, 256
    s_sub_u32 s28, s28, 256
    s_sub_u32 s29, s29, 256
    s_mov_b32 s24, 0
    s_mov_b32 s25, 0
    s_mov_b32 s26, 0
    s_waitcnt lgkmcnt(0)
    s_mov_b32 s8, s48
    s_nop 0
    s_and_b32 s9, s49, 0xffff
    s_mov_b32 s10, 0x10000000
    s_mov_b32 s11, 0x20000
    s_mov_b32 s12, s44
    s_nop 0
    s_and_b32 s13, s45, 0xffff
    s_mov_b32 s14, 7340032
    s_mov_b32 s15, 0x20000
    s_mov_b32 s16, s46
    s_nop 0
    s_and_b32 s17, s47, 0xffff
    s_mov_b32 s18, 7340032
    s_mov_b32 s19, 0x20000
    s_mov_b32 s92, s50
    s_nop 0
    s_and_b32 s93, s51, 0xffff
    s_mov_b32 s94, 4194304
    s_mov_b32 s95, 0x20000
    s_cmp_lt_u32 s31, 2
    s_cselect_b32 s20, s40, s42
    s_cselect_b32 s34, s41, s43
    s_nop 0
    s_and_b32 s21, s34, 0xffff
    s_mov_b32 s22, 2097152
    s_mov_b32 s23, 0x20000
    v_and_b32 v22, 15, v0
    s_lshl_b32 s34, s33, 5
    v_add_u32 v22, s34, v22
    v_lshlrev_b32 v22, 1, v22
    global_load_ushort v32, v22, s[52:53] offset:0
    global_load_ushort v33, v22, s[54:55] offset:0
    global_load_ushort v34, v22, s[56:57] offset:0
    global_load_ushort v35, v22, s[52:53] offset:32
    global_load_ushort v36, v22, s[54:55] offset:32
    global_load_ushort v37, v22, s[56:57] offset:32
    s_getpc_b64 s[36:37]
    L_k1_pca:
    s_nop 0
    s_and_b32 s37, s37, 0xffff
    s_mov_b32 s38, L_k1_end-L_k1_pca
    s_mov_b32 s39, 0x20000
    s_and_b32 s34, s2, 56
    s_cmp_eq_u32 s34, 0
    s_cselect_b32 s34, 0, 0x40000000
    v_lshlrev_b32 v61, 7, v0
    buffer_load_dword v60, v61, s[36:39], s34 offen
    s_add_u32 m0, s27, 256
    s_nop 0
    s_nop 0
    buffer_load_dwordx4 v1, s[92:95], s24 offen offset:0 lds
    buffer_load_dwordx4 v2, s[92:95], s24 offen offset:1024 lds
    buffer_load_dwordx4 v3, s[92:95], s24 offen offset:2048 lds
    buffer_load_dwordx4 v4, s[92:95], s24 offen offset:3072 lds
    s_add_u32 s24, s24, 16384
    s_add_u32 m0, s27, 4352
    s_nop 0
    s_nop 0
    buffer_load_dwordx4 v1, s[92:95], s24 offen offset:0 lds
    buffer_load_dwordx4 v2, s[92:95], s24 offen offset:1024 lds
    buffer_load_dwordx4 v3, s[92:95], s24 offen offset:2048 lds
    buffer_load_dwordx4 v4, s[92:95], s24 offen offset:3072 lds
    s_add_u32 s24, s24, 4294951040
    s_add_u32 m0, s28, 256
    s_nop 0
    s_nop 0
    buffer_load_dwordx4 v5, s[12:15], s25 offen offset:0 lds
    buffer_load_dwordx4 v6, s[12:15], s25 offen offset:1024 lds
    s_add_u32 m0, s28, 8448
    s_nop 0
    s_nop 0
    buffer_load_dwordx4 v5, s[16:19], s25 offen offset:0 lds
    buffer_load_dwordx4 v6, s[16:19], s25 offen offset:1024 lds
    s_add_u32 m0, s29, 256
    s_nop 0
    s_nop 0
    buffer_load_dwordx4 v7, s[20:23], s26 offen lds
    s_add_u32 s25, s25, 229376
    s_sub_u32 s26, s26, -64
    global_load_dwordx4 v[120:123], v118, s[50:51] offset:0
    global_load_dwordx4 v[124:127], v118, s[50:51] offset:512
    global_load_dwordx4 v[128:131], v118, s[50:51] offset:1024
    global_load_dwordx4 v[132:135], v118, s[50:51] offset:1536
    s_and_b32 s61, s61, 0xffff
    s_mov_b32 s62, 256
    s_mov_b32 s63, 0x20000
    s_mov_b32 s86, 0x01010101
    s_lshl_b32 s34, s32, 2
    s_add_u32 s34, s34, s31
    s_min_u32 s35, s34, 17
    s_lshl_b32 s59, s35, 2
    s_lshl_b32 s96, s31, 2
    s_lshl_b32 s35, s33, 11
    s_lshl_b32 s36, s34, 6
    s_add_u32 s35, s35, s36
    s_add_u32 s35, s35, 42074112
    s_cmp_lt_u32 s34, 18
    s_nop 0
    s_cselect_b32 s100, s35, 536870912
    s_lshl_b32 s35, s32, 10
    s_nop 0
    s_add_u32 s101, s35, 42205184
    s_lshl_b32 s34, s33, 3
    s_add_u32 s34, s34, s32
    s_lshl_b32 s35, s34, 8
    s_nop 0
    s_add_u32 s35, s35, 41943040
    v_and_b32 v22, 15, v0
    v_lshlrev_b32 v23, 4, v22
    v_mov_b32_e64 v28, 1073741824
    v_cmp_lt_u32 vcc, 239, v0
    v_mov_b32 v24, -1
    v_mov_b32 v25, -1
    v_mov_b32 v26, -1
    v_mov_b32 v27, -1
    v_cndmask_b32 v23, v28, v23, vcc
    v_cmp_eq_u32 vcc, 0, v22
    v_bfe_u32 v22, v0, 4, 2
    v_lshlrev_b32 v22, 4, v22
    v_cndmask_b32 v119, v28, v22, vcc
    buffer_store_dwordx4 v[24:27], v23, s[8:11], s35 offen sc1
    buffer_store_dwordx4 v[24:27], v119, s[8:11], s100 offen sc1
    s_lshl_b32 s34, s32, 12
    s_lshr_b32 s35, s33, 3
    s_lshl_b32 s35, s35, 8
    s_add_u32 s34, s34, s35
    s_and_b32 s35, s33, 7
    s_lshl_b32 s35, s35, 2
    s_add_u32 s34, s34, s35
    s_nop 0
    s_add_u32 s4, s34, 42467328
    v_min_u32 v28, 1, v0
    v_lshlrev_b32 v28, 30, v28
    v_mov_b32_e64 v22, 0
    buffer_store_dword v22, v28, s[8:11], s4 offen sc1
    v_accvgpr_write_b32 a0, 0
    v_accvgpr_write_b32 a1, 0
    v_accvgpr_write_b32 a2, 0
    v_accvgpr_write_b32 a3, 0
    v_accvgpr_write_b32 a4, 0
    v_accvgpr_write_b32 a5, 0
    v_accvgpr_write_b32 a6, 0
    v_accvgpr_write_b32 a7, 0
    v_accvgpr_write_b32 a8, 0
    v_accvgpr_write_b32 a9, 0
    v_accvgpr_write_b32 a10, 0
    v_accvgpr_write_b32 a11, 0
    v_accvgpr_write_b32 a12, 0
    v_accvgpr_write_b32 a13, 0
    v_accvgpr_write_b32 a14, 0
    v_accvgpr_write_b32 a15, 0
    s_add_u32 m0, s28, 16640
    s_nop 0
    s_nop 0
    buffer_load_dwordx4 v5, s[12:15], s25 offen offset:0 lds
    v_accvgpr_write_b32 a16, 0
    v_accvgpr_write_b32 a17, 0
    v_accvgpr_write_b32 a18, 0
    v_accvgpr_write_b32 a19, 0
    v_accvgpr_write_b32 a20, 0
    v_accvgpr_write_b32 a21, 0
    v_accvgpr_write_b32 a22, 0
    v_accvgpr_write_b32 a23, 0
    v_accvgpr_write_b32 a24, 0
    v_accvgpr_write_b32 a25, 0
    v_accvgpr_write_b32 a26, 0
    v_accvgpr_write_b32 a27, 0
    v_accvgpr_write_b32 a28, 0
    v_accvgpr_write_b32 a29, 0
    v_accvgpr_write_b32 a30, 0
    v_accvgpr_write_b32 a31, 0
    buffer_load_dwordx4 v6, s[12:15], s25 offen offset:1024 lds
    v_accvgpr_write_b32 a32, 0
    v_accvgpr_write_b32 a33, 0
    v_accvgpr_write_b32 a34, 0
    v_accvgpr_write_b32 a35, 0
    v_accvgpr_write_b32 a36, 0
    v_accvgpr_write_b32 a37, 0
    v_accvgpr_write_b32 a38, 0
    v_accvgpr_write_b32 a39, 0
    v_accvgpr_write_b32 a40, 0
    v_accvgpr_write_b32 a41, 0
    v_accvgpr_write_b32 a42, 0
    v_accvgpr_write_b32 a43, 0
    v_accvgpr_write_b32 a44, 0
    v_accvgpr_write_b32 a45, 0
    v_accvgpr_write_b32 a46, 0
    v_accvgpr_write_b32 a47, 0
    s_add_u32 m0, s28, 24832
    s_nop 0
    s_nop 0
    buffer_load_dwordx4 v5, s[16:19], s25 offen offset:0 lds
    v_accvgpr_write_b32 a48, 0
    v_accvgpr_write_b32 a49, 0
    v_accvgpr_write_b32 a50, 0
    v_accvgpr_write_b32 a51, 0
    v_accvgpr_write_b32 a52, 0
    v_accvgpr_write_b32 a53, 0
    v_accvgpr_write_b32 a54, 0
    v_accvgpr_write_b32 a55, 0
    v_accvgpr_write_b32 a56, 0
    v_accvgpr_write_b32 a57, 0
    v_accvgpr_write_b32 a58, 0
    v_accvgpr_write_b32 a59, 0
    v_accvgpr_write_b32 a60, 0
    v_accvgpr_write_b32 a61, 0
    v_accvgpr_write_b32 a62, 0
    v_accvgpr_write_b32 a63, 0
    buffer_load_dwordx4 v6, s[16:19], s25 offen offset:1024 lds
    v_accvgpr_write_b32 a64, 0
    v_accvgpr_write_b32 a65, 0
    v_accvgpr_write_b32 a66, 0
    v_accvgpr_write_b32 a67, 0
    v_accvgpr_write_b32 a68, 0
    v_accvgpr_write_b32 a69, 0
    v_accvgpr_write_b32 a70, 0
    v_accvgpr_write_b32 a71, 0
    v_accvgpr_write_b32 a72, 0
    v_accvgpr_write_b32 a73, 0
    v_accvgpr_write_b32 a74, 0
    v_accvgpr_write_b32 a75, 0
    v_accvgpr_write_b32 a76, 0
    v_accvgpr_write_b32 a77, 0
    v_accvgpr_write_b32 a78, 0
    v_accvgpr_write_b32 a79, 0
    s_add_u32 m0, s29, 4352
    s_nop 0
    s_nop 0
    buffer_load_dwordx4 v7, s[20:23], s26 offen lds
    v_accvgpr_write_b32 a80, 0
    v_accvgpr_write_b32 a81, 0
    v_accvgpr_write_b32 a82, 0
    v_accvgpr_write_b32 a83, 0
    v_accvgpr_write_b32 a84, 0
    v_accvgpr_write_b32 a85, 0
    v_accvgpr_write_b32 a86, 0
    v_accvgpr_write_b32 a87, 0
    v_accvgpr_write_b32 a88, 0
    v_accvgpr_write_b32 a89, 0
    v_accvgpr_write_b32 a90, 0
    v_accvgpr_write_b32 a91, 0
    v_accvgpr_write_b32 a92, 0
    v_accvgpr_write_b32 a93, 0
    v_accvgpr_write_b32 a94, 0
    v_accvgpr_write_b32 a95, 0
    s_add_u32 s25, s25, 229376
    s_sub_u32 s26, s26, -64
    s_add_u32 m0, s27, 33024
    s_nop 0
    s_nop 0
    buffer_load_dwordx4 v1, s[92:95], s24 offen offset:0 lds
    v_accvgpr_write_b32 a96, 0
    v_accvgpr_write_b32 a97, 0
    v_accvgpr_write_b32 a98, 0
    v_accvgpr_write_b32 a99, 0
    v_accvgpr_write_b32 a100, 0
    v_accvgpr_write_b32 a101, 0
    v_accvgpr_write_b32 a102, 0
    v_accvgpr_write_b32 a103, 0
    v_accvgpr_write_b32 a104, 0
    v_accvgpr_write_b32 a105, 0
    v_accvgpr_write_b32 a106, 0
    v_accvgpr_write_b32 a107, 0
    v_accvgpr_write_b32 a108, 0
    v_accvgpr_write_b32 a109, 0
    v_accvgpr_write_b32 a110, 0
    v_accvgpr_write_b32 a111, 0
    buffer_load_dwordx4 v2, s[92:95], s24 offen offset:1024 lds
    v_accvgpr_write_b32 a112, 0
    v_accvgpr_write_b32 a113, 0
    v_accvgpr_write_b32 a114, 0
    v_accvgpr_write_b32 a115, 0
    v_accvgpr_write_b32 a116, 0
    v_accvgpr_write_b32 a117, 0
    v_accvgpr_write_b32 a118, 0
    v_accvgpr_write_b32 a119, 0
    v_accvgpr_write_b32 a120, 0
    v_accvgpr_write_b32 a121, 0
    v_accvgpr_write_b32 a122, 0
    v_accvgpr_write_b32 a123, 0
    v_accvgpr_write_b32 a124, 0
    v_accvgpr_write_b32 a125, 0
    v_accvgpr_write_b32 a126, 0
    v_accvgpr_write_b32 a127, 0
    buffer_load_dwordx4 v3, s[92:95], s24 offen offset:2048 lds
    v_accvgpr_write_b32 a128, 0
    v_accvgpr_write_b32 a129, 0
    v_accvgpr_write_b32 a130, 0
    v_accvgpr_write_b32 a131, 0
    v_accvgpr_write_b32 a132, 0
    v_accvgpr_write_b32 a133, 0
    v_accvgpr_write_b32 a134, 0
    v_accvgpr_write_b32 a135, 0
    v_accvgpr_write_b32 a136, 0
    v_accvgpr_write_b32 a137, 0
    v_accvgpr_write_b32 a138, 0
    v_accvgpr_write_b32 a139, 0
    v_accvgpr_write_b32 a140, 0
    v_accvgpr_write_b32 a141, 0
    v_accvgpr_write_b32 a142, 0
    v_accvgpr_write_b32 a143, 0
    buffer_load_dwordx4 v4, s[92:95], s24 offen offset:3072 lds
    v_accvgpr_write_b32 a144, 0
    v_accvgpr_write_b32 a145, 0
    v_accvgpr_write_b32 a146, 0
    v_accvgpr_write_b32 a147, 0
    v_accvgpr_write_b32 a148, 0
    v_accvgpr_write_b32 a149, 0
    v_accvgpr_write_b32 a150, 0
    v_accvgpr_write_b32 a151, 0
    v_accvgpr_write_b32 a152, 0
    v_accvgpr_write_b32 a153, 0
    v_accvgpr_write_b32 a154, 0
    v_accvgpr_write_b32 a155, 0
    v_accvgpr_write_b32 a156, 0
    v_accvgpr_write_b32 a157, 0
    v_accvgpr_write_b32 a158, 0
    v_accvgpr_write_b32 a159, 0
    s_add_u32 s24, s24, 16384
    s_add_u32 m0, s28, 33024
    s_nop 0
    s_nop 0
    buffer_load_dwordx4 v5, s[12:15], s25 offen offset:0 lds
    v_accvgpr_write_b32 a160, 0
    v_accvgpr_write_b32 a161, 0
    v_accvgpr_write_b32 a162, 0
    v_accvgpr_write_b32 a163, 0
    v_accvgpr_write_b32 a164, 0
    v_accvgpr_write_b32 a165, 0
    v_accvgpr_write_b32 a166, 0
    v_accvgpr_write_b32 a167, 0
    v_accvgpr_write_b32 a168, 0
    v_accvgpr_write_b32 a169, 0
    v_accvgpr_write_b32 a170, 0
    v_accvgpr_write_b32 a171, 0
    v_accvgpr_write_b32 a172, 0
    v_accvgpr_write_b32 a173, 0
    v_accvgpr_write_b32 a174, 0
    v_accvgpr_write_b32 a175, 0
    buffer_load_dwordx4 v6, s[12:15], s25 offen offset:1024 lds
    v_accvgpr_write_b32 a176, 0
    v_accvgpr_write_b32 a177, 0
    v_accvgpr_write_b32 a178, 0
    v_accvgpr_write_b32 a179, 0
    v_accvgpr_write_b32 a180, 0
    v_accvgpr_write_b32 a181, 0
    v_accvgpr_write_b32 a182, 0
    v_accvgpr_write_b32 a183, 0
    v_accvgpr_write_b32 a184, 0
    v_accvgpr_write_b32 a185, 0
    v_accvgpr_write_b32 a186, 0
    v_accvgpr_write_b32 a187, 0
    v_accvgpr_write_b32 a188, 0
    v_accvgpr_write_b32 a189, 0
    v_accvgpr_write_b32 a190, 0
    v_accvgpr_write_b32 a191, 0
    s_add_u32 m0, s28, 41216
    s_nop 0
    s_nop 0
    buffer_load_dwordx4 v5, s[16:19], s25 offen offset:0 lds
    v_accvgpr_write_b32 a192, 0
    v_accvgpr_write_b32 a193, 0
    v_accvgpr_write_b32 a194, 0
    v_accvgpr_write_b32 a195, 0
    v_accvgpr_write_b32 a196, 0
    v_accvgpr_write_b32 a197, 0
    v_accvgpr_write_b32 a198, 0
    v_accvgpr_write_b32 a199, 0
    v_accvgpr_write_b32 a200, 0
    v_accvgpr_write_b32 a201, 0
    v_accvgpr_write_b32 a202, 0
    v_accvgpr_write_b32 a203, 0
    v_accvgpr_write_b32 a204, 0
    v_accvgpr_write_b32 a205, 0
    v_accvgpr_write_b32 a206, 0
    v_accvgpr_write_b32 a207, 0
    buffer_load_dwordx4 v6, s[16:19], s25 offen offset:1024 lds
    v_accvgpr_write_b32 a208, 0
    v_accvgpr_write_b32 a209, 0
    v_accvgpr_write_b32 a210, 0
    v_accvgpr_write_b32 a211, 0
    v_accvgpr_write_b32 a212, 0
    v_accvgpr_write_b32 a213, 0
    v_accvgpr_write_b32 a214, 0
    v_accvgpr_write_b32 a215, 0
    v_accvgpr_write_b32 a216, 0
    v_accvgpr_write_b32 a217, 0
    v_accvgpr_write_b32 a218, 0
    v_accvgpr_write_b32 a219, 0
    v_accvgpr_write_b32 a220, 0
    v_accvgpr_write_b32 a221, 0
    v_accvgpr_write_b32 a222, 0
    v_accvgpr_write_b32 a223, 0
    s_add_u32 m0, s29, 8448
    s_nop 0
    s_nop 0
    buffer_load_dwordx4 v7, s[20:23], s26 offen lds
    s_add_u32 s25, s25, 229376
    s_sub_u32 s26, s26, -64
    v_accvgpr_write_b32 a224, 0
    v_accvgpr_write_b32 a225, 0
    v_accvgpr_write_b32 a226, 0
    v_accvgpr_write_b32 a227, 0
    v_accvgpr_write_b32 a228, 0
    v_accvgpr_write_b32 a229, 0
    v_accvgpr_write_b32 a230, 0
    v_accvgpr_write_b32 a231, 0
    v_accvgpr_write_b32 a232, 0
    v_accvgpr_write_b32 a233, 0
    v_accvgpr_write_b32 a234, 0
    v_accvgpr_write_b32 a235, 0
    v_accvgpr_write_b32 a236, 0
    v_accvgpr_write_b32 a237, 0
    v_accvgpr_write_b32 a238, 0
    v_accvgpr_write_b32 a239, 0
    v_accvgpr_write_b32 a240, 0
    v_accvgpr_write_b32 a241, 0
    v_accvgpr_write_b32 a242, 0
    v_accvgpr_write_b32 a243, 0
    v_accvgpr_write_b32 a244, 0
    v_accvgpr_write_b32 a245, 0
    v_accvgpr_write_b32 a246, 0
    v_accvgpr_write_b32 a247, 0
    v_accvgpr_write_b32 a248, 0
    v_accvgpr_write_b32 a249, 0
    v_accvgpr_write_b32 a250, 0
    v_accvgpr_write_b32 a251, 0
    v_accvgpr_write_b32 a252, 0
    v_accvgpr_write_b32 a253, 0
    v_accvgpr_write_b32 a254, 0
    v_accvgpr_write_b32 a255, 0
    v_mov_b32 v208, 0
    v_mov_b32 v209, 0
    v_mov_b32 v210, 0
    v_mov_b32 v211, 0
    v_mov_b32 v212, 0
    v_mov_b32 v213, 0
    v_mov_b32 v214, 0
    v_mov_b32 v215, 0
    v_mov_b32 v216, 0
    v_mov_b32 v217, 0
    v_mov_b32 v218, 0
    v_mov_b32 v219, 0
    v_mov_b32 v220, 0
    v_mov_b32 v221, 0
    v_mov_b32 v222, 0
    v_mov_b32 v223, 0
    v_mov_b32 v224, 0
    v_mov_b32 v225, 0
    v_mov_b32 v226, 0
    v_mov_b32 v227, 0
    v_mov_b32 v228, 0
    v_mov_b32 v229, 0
    v_mov_b32 v230, 0
    v_mov_b32 v231, 0
    v_mov_b32 v232, 0
    v_mov_b32 v233, 0
    v_mov_b32 v234, 0
    v_mov_b32 v235, 0
    v_mov_b32 v236, 0
    v_mov_b32 v237, 0
    v_mov_b32 v238, 0
    v_mov_b32 v239, 0
    s_lshl_b32 s87, s2, 2
    s_add_u32 s87, s87, s31
    s_mul_i32 s87, s87, 7168
    s_mov_b32 s88, s90
    s_nop 0
    s_and_b32 s89, s91, 0xffff
    s_mov_b32 s90, 7340032
    s_mov_b32 s91, 0x20000
    v_and_b32 v29, 63, v0
    s_lshl_b32 s34, s32, 2
    s_add_u32 s34, s34, s31
    v_lshrrev_b32 v30, 2, v29
    s_lshl_b32 s35, s34, 2
    v_add_u32_e64 v30, s35, v30
    s_movk_i32 s35, 7168
    v_mul_lo_u32 v30, v30, s35
    v_and_b32 v31, 3, v29
    v_lshlrev_b32 v31, 7, v31
    v_min_u32 v31, 220, v31
    v_add_u32_e64 v30, v30, v31
    s_mul_i32 s35, s33, 224
    v_add_u32 v30, s35, v30
    v_mov_b32 v31, 0x40000000
    v_cmp_gt_u32 vcc, 16, v29
    s_nop 1
    v_cndmask_b32 v22, v31, v30, vcc
    s_lshl_b32 s34, s32, 1
    s_and_b32 s35, s31, 1
    s_add_u32 s34, s34, s35
    s_lshl_b32 s34, s34, 1
    s_lshl_b32 s35, s33, 5
    s_add_u32 s34, s34, s35
    v_lshrrev_b32 v30, 1, v29
    v_add_u32 v30, s34, v30
    v_lshlrev_b32 v30, 11, v30
    v_and_b32_e64 v31, 1, v29
    v_lshl_add_u32 v30, v31, 7, v30
    v_mov_b32 v31, 0x40000000
    v_cmp_gt_u32 vcc, 4, v29
    s_nop 1
    v_cndmask_b32 v23, v31, v30, vcc
    s_and_b32 s34, s33, 3
    s_lshl_b32 s34, s34, 2
    s_add_u32 s34, s34, s31
    s_lshl_b32 s34, s34, 4
    s_lshl_b32 s35, s32, 8
    s_add_u32 s34, s34, s35
    v_lshrrev_b32 v30, 1, v29
    v_add_u32 v30, s34, v30
    v_lshlrev_b32 v30, 11, v30
    v_and_b32 v31, 1, v29
    v_lshl_add_u32 v30, v31, 7, v30
    v_mov_b32 v31, 0x40000000
    v_cmp_gt_u32 vcc, 32, v29
    s_nop 1
    v_cndmask_b32 v28, v31, v30, vcc
    s_mov_b32 s97, 917504
    s_mov_b32 s98, 256
    s_mov_b32 s99, 256
    buffer_load_dword v21, v22, s[12:15], s97 offen
    buffer_load_dword v21, v22, s[16:19], s97 offen
    s_add_u32 s97, s97, 917504
    buffer_load_dword v21, v23, s[20:23], s98 offen
    s_add_u32 s98, s98, 256
    buffer_load_dword v21, v28, s[92:95], s99 offen
    s_add_u32 s99, s99, 256
    s_nop 1
    s_lshl_b32 s34, s32, 5
    s_add_u32 s34, s34, s33
    s_lshl_b32 s34, s34, 2
    s_add_u32 s34, s34, s31
    s_nop 0
    s_mul_i32 s34, s34, 12288
    s_add_u32 s34, s34, 83886080
    s_add_u32 s44, s48, s34
    s_addc_u32 s45, s49, 0
    s_and_b32 s45, s45, 0xffff
    s_mov_b32 s46, 12288
    s_mov_b32 s47, 0x20000
    s_mov_b32 s58, 0
    v_and_b32 v31, 63, v0
    v_lshlrev_b32 v30, 4, v31
    v_mov_b32 v24, 0x40000000
    v_cmp_gt_u32 vcc, 32, v31
    s_nop 1
    v_cndmask_b32 v30, v24, v30, vcc
    v_mov_b32 v24, -1
    v_mov_b32 v25, -1
    v_mov_b32 v26, -1
    v_mov_b32 v27, -1
    v_mov_b32 v31, v119
    v_and_b32 v116, 0x3b, v0
    v_cmp_eq_u32 vcc, 0, v116
    v_and_b32 v116, 4, v0
    v_mov_b32 v117, 1073741824
    v_cndmask_b32 v116, v117, v116, vcc
    s_lshl_b32 s34, s2, 5
    s_lshl_b32 s35, s31, 3
    s_add_u32 s34, s34, s35
    s_add_u32 s34, s34, 42205184
    s_waitcnt vmcnt(21)
    v_lshlrev_b32 v136, 16, v120
    v_and_b32 v137, 0xffff0000, v120
    v_lshlrev_b32_e64 v138, 16, v121
    v_and_b32 v139, 0xffff0000, v121
    v_lshlrev_b32_e64 v140, 16, v122
    v_and_b32 v141, 0xffff0000, v122
    v_lshlrev_b32_e64 v142, 16, v123
    v_and_b32 v143, 0xffff0000, v123
    v_lshlrev_b32_e64 v144, 16, v124
    v_and_b32 v145, 0xffff0000, v124
    s_add_u32 m0, s27, 37120
    s_nop 0
    s_nop 0
    buffer_load_dwordx4 v1, s[92:95], s24 offen offset:0 lds
    v_lshlrev_b32_e64 v146, 16, v125
    v_and_b32 v147, 0xffff0000, v125
    v_lshlrev_b32_e64 v148, 16, v126
    v_and_b32 v149, 0xffff0000, v126
    v_lshlrev_b32_e64 v150, 16, v127
    v_and_b32 v151, 0xffff0000, v127
    v_lshlrev_b32_e64 v152, 16, v128
    v_and_b32 v153, 0xffff0000, v128
    v_lshlrev_b32_e64 v154, 16, v129
    v_and_b32 v155, 0xffff0000, v129
    buffer_load_dwordx4 v2, s[92:95], s24 offen offset:1024 lds
    v_lshlrev_b32_e64 v156, 16, v130
    v_and_b32 v157, 0xffff0000, v130
    v_lshlrev_b32_e64 v158, 16, v131
    v_and_b32 v159, 0xffff0000, v131
    v_lshlrev_b32_e64 v160, 16, v132
    v_and_b32 v161, 0xffff0000, v132
    v_lshlrev_b32_e64 v162, 16, v133
    v_and_b32 v163, 0xffff0000, v133
    v_lshlrev_b32_e64 v164, 16, v134
    v_and_b32 v165, 0xffff0000, v134
    buffer_load_dwordx4 v3, s[92:95], s24 offen offset:2048 lds
    v_lshlrev_b32_e64 v166, 16, v135
    v_and_b32 v167, 0xffff0000, v135
    v_pk_add_f32 v[168:169], v[136:137], v[138:139]
    v_pk_add_f32 v[172:173], v[140:141], v[142:143]
    v_pk_mul_f32 v[170:171], v[136:137], v[136:137]
    v_pk_mul_f32 v[174:175], v[138:139], v[138:139]
    v_pk_add_f32 v[172:173], v[172:173], v[144:145]
    v_pk_add_f32 v[168:169], v[168:169], v[146:147]
    v_pk_add_f32 v[172:173], v[172:173], v[148:149]
    v_pk_add_f32 v[168:169], v[168:169], v[150:151]
    buffer_load_dwordx4 v4, s[92:95], s24 offen offset:3072 lds
    v_pk_add_f32 v[172:173], v[172:173], v[152:153]
    v_pk_add_f32 v[168:169], v[168:169], v[154:155]
    v_pk_add_f32 v[172:173], v[172:173], v[156:157]
    v_pk_add_f32 v[168:169], v[168:169], v[158:159]
    v_pk_add_f32 v[172:173], v[172:173], v[160:161]
    v_pk_add_f32 v[168:169], v[168:169], v[162:163]
    v_pk_add_f32 v[172:173], v[172:173], v[164:165]
    v_pk_add_f32 v[168:169], v[168:169], v[166:167]
    v_pk_fma_f32 v[170:171], v[140:141], v[140:141], v[170:171]
    v_pk_fma_f32 v[174:175], v[142:143], v[142:143], v[174:175]
    s_add_u32 s24, s24, 4294951040
    s_add_u32 m0, s28, 49408
    s_nop 0
    s_nop 0
    buffer_load_dwordx4 v5, s[12:15], s25 offen offset:0 lds
    v_pk_fma_f32 v[170:171], v[144:145], v[144:145], v[170:171]
    v_pk_fma_f32 v[174:175], v[146:147], v[146:147], v[174:175]
    v_pk_fma_f32 v[170:171], v[148:149], v[148:149], v[170:171]
    v_pk_fma_f32 v[174:175], v[150:151], v[150:151], v[174:175]
    v_pk_fma_f32 v[170:171], v[152:153], v[152:153], v[170:171]
    v_pk_fma_f32 v[174:175], v[154:155], v[154:155], v[174:175]
    v_pk_fma_f32 v[170:171], v[156:157], v[156:157], v[170:171]
    v_pk_fma_f32 v[174:175], v[158:159], v[158:159], v[174:175]
    v_pk_fma_f32 v[170:171], v[160:161], v[160:161], v[170:171]
    v_pk_fma_f32 v[174:175], v[162:163], v[162:163], v[174:175]
    buffer_load_dwordx4 v6, s[12:15], s25 offen offset:1024 lds
    v_pk_fma_f32 v[170:171], v[164:165], v[164:165], v[170:171]
    v_pk_fma_f32 v[174:175], v[166:167], v[166:167], v[174:175]
    v_pk_add_f32 v[168:169], v[168:169], v[172:173]
    v_pk_add_f32 v[170:171], v[170:171], v[174:175]
    v_add_f32 v168, v168, v169
    v_add_f32_e64 v170, v170, v171
    s_nop 1
    v_add_f32_dpp v168, v168, v168 quad_perm:[1,0,3,2] row_mask:0xf bank_mask:0xf
    v_add_f32_dpp v170, v170, v170 quad_perm:[1,0,3,2] row_mask:0xf bank_mask:0xf
    s_nop 1
    s_nop 0
    s_add_u32 m0, s28, 57600
    s_nop 0
    s_nop 0
    buffer_load_dwordx4 v5, s[16:19], s25 offen offset:0 lds
    v_add_f32_dpp v168, v168, v168 quad_perm:[2,3,0,1] row_mask:0xf bank_mask:0xf
    v_add_f32_dpp v170, v170, v170 quad_perm:[2,3,0,1] row_mask:0xf bank_mask:0xf
    s_nop 1
    s_nop 0
    v_add_f32_dpp v168, v168, v168 row_ror:8 row_mask:0xf bank_mask:0xf
    v_add_f32_dpp v170, v170, v170 row_ror:8 row_mask:0xf bank_mask:0xf
    v_mov_b32 v169, v168
    v_mov_b32_e64 v171, v170
    s_nop 1
    v_permlane16_swap_b32 v168, v169
    v_permlane16_swap_b32 v170, v171
    buffer_load_dwordx4 v6, s[16:19], s25 offen offset:1024 lds
    s_nop 1
    v_add_f32 v168, v168, v169
    v_add_f32 v170, v170, v171
    v_mov_b32 v169, v168
    v_mov_b32 v171, v170
    s_nop 1
    v_permlane32_swap_b32 v168, v169
    v_permlane32_swap_b32 v170, v171
    s_nop 1
    v_add_f32 v168, v168, v169
    s_add_u32 m0, s29, 12544
    s_nop 0
    s_nop 0
    buffer_load_dwordx4 v7, s[20:23], s26 offen lds
    s_add_u32 s25, s25, 229376
    s_sub_u32 s26, s26, -64
    v_add_f32_e64 v170, v170, v171
    v_mul_f32 v168, 981467136, v168
    v_mul_f32 v170, 981467136, v170
    v_fma_f32 v170, -v168, v168, v170
    v_max_f32_e64 v170, 0, v170
    v_cvt_pk_bf16_f32 v170, v170, v170
    v_lshlrev_b32_e64 v170, 16, v170
    v_add_f32 v170, 925353388, v170
    v_cvt_pk_bf16_f32 v170, v170, v170
    v_lshlrev_b32 v170, 16, v170
    v_sqrt_f32_e64 v170, v170
    s_nop 0
    v_cvt_pk_bf16_f32 v169, v168, v170
    buffer_store_dword v169, v116, s[8:11], s34 offen sc1
    s_waitcnt vmcnt(49)
    s_nop 0
    v_lshl_or_b32 v17, v33, 16, v32
    v_lshl_or_b32 v18, v36, 16, v35
    v_lshl_or_b32 v19, v37, 16, v34
    v_mov_b32 v244, 0x3f803f80
    v_mov_b32_e64 v248, 0
    v_mov_b32 v245, 0x3f803f80
    v_mov_b32_e64 v249, 0
    v_mov_b32 v246, 0x3f803f80
    v_mov_b32_e64 v250, 0
    v_mov_b32 v247, 0x3f803f80
    v_mov_b32 v251, 0
    v_and_b32 v253, 63, v0
    v_lshlrev_b32 v253, 2, v253
    v_cmp_eq_u32 vcc, 0, v0
    v_mov_b32 v62, 1073741824
    v_mov_b32 v255, 1
    v_mov_b32 v63, 0
    v_cndmask_b32 v254, v62, v63, vcc
    s_waitcnt vmcnt(35)
    s_barrier
    ds_read_b128 v[32:35], v8 offset:0
    ds_read_b128 v[36:39], v8 offset:2048
    ds_read_b128 v[40:43], v8 offset:4096
    ds_read_b128 v[44:47], v8 offset:6144
    ds_read_b64_tr_b16 v[48:49], v10 offset:0
    ds_read_b64_tr_b16 v[50:51], v10 offset:1024
    ds_read_b64_tr_b16 v[76:77], v10 offset:8192
    ds_read_b64_tr_b16 v[78:79], v10 offset:9216
    ds_read_b64_tr_b16 v[52:53], v11 offset:0
    ds_read_b64_tr_b16 v[54:55], v11 offset:1024
    ds_read_b64_tr_b16 v[80:81], v11 offset:8192
    ds_read_b64_tr_b16 v[82:83], v11 offset:9216
    ds_read_b64_tr_b16 v[56:57], v12 offset:0
    ds_read_b64_tr_b16 v[58:59], v12 offset:1024
    ds_read_b64_tr_b16 v[84:85], v12 offset:8192
    ds_read_b64_tr_b16 v[86:87], v12 offset:9216
    ds_read_b64_tr_b16 v[60:61], v13 offset:0
    ds_read_b64_tr_b16 v[62:63], v13 offset:1024
    ds_read_b64_tr_b16 v[88:89], v13 offset:8192
    ds_read_b64_tr_b16 v[90:91], v13 offset:9216
    ds_read_b64_tr_b16 v[64:65], v14 offset:0
    ds_read_b64_tr_b16 v[66:67], v14 offset:1024
    ds_read_b64_tr_b16 v[92:93], v14 offset:8192
    ds_read_b64_tr_b16 v[94:95], v14 offset:9216
    ds_read_b64_tr_b16 v[68:69], v15 offset:0
    ds_read_b64_tr_b16 v[70:71], v15 offset:1024
    ds_read_b64_tr_b16 v[96:97], v15 offset:8192
    ds_read_b64_tr_b16 v[98:99], v15 offset:9216
    ds_read_b64_tr_b16 v[72:73], v16 offset:0
    ds_read_b64_tr_b16 v[74:75], v16 offset:1024
    ds_read_b64_tr_b16 v[100:101], v16 offset:8192
    ds_read_b64_tr_b16 v[102:103], v16 offset:9216
    ds_read_b128 v[104:107], v9 offset:0
    ds_read_b128 v[108:111], v9 offset:1024
    ds_read_b128 v[112:115], v9 offset:2048
    ds_read_b128 v[116:119], v9 offset:3072
    s_waitcnt vmcnt(23) lgkmcnt(0)
    s_barrier
    v_mfma_f32_16x16x32_bf16 a[0:3], v[48:51], v[32:35], a[0:3]
    s_add_u32 m0, s28, 256
    v_mfma_f32_16x16x32_bf16 a[4:7], v[48:51], v[36:39], a[4:7]
    ds_read_b128 v[120:123], v20 offset:0
    v_mfma_f32_16x16x32_bf16 a[8:11], v[48:51], v[40:43], a[8:11]
    ds_read_b128 v[124:127], v20 offset:2048
    v_mfma_f32_16x16x32_bf16 a[12:15], v[48:51], v[44:47], a[12:15]
    ds_read_b128 v[128:131], v20 offset:4096
    v_mfma_f32_16x16x32_bf16 a[112:115], v[76:79], v[32:35], a[112:115]
    buffer_load_dwordx4 v5, s[12:15], s25 offen offset:0 lds
    v_mfma_f32_16x16x32_bf16 a[116:119], v[76:79], v[36:39], a[116:119]
    ds_read_b128 v[132:135], v20 offset:6144
    v_mfma_f32_16x16x32_bf16 a[120:123], v[76:79], v[40:43], a[120:123]
    ds_read_b64_tr_b16 v[136:137], v10 offset:16384
    v_mfma_f32_16x16x32_bf16 a[124:127], v[76:79], v[44:47], a[124:127]
    ds_read_b64_tr_b16 v[138:139], v10 offset:17408
    v_mfma_f32_16x16x32_bf16 a[16:19], v[52:55], v[32:35], a[16:19]
    buffer_load_dwordx4 v6, s[12:15], s25 offen offset:1024 lds
    v_mfma_f32_16x16x32_bf16 a[20:23], v[52:55], v[36:39], a[20:23]
    ds_read_b64_tr_b16 v[164:165], v10 offset:24576
    v_mfma_f32_16x16x32_bf16 a[24:27], v[52:55], v[40:43], a[24:27]
    ds_read_b64_tr_b16 v[166:167], v10 offset:25600
    v_mfma_f32_16x16x32_bf16 a[28:31], v[52:55], v[44:47], a[28:31]
    ds_read_b64_tr_b16 v[140:141], v11 offset:16384
    v_mfma_f32_16x16x32_bf16 a[128:131], v[80:83], v[32:35], a[128:131]
    s_add_u32 m0, s28, 8448
    v_mfma_f32_16x16x32_bf16 a[132:135], v[80:83], v[36:39], a[132:135]
    ds_read_b64_tr_b16 v[142:143], v11 offset:17408
    v_mfma_f32_16x16x32_bf16 a[136:139], v[80:83], v[40:43], a[136:139]
    ds_read_b64_tr_b16 v[168:169], v11 offset:24576
    v_mfma_f32_16x16x32_bf16 a[140:143], v[80:83], v[44:47], a[140:143]
    ds_read_b64_tr_b16 v[170:171], v11 offset:25600
    v_mfma_f32_16x16x32_bf16 a[32:35], v[56:59], v[32:35], a[32:35]
    buffer_load_dwordx4 v5, s[16:19], s25 offen offset:0 lds
    v_mfma_f32_16x16x32_bf16 a[36:39], v[56:59], v[36:39], a[36:39]
    ds_read_b64_tr_b16 v[144:145], v12 offset:16384
    v_mfma_f32_16x16x32_bf16 a[40:43], v[56:59], v[40:43], a[40:43]
    ds_read_b64_tr_b16 v[146:147], v12 offset:17408
    v_mfma_f32_16x16x32_bf16 a[44:47], v[56:59], v[44:47], a[44:47]
    ds_read_b64_tr_b16 v[172:173], v12 offset:24576
    v_mfma_f32_16x16x32_bf16 a[144:147], v[84:87], v[32:35], a[144:147]
    buffer_load_dwordx4 v6, s[16:19], s25 offen offset:1024 lds
    v_mfma_f32_16x16x32_bf16 a[148:151], v[84:87], v[36:39], a[148:151]
    ds_read_b64_tr_b16 v[174:175], v12 offset:25600
    v_mfma_f32_16x16x32_bf16 a[152:155], v[84:87], v[40:43], a[152:155]
    ds_read_b64_tr_b16 v[148:149], v13 offset:16384
    v_mfma_f32_16x16x32_bf16 a[156:159], v[84:87], v[44:47], a[156:159]
    ds_read_b64_tr_b16 v[150:151], v13 offset:17408
    v_mfma_f32_16x16x32_bf16 a[48:51], v[60:63], v[32:35], a[48:51]
    s_add_u32 m0, s29, 256
    v_mfma_f32_16x16x32_bf16 a[52:55], v[60:63], v[36:39], a[52:55]
    ds_read_b64_tr_b16 v[176:177], v13 offset:24576
    v_mfma_f32_16x16x32_bf16 a[56:59], v[60:63], v[40:43], a[56:59]
    ds_read_b64_tr_b16 v[178:179], v13 offset:25600
    v_mfma_f32_16x16x32_bf16 a[60:63], v[60:63], v[44:47], a[60:63]
    ds_read_b64_tr_b16 v[152:153], v14 offset:16384
    v_mfma_f32_16x16x32_bf16 a[160:163], v[88:91], v[32:35], a[160:163]
    buffer_load_dwordx4 v7, s[20:23], s26 offen lds
    v_mfma_f32_16x16x32_bf16 a[164:167], v[88:91], v[36:39], a[164:167]
    ds_read_b64_tr_b16 v[154:155], v14 offset:17408
    v_mfma_f32_16x16x32_bf16 a[168:171], v[88:91], v[40:43], a[168:171]
    s_waitcnt lgkmcnt(15)
    s_nop 0
    v_mfma_f32_16x16x32_bf16 a[172:175], v[88:91], v[44:47], a[172:175]
    ds_read_b64_tr_b16 v[180:181], v14 offset:24576
    v_mfma_f32_16x16x32_bf16 a[64:67], v[64:67], v[32:35], a[64:67]
    s_add_u32 m0, s27, 256
    v_mfma_f32_16x16x32_bf16 a[68:71], v[64:67], v[36:39], a[68:71]
    ds_read_b64_tr_b16 v[182:183], v14 offset:25600
    v_mfma_f32_16x16x32_bf16 a[72:75], v[64:67], v[40:43], a[72:75]
    ds_read_b64_tr_b16 v[156:157], v15 offset:16384
    v_mfma_f32_16x16x32_bf16 a[76:79], v[64:67], v[44:47], a[76:79]
    ds_read_b64_tr_b16 v[158:159], v15 offset:17408
    v_mfma_f32_16x16x32_bf16 a[176:179], v[92:95], v[32:35], a[176:179]
    buffer_load_dwordx4 v1, s[92:95], s24 offen offset:0 lds
    v_mfma_f32_16x16x32_bf16 a[180:183], v[92:95], v[36:39], a[180:183]
    ds_read_b64_tr_b16 v[184:185], v15 offset:24576
    v_mfma_f32_16x16x32_bf16 a[184:187], v[92:95], v[40:43], a[184:187]
    ds_read_b64_tr_b16 v[186:187], v15 offset:25600
    v_mfma_f32_16x16x32_bf16 a[188:191], v[92:95], v[44:47], a[188:191]
    ds_read_b64_tr_b16 v[160:161], v16 offset:16384
    v_mfma_f32_16x16x32_bf16 a[80:83], v[68:71], v[32:35], a[80:83]
    buffer_load_dwordx4 v2, s[92:95], s24 offen offset:1024 lds
    v_mfma_f32_16x16x32_bf16 a[84:87], v[68:71], v[36:39], a[84:87]
    ds_read_b64_tr_b16 v[162:163], v16 offset:17408
    v_mfma_f32_16x16x32_bf16 a[88:91], v[68:71], v[40:43], a[88:91]
    ds_read_b64_tr_b16 v[188:189], v16 offset:24576
    v_mfma_f32_16x16x32_bf16 a[92:95], v[68:71], v[44:47], a[92:95]
    ds_read_b64_tr_b16 v[190:191], v16 offset:25600
    v_mfma_f32_16x16x32_bf16 a[192:195], v[96:99], v[32:35], a[192:195]
    buffer_load_dwordx4 v3, s[92:95], s24 offen offset:2048 lds
    v_mfma_f32_16x16x32_bf16 a[196:199], v[96:99], v[36:39], a[196:199]
    ds_read_b128 v[192:195], v9 offset:4096
    v_mfma_f32_16x16x32_bf16 a[200:203], v[96:99], v[40:43], a[200:203]
    ds_read_b128 v[196:199], v9 offset:5120
    v_mfma_f32_16x16x32_bf16 a[204:207], v[96:99], v[44:47], a[204:207]
    ds_read_b128 v[200:203], v9 offset:6144
    v_mfma_f32_16x16x32_bf16 a[96:99], v[72:75], v[32:35], a[96:99]
    buffer_load_dwordx4 v4, s[92:95], s24 offen offset:3072 lds
    v_mfma_f32_16x16x32_bf16 a[100:103], v[72:75], v[36:39], a[100:103]
    ds_read_b128 v[204:207], v9 offset:7168
    v_mfma_f32_16x16x32_bf16 a[104:107], v[72:75], v[40:43], a[104:107]
    s_set_gpr_idx_on s59, gpr_idx(SRC0)
    v_mov_b64 v[240:241], v[48:49]
    v_mov_b64 v[242:243], v[50:51]
    s_set_gpr_idx_off
    v_mfma_f32_16x16x32_bf16 a[108:111], v[72:75], v[44:47], a[108:111]
    v_mfma_f32_16x16x32_bf16 a[208:211], v[100:103], v[32:35], a[208:211]
    s_add_u32 s24, s24, 16384
    v_mfma_f32_16x16x32_bf16 a[212:215], v[100:103], v[36:39], a[212:215]
    v_mfma_f32_16x16x32_bf16 a[216:219], v[100:103], v[40:43], a[216:219]
    v_mfma_f32_16x16x32_bf16 v[248:251], v[240:243], v[244:247], v[248:251]
    v_mfma_f32_16x16x32_bf16 a[220:223], v[100:103], v[44:47], a[220:223]
    v_mfma_f32_16x16x32_bf16 a[224:227], v[32:35], v[104:107], a[224:227]
    s_add_u32 s25, s25, 229376
    v_mfma_f32_16x16x32_bf16 a[240:243], v[36:39], v[104:107], a[240:243]
    v_mfma_f32_16x16x32_bf16 v[208:211], v[40:43], v[104:107], v[208:211]
    v_mfma_f32_16x16x32_bf16 v[224:227], v[44:47], v[104:107], v[224:227]
    v_mfma_f32_16x16x32_bf16 a[228:231], v[32:35], v[108:111], a[228:231]
    s_sub_u32 s26, s26, -64
    buffer_load_dword v21, v22, s[12:15], s97 offen
    v_mfma_f32_16x16x32_bf16 a[244:247], v[36:39], v[108:111], a[244:247]
    v_mfma_f32_16x16x32_bf16 v[212:215], v[40:43], v[108:111], v[212:215]
    v_mfma_f32_16x16x32_bf16 v[228:231], v[44:47], v[108:111], v[228:231]
    v_mfma_f32_16x16x32_bf16 a[232:235], v[32:35], v[112:115], a[232:235]
    v_mfma_f32_16x16x32_bf16 a[248:251], v[36:39], v[112:115], a[248:251]
    v_mfma_f32_16x16x32_bf16 v[216:219], v[40:43], v[112:115], v[216:219]
    buffer_store_dwordx4 v[24:27], v30, s[44:47], s58 offen sc1
    v_mfma_f32_16x16x32_bf16 v[232:235], v[44:47], v[112:115], v[232:235]
    s_add_u32 s58, s58, 512
    v_mfma_f32_16x16x32_bf16 a[236:239], v[32:35], v[116:119], a[236:239]
    v_mfma_f32_16x16x32_bf16 a[252:255], v[36:39], v[116:119], a[252:255]
    v_mfma_f32_16x16x32_bf16 v[220:223], v[40:43], v[116:119], v[220:223]
    v_mfma_f32_16x16x32_bf16 v[236:239], v[44:47], v[116:119], v[236:239]
    s_waitcnt vmcnt(17) lgkmcnt(0)
    s_barrier
    v_mfma_f32_16x16x32_bf16 a[0:3], v[136:139], v[120:123], a[0:3]
    s_add_u32 m0, s27, 4352
    v_mfma_f32_16x16x32_bf16 a[4:7], v[136:139], v[124:127], a[4:7]
    ds_read_b128 v[32:35], v8 offset:32768
    v_mfma_f32_16x16x32_bf16 a[8:11], v[136:139], v[128:131], a[8:11]
    ds_read_b128 v[36:39], v8 offset:34816
    v_mfma_f32_16x16x32_bf16 a[12:15], v[136:139], v[132:135], a[12:15]
    ds_read_b128 v[40:43], v8 offset:36864
    v_mfma_f32_16x16x32_bf16 a[112:115], v[164:167], v[120:123], a[112:115]
    buffer_load_dwordx4 v1, s[92:95], s24 offen offset:0 lds
    v_mfma_f32_16x16x32_bf16 a[116:119], v[164:167], v[124:127], a[116:119]
    ds_read_b128 v[44:47], v8 offset:38912
    v_mfma_f32_16x16x32_bf16 a[120:123], v[164:167], v[128:131], a[120:123]
    ds_read_b64_tr_b16 v[48:49], v10 offset:32768
    v_mfma_f32_16x16x32_bf16 a[124:127], v[164:167], v[132:135], a[124:127]
    ds_read_b64_tr_b16 v[50:51], v10 offset:33792
    v_mfma_f32_16x16x32_bf16 a[16:19], v[140:143], v[120:123], a[16:19]
    buffer_load_dwordx4 v2, s[92:95], s24 offen offset:1024 lds
    v_mfma_f32_16x16x32_bf16 a[20:23], v[140:143], v[124:127], a[20:23]
    ds_read_b64_tr_b16 v[76:77], v10 offset:40960
    v_mfma_f32_16x16x32_bf16 a[24:27], v[140:143], v[128:131], a[24:27]
    ds_read_b64_tr_b16 v[78:79], v10 offset:41984
    v_mfma_f32_16x16x32_bf16 a[28:31], v[140:143], v[132:135], a[28:31]
    ds_read_b64_tr_b16 v[52:53], v11 offset:32768
    v_mfma_f32_16x16x32_bf16 a[128:131], v[168:171], v[120:123], a[128:131]
    buffer_load_dwordx4 v3, s[92:95], s24 offen offset:2048 lds
    v_mfma_f32_16x16x32_bf16 a[132:135], v[168:171], v[124:127], a[132:135]
    ds_read_b64_tr_b16 v[54:55], v11 offset:33792
    v_mfma_f32_16x16x32_bf16 a[136:139], v[168:171], v[128:131], a[136:139]
    ds_read_b64_tr_b16 v[80:81], v11 offset:40960
    v_mfma_f32_16x16x32_bf16 a[140:143], v[168:171], v[132:135], a[140:143]
    ds_read_b64_tr_b16 v[82:83], v11 offset:41984
    v_mfma_f32_16x16x32_bf16 a[32:35], v[144:147], v[120:123], a[32:35]
    buffer_load_dwordx4 v4, s[92:95], s24 offen offset:3072 lds
    v_mfma_f32_16x16x32_bf16 a[36:39], v[144:147], v[124:127], a[36:39]
    ds_read_b64_tr_b16 v[56:57], v12 offset:32768
    v_mfma_f32_16x16x32_bf16 a[40:43], v[144:147], v[128:131], a[40:43]
    ds_read_b64_tr_b16 v[58:59], v12 offset:33792
    v_mfma_f32_16x16x32_bf16 a[44:47], v[144:147], v[132:135], a[44:47]
    ds_read_b64_tr_b16 v[84:85], v12 offset:40960
    v_mfma_f32_16x16x32_bf16 a[144:147], v[172:175], v[120:123], a[144:147]
    s_add_u32 m0, s28, 16640
    v_mfma_f32_16x16x32_bf16 a[148:151], v[172:175], v[124:127], a[148:151]
    ds_read_b64_tr_b16 v[86:87], v12 offset:41984
    v_mfma_f32_16x16x32_bf16 a[152:155], v[172:175], v[128:131], a[152:155]
    ds_read_b64_tr_b16 v[60:61], v13 offset:32768
    v_mfma_f32_16x16x32_bf16 a[156:159], v[172:175], v[132:135], a[156:159]
    ds_read_b64_tr_b16 v[62:63], v13 offset:33792
    v_mfma_f32_16x16x32_bf16 a[48:51], v[148:151], v[120:123], a[48:51]
    buffer_load_dwordx4 v5, s[12:15], s25 offen offset:0 lds
    v_mfma_f32_16x16x32_bf16 a[52:55], v[148:151], v[124:127], a[52:55]
    ds_read_b64_tr_b16 v[88:89], v13 offset:40960
    v_mfma_f32_16x16x32_bf16 a[56:59], v[148:151], v[128:131], a[56:59]
    ds_read_b64_tr_b16 v[90:91], v13 offset:41984
    v_mfma_f32_16x16x32_bf16 a[60:63], v[148:151], v[132:135], a[60:63]
    ds_read_b64_tr_b16 v[64:65], v14 offset:32768
    v_mfma_f32_16x16x32_bf16 a[160:163], v[176:179], v[120:123], a[160:163]
    buffer_load_dwordx4 v6, s[12:15], s25 offen offset:1024 lds
    v_mfma_f32_16x16x32_bf16 a[164:167], v[176:179], v[124:127], a[164:167]
    ds_read_b64_tr_b16 v[66:67], v14 offset:33792
    v_mfma_f32_16x16x32_bf16 a[168:171], v[176:179], v[128:131], a[168:171]
    ds_read_b64_tr_b16 v[92:93], v14 offset:40960
    v_mfma_f32_16x16x32_bf16 a[172:175], v[176:179], v[132:135], a[172:175]
    ds_read_b64_tr_b16 v[94:95], v14 offset:41984
    v_mfma_f32_16x16x32_bf16 a[64:67], v[152:155], v[120:123], a[64:67]
    s_add_u32 m0, s28, 24832
    v_mfma_f32_16x16x32_bf16 a[68:71], v[152:155], v[124:127], a[68:71]
    ds_read_b64_tr_b16 v[68:69], v15 offset:32768
    v_mfma_f32_16x16x32_bf16 a[72:75], v[152:155], v[128:131], a[72:75]
    ds_read_b64_tr_b16 v[70:71], v15 offset:33792
    v_mfma_f32_16x16x32_bf16 a[76:79], v[152:155], v[132:135], a[76:79]
    ds_read_b64_tr_b16 v[96:97], v15 offset:40960
    v_mfma_f32_16x16x32_bf16 a[176:179], v[180:183], v[120:123], a[176:179]
    buffer_load_dwordx4 v5, s[16:19], s25 offen offset:0 lds
    v_mfma_f32_16x16x32_bf16 a[180:183], v[180:183], v[124:127], a[180:183]
    ds_read_b64_tr_b16 v[98:99], v15 offset:41984
    v_mfma_f32_16x16x32_bf16 a[184:187], v[180:183], v[128:131], a[184:187]
    ds_read_b64_tr_b16 v[72:73], v16 offset:32768
    v_mfma_f32_16x16x32_bf16 a[188:191], v[180:183], v[132:135], a[188:191]
    ds_read_b64_tr_b16 v[74:75], v16 offset:33792
    v_mfma_f32_16x16x32_bf16 a[80:83], v[156:159], v[120:123], a[80:83]
    buffer_load_dwordx4 v6, s[16:19], s25 offen offset:1024 lds
    v_mfma_f32_16x16x32_bf16 a[84:87], v[156:159], v[124:127], a[84:87]
    ds_read_b64_tr_b16 v[100:101], v16 offset:40960
    v_mfma_f32_16x16x32_bf16 a[88:91], v[156:159], v[128:131], a[88:91]
    ds_read_b64_tr_b16 v[102:103], v16 offset:41984
    v_mfma_f32_16x16x32_bf16 a[92:95], v[156:159], v[132:135], a[92:95]
    ds_read_b128 v[104:107], v9 offset:8192
    v_mfma_f32_16x16x32_bf16 a[192:195], v[184:187], v[120:123], a[192:195]
    s_add_u32 m0, s29, 4352
    v_mfma_f32_16x16x32_bf16 a[196:199], v[184:187], v[124:127], a[196:199]
    ds_read_b128 v[108:111], v9 offset:9216
    v_mfma_f32_16x16x32_bf16 a[200:203], v[184:187], v[128:131], a[200:203]
    ds_read_b128 v[112:115], v9 offset:10240
    v_mfma_f32_16x16x32_bf16 a[204:207], v[184:187], v[132:135], a[204:207]
    ds_read_b128 v[116:119], v9 offset:11264
    v_mfma_f32_16x16x32_bf16 a[96:99], v[160:163], v[120:123], a[96:99]
    buffer_load_dwordx4 v7, s[20:23], s26 offen lds
    v_mfma_f32_16x16x32_bf16 a[100:103], v[160:163], v[124:127], a[100:103]
    v_mfma_f32_16x16x32_bf16 a[104:107], v[160:163], v[128:131], a[104:107]
    s_set_gpr_idx_on s59, gpr_idx(SRC0)
    v_mov_b64 v[240:241], v[136:137]
    v_mov_b64 v[242:243], v[138:139]
    s_set_gpr_idx_off
    v_mfma_f32_16x16x32_bf16 a[108:111], v[160:163], v[132:135], a[108:111]
    v_mfma_f32_16x16x32_bf16 a[208:211], v[188:191], v[120:123], a[208:211]
    s_add_u32 s24, s24, 4294951040
    v_mfma_f32_16x16x32_bf16 a[212:215], v[188:191], v[124:127], a[212:215]
    v_mfma_f32_16x16x32_bf16 a[216:219], v[188:191], v[128:131], a[216:219]
    v_mfma_f32_16x16x32_bf16 v[248:251], v[240:243], v[244:247], v[248:251]
    v_mfma_f32_16x16x32_bf16 a[220:223], v[188:191], v[132:135], a[220:223]
    v_mfma_f32_16x16x32_bf16 a[224:227], v[120:123], v[192:195], a[224:227]
    s_add_u32 s25, s25, 229376
    v_mfma_f32_16x16x32_bf16 a[240:243], v[124:127], v[192:195], a[240:243]
    v_mfma_f32_16x16x32_bf16 v[208:211], v[128:131], v[192:195], v[208:211]
    v_mfma_f32_16x16x32_bf16 v[224:227], v[132:135], v[192:195], v[224:227]
    v_mfma_f32_16x16x32_bf16 a[228:231], v[120:123], v[196:199], a[228:231]
    s_sub_u32 s26, s26, -64
    buffer_load_dword v21, v22, s[16:19], s97 offen
    v_mfma_f32_16x16x32_bf16 a[244:247], v[124:127], v[196:199], a[244:247]
    s_add_u32 s97, s97, 917504
    v_mfma_f32_16x16x32_bf16 v[212:215], v[128:131], v[196:199], v[212:215]
    v_mfma_f32_16x16x32_bf16 v[228:231], v[132:135], v[196:199], v[228:231]
    v_mfma_f32_16x16x32_bf16 a[232:235], v[120:123], v[200:203], a[232:235]
    v_mfma_f32_16x16x32_bf16 a[248:251], v[124:127], v[200:203], a[248:251]
    v_mfma_f32_16x16x32_bf16 v[216:219], v[128:131], v[200:203], v[216:219]
    buffer_store_dwordx4 v[24:27], v30, s[44:47], s58 offen sc1
    v_mfma_f32_16x16x32_bf16 v[232:235], v[132:135], v[200:203], v[232:235]
    s_add_u32 s58, s58, 512
    v_mfma_f32_16x16x32_bf16 a[236:239], v[120:123], v[204:207], a[236:239]
    v_mfma_f32_16x16x32_bf16 a[252:255], v[124:127], v[204:207], a[252:255]
    v_mfma_f32_16x16x32_bf16 v[220:223], v[128:131], v[204:207], v[220:223]
    v_mfma_f32_16x16x32_bf16 v[236:239], v[132:135], v[204:207], v[236:239]
    s_waitcnt vmcnt(23) lgkmcnt(0)
    s_barrier
    v_mfma_f32_16x16x32_bf16 a[0:3], v[48:51], v[32:35], a[0:3]
    s_add_u32 m0, s28, 33024
    v_mfma_f32_16x16x32_bf16 a[4:7], v[48:51], v[36:39], a[4:7]
    ds_read_b128 v[120:123], v20 offset:32768
    v_mfma_f32_16x16x32_bf16 a[8:11], v[48:51], v[40:43], a[8:11]
    ds_read_b128 v[124:127], v20 offset:34816
    v_mfma_f32_16x16x32_bf16 a[12:15], v[48:51], v[44:47], a[12:15]
    ds_read_b128 v[128:131], v20 offset:36864
    v_mfma_f32_16x16x32_bf16 a[112:115], v[76:79], v[32:35], a[112:115]
    buffer_load_dwordx4 v5, s[12:15], s25 offen offset:0 lds
    v_mfma_f32_16x16x32_bf16 a[116:119], v[76:79], v[36:39], a[116:119]
    ds_read_b128 v[132:135], v20 offset:38912
    v_mfma_f32_16x16x32_bf16 a[120:123], v[76:79], v[40:43], a[120:123]
    ds_read_b64_tr_b16 v[136:137], v10 offset:49152
    v_mfma_f32_16x16x32_bf16 a[124:127], v[76:79], v[44:47], a[124:127]
    ds_read_b64_tr_b16 v[138:139], v10 offset:50176
    v_mfma_f32_16x16x32_bf16 a[16:19], v[52:55], v[32:35], a[16:19]
    buffer_load_dwordx4 v6, s[12:15], s25 offen offset:1024 lds
    v_mfma_f32_16x16x32_bf16 a[20:23], v[52:55], v[36:39], a[20:23]
    ds_read_b64_tr_b16 v[164:165], v10 offset:57344
    v_mfma_f32_16x16x32_bf16 a[24:27], v[52:55], v[40:43], a[24:27]
    ds_read_b64_tr_b16 v[166:167], v10 offset:58368
    v_mfma_f32_16x16x32_bf16 a[28:31], v[52:55], v[44:47], a[28:31]
    ds_read_b64_tr_b16 v[140:141], v11 offset:49152
    v_mfma_f32_16x16x32_bf16 a[128:131], v[80:83], v[32:35], a[128:131]
    s_add_u32 m0, s28, 41216
    v_mfma_f32_16x16x32_bf16 a[132:135], v[80:83], v[36:39], a[132:135]
    ds_read_b64_tr_b16 v[142:143], v11 offset:50176
    v_mfma_f32_16x16x32_bf16 a[136:139], v[80:83], v[40:43], a[136:139]
    ds_read_b64_tr_b16 v[168:169], v11 offset:57344
    v_mfma_f32_16x16x32_bf16 a[140:143], v[80:83], v[44:47], a[140:143]
    ds_read_b64_tr_b16 v[170:171], v11 offset:58368
    v_mfma_f32_16x16x32_bf16 a[32:35], v[56:59], v[32:35], a[32:35]
    buffer_load_dwordx4 v5, s[16:19], s25 offen offset:0 lds
    v_mfma_f32_16x16x32_bf16 a[36:39], v[56:59], v[36:39], a[36:39]
    ds_read_b64_tr_b16 v[144:145], v12 offset:49152
    v_mfma_f32_16x16x32_bf16 a[40:43], v[56:59], v[40:43], a[40:43]
    ds_read_b64_tr_b16 v[146:147], v12 offset:50176
    v_mfma_f32_16x16x32_bf16 a[44:47], v[56:59], v[44:47], a[44:47]
    ds_read_b64_tr_b16 v[172:173], v12 offset:57344
    v_mfma_f32_16x16x32_bf16 a[144:147], v[84:87], v[32:35], a[144:147]
    buffer_load_dwordx4 v6, s[16:19], s25 offen offset:1024 lds
    v_mfma_f32_16x16x32_bf16 a[148:151], v[84:87], v[36:39], a[148:151]
    ds_read_b64_tr_b16 v[174:175], v12 offset:58368
    v_mfma_f32_16x16x32_bf16 a[152:155], v[84:87], v[40:43], a[152:155]
    ds_read_b64_tr_b16 v[148:149], v13 offset:49152
    v_mfma_f32_16x16x32_bf16 a[156:159], v[84:87], v[44:47], a[156:159]
    ds_read_b64_tr_b16 v[150:151], v13 offset:50176
    v_mfma_f32_16x16x32_bf16 a[48:51], v[60:63], v[32:35], a[48:51]
    s_add_u32 m0, s29, 8448
    v_mfma_f32_16x16x32_bf16 a[52:55], v[60:63], v[36:39], a[52:55]
    ds_read_b64_tr_b16 v[176:177], v13 offset:57344
    v_mfma_f32_16x16x32_bf16 a[56:59], v[60:63], v[40:43], a[56:59]
    ds_read_b64_tr_b16 v[178:179], v13 offset:58368
    v_mfma_f32_16x16x32_bf16 a[60:63], v[60:63], v[44:47], a[60:63]
    ds_read_b64_tr_b16 v[152:153], v14 offset:49152
    v_mfma_f32_16x16x32_bf16 a[160:163], v[88:91], v[32:35], a[160:163]
    buffer_load_dwordx4 v7, s[20:23], s26 offen lds
    v_mfma_f32_16x16x32_bf16 a[164:167], v[88:91], v[36:39], a[164:167]
    ds_read_b64_tr_b16 v[154:155], v14 offset:50176
    v_mfma_f32_16x16x32_bf16 a[168:171], v[88:91], v[40:43], a[168:171]
    s_waitcnt lgkmcnt(15)
    s_nop 0
    v_mfma_f32_16x16x32_bf16 a[172:175], v[88:91], v[44:47], a[172:175]
    ds_read_b64_tr_b16 v[180:181], v14 offset:57344
    v_mfma_f32_16x16x32_bf16 a[64:67], v[64:67], v[32:35], a[64:67]
    s_add_u32 m0, s27, 33024
    v_mfma_f32_16x16x32_bf16 a[68:71], v[64:67], v[36:39], a[68:71]
    ds_read_b64_tr_b16 v[182:183], v14 offset:58368
    v_mfma_f32_16x16x32_bf16 a[72:75], v[64:67], v[40:43], a[72:75]
    ds_read_b64_tr_b16 v[156:157], v15 offset:49152
    v_mfma_f32_16x16x32_bf16 a[76:79], v[64:67], v[44:47], a[76:79]
    ds_read_b64_tr_b16 v[158:159], v15 offset:50176
    v_mfma_f32_16x16x32_bf16 a[176:179], v[92:95], v[32:35], a[176:179]
    buffer_load_dwordx4 v1, s[92:95], s24 offen offset:0 lds
    v_mfma_f32_16x16x32_bf16 a[180:183], v[92:95], v[36:39], a[180:183]
    ds_read_b64_tr_b16 v[184:185], v15 offset:57344
    v_mfma_f32_16x16x32_bf16 a[184:187], v[92:95], v[40:43], a[184:187]
    ds_read_b64_tr_b16 v[186:187], v15 offset:58368
    v_mfma_f32_16x16x32_bf16 a[188:191], v[92:95], v[44:47], a[188:191]
    ds_read_b64_tr_b16 v[160:161], v16 offset:49152
    v_mfma_f32_16x16x32_bf16 a[80:83], v[68:71], v[32:35], a[80:83]
    buffer_load_dwordx4 v2, s[92:95], s24 offen offset:1024 lds
    v_mfma_f32_16x16x32_bf16 a[84:87], v[68:71], v[36:39], a[84:87]
    ds_read_b64_tr_b16 v[162:163], v16 offset:50176
    v_mfma_f32_16x16x32_bf16 a[88:91], v[68:71], v[40:43], a[88:91]
    ds_read_b64_tr_b16 v[188:189], v16 offset:57344
    v_mfma_f32_16x16x32_bf16 a[92:95], v[68:71], v[44:47], a[92:95]
    ds_read_b64_tr_b16 v[190:191], v16 offset:58368
    v_mfma_f32_16x16x32_bf16 a[192:195], v[96:99], v[32:35], a[192:195]
    buffer_load_dwordx4 v3, s[92:95], s24 offen offset:2048 lds
    v_mfma_f32_16x16x32_bf16 a[196:199], v[96:99], v[36:39], a[196:199]
    ds_read_b128 v[192:195], v9 offset:12288
    v_mfma_f32_16x16x32_bf16 a[200:203], v[96:99], v[40:43], a[200:203]
    ds_read_b128 v[196:199], v9 offset:13312
    v_mfma_f32_16x16x32_bf16 a[204:207], v[96:99], v[44:47], a[204:207]
    ds_read_b128 v[200:203], v9 offset:14336
    v_mfma_f32_16x16x32_bf16 a[96:99], v[72:75], v[32:35], a[96:99]
    buffer_load_dwordx4 v4, s[92:95], s24 offen offset:3072 lds
    v_mfma_f32_16x16x32_bf16 a[100:103], v[72:75], v[36:39], a[100:103]
    ds_read_b128 v[204:207], v9 offset:15360
    v_mfma_f32_16x16x32_bf16 a[104:107], v[72:75], v[40:43], a[104:107]
    s_set_gpr_idx_on s59, gpr_idx(SRC0)
    v_mov_b64 v[240:241], v[48:49]
    v_mov_b64 v[242:243], v[50:51]
    s_set_gpr_idx_off
    v_mfma_f32_16x16x32_bf16 a[108:111], v[72:75], v[44:47], a[108:111]
    v_mfma_f32_16x16x32_bf16 a[208:211], v[100:103], v[32:35], a[208:211]
    s_add_u32 s24, s24, 16384
    v_mfma_f32_16x16x32_bf16 a[212:215], v[100:103], v[36:39], a[212:215]
    v_mfma_f32_16x16x32_bf16 a[216:219], v[100:103], v[40:43], a[216:219]
    v_mfma_f32_16x16x32_bf16 v[248:251], v[240:243], v[244:247], v[248:251]
    v_mfma_f32_16x16x32_bf16 a[220:223], v[100:103], v[44:47], a[220:223]
    v_mfma_f32_16x16x32_bf16 a[224:227], v[32:35], v[104:107], a[224:227]
    s_add_u32 s25, s25, 229376
    v_mfma_f32_16x16x32_bf16 a[240:243], v[36:39], v[104:107], a[240:243]
    v_mfma_f32_16x16x32_bf16 v[208:211], v[40:43], v[104:107], v[208:211]
    v_mfma_f32_16x16x32_bf16 v[224:227], v[44:47], v[104:107], v[224:227]
    v_mfma_f32_16x16x32_bf16 a[228:231], v[32:35], v[108:111], a[228:231]
    s_sub_u32 s26, s26, -64
    buffer_load_dword v21, v23, s[20:23], s98 offen
    v_mfma_f32_16x16x32_bf16 a[244:247], v[36:39], v[108:111], a[244:247]
    s_add_u32 s98, s98, 256
    v_mfma_f32_16x16x32_bf16 v[212:215], v[40:43], v[108:111], v[212:215]
    v_mfma_f32_16x16x32_bf16 v[228:231], v[44:47], v[108:111], v[228:231]
    v_mfma_f32_16x16x32_bf16 a[232:235], v[32:35], v[112:115], a[232:235]
    v_mfma_f32_16x16x32_bf16 a[248:251], v[36:39], v[112:115], a[248:251]
    v_mfma_f32_16x16x32_bf16 v[216:219], v[40:43], v[112:115], v[216:219]
    buffer_store_dwordx4 v[24:27], v30, s[44:47], s58 offen sc1
    v_mfma_f32_16x16x32_bf16 v[232:235], v[44:47], v[112:115], v[232:235]
    s_add_u32 s58, s58, 512
    v_mfma_f32_16x16x32_bf16 a[236:239], v[32:35], v[116:119], a[236:239]
    v_mfma_f32_16x16x32_bf16 a[252:255], v[36:39], v[116:119], a[252:255]
    v_mfma_f32_16x16x32_bf16 v[220:223], v[40:43], v[116:119], v[220:223]
    v_mfma_f32_16x16x32_bf16 v[236:239], v[44:47], v[116:119], v[236:239]
    s_waitcnt vmcnt(18) lgkmcnt(0)
    s_barrier
    v_mfma_f32_16x16x32_bf16 a[0:3], v[136:139], v[120:123], a[0:3]
    s_add_u32 m0, s27, 37120
    v_mfma_f32_16x16x32_bf16 a[4:7], v[136:139], v[124:127], a[4:7]
    ds_read_b128 v[32:35], v8 offset:0
    v_mfma_f32_16x16x32_bf16 a[8:11], v[136:139], v[128:131], a[8:11]
    ds_read_b128 v[36:39], v8 offset:2048
    v_mfma_f32_16x16x32_bf16 a[12:15], v[136:139], v[132:135], a[12:15]
    ds_read_b128 v[40:43], v8 offset:4096
    v_mfma_f32_16x16x32_bf16 a[112:115], v[164:167], v[120:123], a[112:115]
    buffer_load_dwordx4 v1, s[92:95], s24 offen offset:0 lds
    v_mfma_f32_16x16x32_bf16 a[116:119], v[164:167], v[124:127], a[116:119]
    ds_read_b128 v[44:47], v8 offset:6144
    v_mfma_f32_16x16x32_bf16 a[120:123], v[164:167], v[128:131], a[120:123]
    ds_read_b64_tr_b16 v[48:49], v10 offset:0
    v_mfma_f32_16x16x32_bf16 a[124:127], v[164:167], v[132:135], a[124:127]
    ds_read_b64_tr_b16 v[50:51], v10 offset:1024
    v_mfma_f32_16x16x32_bf16 a[16:19], v[140:143], v[120:123], a[16:19]
    buffer_load_dwordx4 v2, s[92:95], s24 offen offset:1024 lds
    v_mfma_f32_16x16x32_bf16 a[20:23], v[140:143], v[124:127], a[20:23]
    ds_read_b64_tr_b16 v[76:77], v10 offset:8192
    v_mfma_f32_16x16x32_bf16 a[24:27], v[140:143], v[128:131], a[24:27]
    ds_read_b64_tr_b16 v[78:79], v10 offset:9216
    v_mfma_f32_16x16x32_bf16 a[28:31], v[140:143], v[132:135], a[28:31]
    ds_read_b64_tr_b16 v[52:53], v11 offset:0
    v_mfma_f32_16x16x32_bf16 a[128:131], v[168:171], v[120:123], a[128:131]
    buffer_load_dwordx4 v3, s[92:95], s24 offen offset:2048 lds
    v_mfma_f32_16x16x32_bf16 a[132:135], v[168:171], v[124:127], a[132:135]
    ds_read_b64_tr_b16 v[54:55], v11 offset:1024
    v_mfma_f32_16x16x32_bf16 a[136:139], v[168:171], v[128:131], a[136:139]
    ds_read_b64_tr_b16 v[80:81], v11 offset:8192
    v_mfma_f32_16x16x32_bf16 a[140:143], v[168:171], v[132:135], a[140:143]
    ds_read_b64_tr_b16 v[82:83], v11 offset:9216
    v_mfma_f32_16x16x32_bf16 a[32:35], v[144:147], v[120:123], a[32:35]
    buffer_load_dwordx4 v4, s[92:95], s24 offen offset:3072 lds
    v_mfma_f32_16x16x32_bf16 a[36:39], v[144:147], v[124:127], a[36:39]
    ds_read_b64_tr_b16 v[56:57], v12 offset:0
    v_mfma_f32_16x16x32_bf16 a[40:43], v[144:147], v[128:131], a[40:43]
    ds_read_b64_tr_b16 v[58:59], v12 offset:1024
    v_mfma_f32_16x16x32_bf16 a[44:47], v[144:147], v[132:135], a[44:47]
    ds_read_b64_tr_b16 v[84:85], v12 offset:8192
    v_mfma_f32_16x16x32_bf16 a[144:147], v[172:175], v[120:123], a[144:147]
    s_add_u32 m0, s28, 49408
    v_mfma_f32_16x16x32_bf16 a[148:151], v[172:175], v[124:127], a[148:151]
    ds_read_b64_tr_b16 v[86:87], v12 offset:9216
    v_mfma_f32_16x16x32_bf16 a[152:155], v[172:175], v[128:131], a[152:155]
    ds_read_b64_tr_b16 v[60:61], v13 offset:0
    v_mfma_f32_16x16x32_bf16 a[156:159], v[172:175], v[132:135], a[156:159]
    ds_read_b64_tr_b16 v[62:63], v13 offset:1024
    v_mfma_f32_16x16x32_bf16 a[48:51], v[148:151], v[120:123], a[48:51]
    buffer_load_dwordx4 v5, s[12:15], s25 offen offset:0 lds
    v_mfma_f32_16x16x32_bf16 a[52:55], v[148:151], v[124:127], a[52:55]
    ds_read_b64_tr_b16 v[88:89], v13 offset:8192
    v_mfma_f32_16x16x32_bf16 a[56:59], v[148:151], v[128:131], a[56:59]
    ds_read_b64_tr_b16 v[90:91], v13 offset:9216
    v_mfma_f32_16x16x32_bf16 a[60:63], v[148:151], v[132:135], a[60:63]
    ds_read_b64_tr_b16 v[64:65], v14 offset:0
    v_mfma_f32_16x16x32_bf16 a[160:163], v[176:179], v[120:123], a[160:163]
    buffer_load_dwordx4 v6, s[12:15], s25 offen offset:1024 lds
    v_mfma_f32_16x16x32_bf16 a[164:167], v[176:179], v[124:127], a[164:167]
    ds_read_b64_tr_b16 v[66:67], v14 offset:1024
    v_mfma_f32_16x16x32_bf16 a[168:171], v[176:179], v[128:131], a[168:171]
    buffer_store_byte v255, v254, s[60:63], s2 offen sc1
    v_mfma_f32_16x16x32_bf16 a[172:175], v[176:179], v[132:135], a[172:175]
    ds_read_b64_tr_b16 v[92:93], v14 offset:8192
    v_mfma_f32_16x16x32_bf16 a[64:67], v[152:155], v[120:123], a[64:67]
    s_add_u32 m0, s28, 57600
    v_mfma_f32_16x16x32_bf16 a[68:71], v[152:155], v[124:127], a[68:71]
    ds_read_b64_tr_b16 v[94:95], v14 offset:9216
    v_mfma_f32_16x16x32_bf16 a[72:75], v[152:155], v[128:131], a[72:75]
    ds_read_b64_tr_b16 v[68:69], v15 offset:0
    v_mfma_f32_16x16x32_bf16 a[76:79], v[152:155], v[132:135], a[76:79]
    ds_read_b64_tr_b16 v[70:71], v15 offset:1024
    v_mfma_f32_16x16x32_bf16 a[176:179], v[180:183], v[120:123], a[176:179]
    buffer_load_dwordx4 v5, s[16:19], s25 offen offset:0 lds
    v_mfma_f32_16x16x32_bf16 a[180:183], v[180:183], v[124:127], a[180:183]
    ds_read_b64_tr_b16 v[96:97], v15 offset:8192
    v_mfma_f32_16x16x32_bf16 a[184:187], v[180:183], v[128:131], a[184:187]
    ds_read_b64_tr_b16 v[98:99], v15 offset:9216
    v_mfma_f32_16x16x32_bf16 a[188:191], v[180:183], v[132:135], a[188:191]
    ds_read_b64_tr_b16 v[72:73], v16 offset:0
    v_mfma_f32_16x16x32_bf16 a[80:83], v[156:159], v[120:123], a[80:83]
    buffer_load_dwordx4 v6, s[16:19], s25 offen offset:1024 lds
    v_mfma_f32_16x16x32_bf16 a[84:87], v[156:159], v[124:127], a[84:87]
    ds_read_b64_tr_b16 v[74:75], v16 offset:1024
    v_mfma_f32_16x16x32_bf16 a[88:91], v[156:159], v[128:131], a[88:91]
    ds_read_b64_tr_b16 v[100:101], v16 offset:8192
    v_mfma_f32_16x16x32_bf16 a[92:95], v[156:159], v[132:135], a[92:95]
    ds_read_b64_tr_b16 v[102:103], v16 offset:9216
    v_mfma_f32_16x16x32_bf16 a[192:195], v[184:187], v[120:123], a[192:195]
    s_add_u32 m0, s29, 12544
    v_mfma_f32_16x16x32_bf16 a[196:199], v[184:187], v[124:127], a[196:199]
    ds_read_b128 v[104:107], v9 offset:0
    v_mfma_f32_16x16x32_bf16 a[200:203], v[184:187], v[128:131], a[200:203]
    ds_read_b128 v[108:111], v9 offset:1024
    v_mfma_f32_16x16x32_bf16 a[204:207], v[184:187], v[132:135], a[204:207]
    ds_read_b128 v[112:115], v9 offset:2048
    v_mfma_f32_16x16x32_bf16 a[96:99], v[160:163], v[120:123], a[96:99]
    buffer_load_dwordx4 v7, s[20:23], s26 offen lds
    v_mfma_f32_16x16x32_bf16 a[100:103], v[160:163], v[124:127], a[100:103]
    ds_read_b128 v[116:119], v9 offset:3072
    v_mfma_f32_16x16x32_bf16 a[104:107], v[160:163], v[128:131], a[104:107]
    s_set_gpr_idx_on s59, gpr_idx(SRC0)
    v_mov_b64 v[240:241], v[136:137]
    v_mov_b64 v[242:243], v[138:139]
    s_set_gpr_idx_off
    v_mfma_f32_16x16x32_bf16 a[108:111], v[160:163], v[132:135], a[108:111]
    v_mfma_f32_16x16x32_bf16 a[208:211], v[188:191], v[120:123], a[208:211]
    s_add_u32 s24, s24, 4294951040
    v_mfma_f32_16x16x32_bf16 a[212:215], v[188:191], v[124:127], a[212:215]
    v_mfma_f32_16x16x32_bf16 a[216:219], v[188:191], v[128:131], a[216:219]
    v_mfma_f32_16x16x32_bf16 v[248:251], v[240:243], v[244:247], v[248:251]
    v_mfma_f32_16x16x32_bf16 a[220:223], v[188:191], v[132:135], a[220:223]
    v_mfma_f32_16x16x32_bf16 a[224:227], v[120:123], v[192:195], a[224:227]
    s_add_u32 s25, s25, 229376
    v_mfma_f32_16x16x32_bf16 a[240:243], v[124:127], v[192:195], a[240:243]
    v_mfma_f32_16x16x32_bf16 v[208:211], v[128:131], v[192:195], v[208:211]
    v_mfma_f32_16x16x32_bf16 v[224:227], v[132:135], v[192:195], v[224:227]
    v_mfma_f32_16x16x32_bf16 a[228:231], v[120:123], v[196:199], a[228:231]
    s_sub_u32 s26, s26, -64
    buffer_load_dword v21, v28, s[92:95], s99 offen
    v_mfma_f32_16x16x32_bf16 a[244:247], v[124:127], v[196:199], a[244:247]
    s_add_u32 s99, s99, 256
    v_mfma_f32_16x16x32_bf16 v[212:215], v[128:131], v[196:199], v[212:215]
    v_mfma_f32_16x16x32_bf16 v[228:231], v[132:135], v[196:199], v[228:231]
    v_mfma_f32_16x16x32_bf16 a[232:235], v[120:123], v[200:203], a[232:235]
    v_mfma_f32_16x16x32_bf16 a[248:251], v[124:127], v[200:203], a[248:251]
    v_mfma_f32_16x16x32_bf16 v[216:219], v[128:131], v[200:203], v[216:219]
    buffer_store_dwordx4 v[24:27], v30, s[44:47], s58 offen sc1
    v_mfma_f32_16x16x32_bf16 v[232:235], v[132:135], v[200:203], v[232:235]
    s_add_u32 s58, s58, 512
    v_mfma_f32_16x16x32_bf16 a[236:239], v[120:123], v[204:207], a[236:239]
    v_mfma_f32_16x16x32_bf16 a[252:255], v[124:127], v[204:207], a[252:255]
    v_mfma_f32_16x16x32_bf16 v[220:223], v[128:131], v[204:207], v[220:223]
    v_mfma_f32_16x16x32_bf16 v[236:239], v[132:135], v[204:207], v[236:239]
    s_mov_b32 s30, 5
.p2align 6
L_k1_loop:
    s_waitcnt vmcnt(24) lgkmcnt(0)
    s_barrier
    v_mfma_f32_16x16x32_bf16 a[0:3], v[48:51], v[32:35], a[0:3]
    s_add_u32 m0, s28, 256
    v_mfma_f32_16x16x32_bf16 a[4:7], v[48:51], v[36:39], a[4:7]
    ds_read_b128 v[120:123], v20 offset:0
    v_mfma_f32_16x16x32_bf16 a[8:11], v[48:51], v[40:43], a[8:11]
    ds_read_b128 v[124:127], v20 offset:2048
    v_mfma_f32_16x16x32_bf16 a[12:15], v[48:51], v[44:47], a[12:15]
    ds_read_b128 v[128:131], v20 offset:4096
    v_mfma_f32_16x16x32_bf16 a[112:115], v[76:79], v[32:35], a[112:115]
    buffer_load_dwordx4 v5, s[12:15], s25 offen offset:0 lds
    v_mfma_f32_16x16x32_bf16 a[116:119], v[76:79], v[36:39], a[116:119]
    ds_read_b128 v[132:135], v20 offset:6144
    v_mfma_f32_16x16x32_bf16 a[120:123], v[76:79], v[40:43], a[120:123]
    ds_read_b64_tr_b16 v[136:137], v10 offset:16384
    v_mfma_f32_16x16x32_bf16 a[124:127], v[76:79], v[44:47], a[124:127]
    ds_read_b64_tr_b16 v[138:139], v10 offset:17408
    v_mfma_f32_16x16x32_bf16 a[16:19], v[52:55], v[32:35], a[16:19]
    buffer_load_dwordx4 v6, s[12:15], s25 offen offset:1024 lds
    v_mfma_f32_16x16x32_bf16 a[20:23], v[52:55], v[36:39], a[20:23]
    ds_read_b64_tr_b16 v[164:165], v10 offset:24576
    v_mfma_f32_16x16x32_bf16 a[24:27], v[52:55], v[40:43], a[24:27]
    ds_read_b64_tr_b16 v[166:167], v10 offset:25600
    v_mfma_f32_16x16x32_bf16 a[28:31], v[52:55], v[44:47], a[28:31]
    ds_read_b64_tr_b16 v[140:141], v11 offset:16384
    v_mfma_f32_16x16x32_bf16 a[128:131], v[80:83], v[32:35], a[128:131]
    s_add_u32 m0, s28, 8448
    v_mfma_f32_16x16x32_bf16 a[132:135], v[80:83], v[36:39], a[132:135]
    ds_read_b64_tr_b16 v[142:143], v11 offset:17408
    v_mfma_f32_16x16x32_bf16 a[136:139], v[80:83], v[40:43], a[136:139]
    ds_read_b64_tr_b16 v[168:169], v11 offset:24576
    v_mfma_f32_16x16x32_bf16 a[140:143], v[80:83], v[44:47], a[140:143]
    ds_read_b64_tr_b16 v[170:171], v11 offset:25600
    v_mfma_f32_16x16x32_bf16 a[32:35], v[56:59], v[32:35], a[32:35]
    buffer_load_dwordx4 v5, s[16:19], s25 offen offset:0 lds
    v_mfma_f32_16x16x32_bf16 a[36:39], v[56:59], v[36:39], a[36:39]
    ds_read_b64_tr_b16 v[144:145], v12 offset:16384
    v_mfma_f32_16x16x32_bf16 a[40:43], v[56:59], v[40:43], a[40:43]
    ds_read_b64_tr_b16 v[146:147], v12 offset:17408
    v_mfma_f32_16x16x32_bf16 a[44:47], v[56:59], v[44:47], a[44:47]
    ds_read_b64_tr_b16 v[172:173], v12 offset:24576
    v_mfma_f32_16x16x32_bf16 a[144:147], v[84:87], v[32:35], a[144:147]
    buffer_load_dwordx4 v6, s[16:19], s25 offen offset:1024 lds
    v_mfma_f32_16x16x32_bf16 a[148:151], v[84:87], v[36:39], a[148:151]
    ds_read_b64_tr_b16 v[174:175], v12 offset:25600
    v_mfma_f32_16x16x32_bf16 a[152:155], v[84:87], v[40:43], a[152:155]
    ds_read_b64_tr_b16 v[148:149], v13 offset:16384
    v_mfma_f32_16x16x32_bf16 a[156:159], v[84:87], v[44:47], a[156:159]
    ds_read_b64_tr_b16 v[150:151], v13 offset:17408
    v_mfma_f32_16x16x32_bf16 a[48:51], v[60:63], v[32:35], a[48:51]
    s_add_u32 m0, s29, 256
    v_mfma_f32_16x16x32_bf16 a[52:55], v[60:63], v[36:39], a[52:55]
    ds_read_b64_tr_b16 v[176:177], v13 offset:24576
    v_mfma_f32_16x16x32_bf16 a[56:59], v[60:63], v[40:43], a[56:59]
    ds_read_b64_tr_b16 v[178:179], v13 offset:25600
    v_mfma_f32_16x16x32_bf16 a[60:63], v[60:63], v[44:47], a[60:63]
    ds_read_b64_tr_b16 v[152:153], v14 offset:16384
    v_mfma_f32_16x16x32_bf16 a[160:163], v[88:91], v[32:35], a[160:163]
    buffer_load_dwordx4 v7, s[20:23], s26 offen lds
    v_mfma_f32_16x16x32_bf16 a[164:167], v[88:91], v[36:39], a[164:167]
    ds_read_b64_tr_b16 v[154:155], v14 offset:17408
    v_mfma_f32_16x16x32_bf16 a[168:171], v[88:91], v[40:43], a[168:171]
    s_waitcnt lgkmcnt(15)
    s_nop 0
    v_mfma_f32_16x16x32_bf16 a[172:175], v[88:91], v[44:47], a[172:175]
    ds_read_b64_tr_b16 v[180:181], v14 offset:24576
    v_mfma_f32_16x16x32_bf16 a[64:67], v[64:67], v[32:35], a[64:67]
    s_add_u32 m0, s27, 256
    v_mfma_f32_16x16x32_bf16 a[68:71], v[64:67], v[36:39], a[68:71]
    ds_read_b64_tr_b16 v[182:183], v14 offset:25600
    v_mfma_f32_16x16x32_bf16 a[72:75], v[64:67], v[40:43], a[72:75]
    ds_read_b64_tr_b16 v[156:157], v15 offset:16384
    v_mfma_f32_16x16x32_bf16 a[76:79], v[64:67], v[44:47], a[76:79]
    ds_read_b64_tr_b16 v[158:159], v15 offset:17408
    v_mfma_f32_16x16x32_bf16 a[176:179], v[92:95], v[32:35], a[176:179]
    buffer_load_dwordx4 v1, s[92:95], s24 offen offset:0 lds
    v_mfma_f32_16x16x32_bf16 a[180:183], v[92:95], v[36:39], a[180:183]
    ds_read_b64_tr_b16 v[184:185], v15 offset:24576
    v_mfma_f32_16x16x32_bf16 a[184:187], v[92:95], v[40:43], a[184:187]
    ds_read_b64_tr_b16 v[186:187], v15 offset:25600
    v_mfma_f32_16x16x32_bf16 a[188:191], v[92:95], v[44:47], a[188:191]
    ds_read_b64_tr_b16 v[160:161], v16 offset:16384
    v_mfma_f32_16x16x32_bf16 a[80:83], v[68:71], v[32:35], a[80:83]
    buffer_load_dwordx4 v2, s[92:95], s24 offen offset:1024 lds
    v_mfma_f32_16x16x32_bf16 a[84:87], v[68:71], v[36:39], a[84:87]
    ds_read_b64_tr_b16 v[162:163], v16 offset:17408
    v_mfma_f32_16x16x32_bf16 a[88:91], v[68:71], v[40:43], a[88:91]
    ds_read_b64_tr_b16 v[188:189], v16 offset:24576
    v_mfma_f32_16x16x32_bf16 a[92:95], v[68:71], v[44:47], a[92:95]
    ds_read_b64_tr_b16 v[190:191], v16 offset:25600
    v_mfma_f32_16x16x32_bf16 a[192:195], v[96:99], v[32:35], a[192:195]
    buffer_load_dwordx4 v3, s[92:95], s24 offen offset:2048 lds
    v_mfma_f32_16x16x32_bf16 a[196:199], v[96:99], v[36:39], a[196:199]
    ds_read_b128 v[192:195], v9 offset:4096
    v_mfma_f32_16x16x32_bf16 a[200:203], v[96:99], v[40:43], a[200:203]
    ds_read_b128 v[196:199], v9 offset:5120
    v_mfma_f32_16x16x32_bf16 a[204:207], v[96:99], v[44:47], a[204:207]
    ds_read_b128 v[200:203], v9 offset:6144
    v_mfma_f32_16x16x32_bf16 a[96:99], v[72:75], v[32:35], a[96:99]
    buffer_load_dwordx4 v4, s[92:95], s24 offen offset:3072 lds
    v_mfma_f32_16x16x32_bf16 a[100:103], v[72:75], v[36:39], a[100:103]
    ds_read_b128 v[204:207], v9 offset:7168
    v_mfma_f32_16x16x32_bf16 a[104:107], v[72:75], v[40:43], a[104:107]
    s_set_gpr_idx_on s59, gpr_idx(SRC0)
    v_mov_b64 v[240:241], v[48:49]
    v_mov_b64 v[242:243], v[50:51]
    s_set_gpr_idx_off
    v_mfma_f32_16x16x32_bf16 a[108:111], v[72:75], v[44:47], a[108:111]
    v_mfma_f32_16x16x32_bf16 a[208:211], v[100:103], v[32:35], a[208:211]
    s_add_u32 s24, s24, 16384
    v_mfma_f32_16x16x32_bf16 a[212:215], v[100:103], v[36:39], a[212:215]
    v_mfma_f32_16x16x32_bf16 a[216:219], v[100:103], v[40:43], a[216:219]
    v_mfma_f32_16x16x32_bf16 v[248:251], v[240:243], v[244:247], v[248:251]
    v_mfma_f32_16x16x32_bf16 a[220:223], v[100:103], v[44:47], a[220:223]
    v_mfma_f32_16x16x32_bf16 a[224:227], v[32:35], v[104:107], a[224:227]
    s_add_u32 s25, s25, 229376
    v_mfma_f32_16x16x32_bf16 a[240:243], v[36:39], v[104:107], a[240:243]
    v_mfma_f32_16x16x32_bf16 v[208:211], v[40:43], v[104:107], v[208:211]
    v_mfma_f32_16x16x32_bf16 v[224:227], v[44:47], v[104:107], v[224:227]
    v_mfma_f32_16x16x32_bf16 a[228:231], v[32:35], v[108:111], a[228:231]
    s_sub_u32 s26, s26, -64
    buffer_load_dword v21, v22, s[12:15], s97 offen
    v_mfma_f32_16x16x32_bf16 a[244:247], v[36:39], v[108:111], a[244:247]
    v_mfma_f32_16x16x32_bf16 v[212:215], v[40:43], v[108:111], v[212:215]
    v_mfma_f32_16x16x32_bf16 v[228:231], v[44:47], v[108:111], v[228:231]
    v_mfma_f32_16x16x32_bf16 a[232:235], v[32:35], v[112:115], a[232:235]
    v_mfma_f32_16x16x32_bf16 a[248:251], v[36:39], v[112:115], a[248:251]
    v_mfma_f32_16x16x32_bf16 v[216:219], v[40:43], v[112:115], v[216:219]
    buffer_store_dwordx4 v[24:27], v30, s[44:47], s58 offen sc1
    v_mfma_f32_16x16x32_bf16 v[232:235], v[44:47], v[112:115], v[232:235]
    s_add_u32 s58, s58, 512
    v_mfma_f32_16x16x32_bf16 a[236:239], v[32:35], v[116:119], a[236:239]
    v_mfma_f32_16x16x32_bf16 a[252:255], v[36:39], v[116:119], a[252:255]
    v_mfma_f32_16x16x32_bf16 v[220:223], v[40:43], v[116:119], v[220:223]
    v_mfma_f32_16x16x32_bf16 v[236:239], v[44:47], v[116:119], v[236:239]
    s_waitcnt vmcnt(18) lgkmcnt(0)
    s_barrier
    v_mfma_f32_16x16x32_bf16 a[0:3], v[136:139], v[120:123], a[0:3]
    s_add_u32 m0, s27, 4352
    v_mfma_f32_16x16x32_bf16 a[4:7], v[136:139], v[124:127], a[4:7]
    ds_read_b128 v[32:35], v8 offset:32768
    v_mfma_f32_16x16x32_bf16 a[8:11], v[136:139], v[128:131], a[8:11]
    ds_read_b128 v[36:39], v8 offset:34816
    v_mfma_f32_16x16x32_bf16 a[12:15], v[136:139], v[132:135], a[12:15]
    ds_read_b128 v[40:43], v8 offset:36864
    v_mfma_f32_16x16x32_bf16 a[112:115], v[164:167], v[120:123], a[112:115]
    buffer_load_dwordx4 v1, s[92:95], s24 offen offset:0 lds
    v_mfma_f32_16x16x32_bf16 a[116:119], v[164:167], v[124:127], a[116:119]
    ds_read_b128 v[44:47], v8 offset:38912
    v_mfma_f32_16x16x32_bf16 a[120:123], v[164:167], v[128:131], a[120:123]
    ds_read_b64_tr_b16 v[48:49], v10 offset:32768
    v_mfma_f32_16x16x32_bf16 a[124:127], v[164:167], v[132:135], a[124:127]
    ds_read_b64_tr_b16 v[50:51], v10 offset:33792
    v_mfma_f32_16x16x32_bf16 a[16:19], v[140:143], v[120:123], a[16:19]
    buffer_load_dwordx4 v2, s[92:95], s24 offen offset:1024 lds
    v_mfma_f32_16x16x32_bf16 a[20:23], v[140:143], v[124:127], a[20:23]
    ds_read_b64_tr_b16 v[76:77], v10 offset:40960
    v_mfma_f32_16x16x32_bf16 a[24:27], v[140:143], v[128:131], a[24:27]
    ds_read_b64_tr_b16 v[78:79], v10 offset:41984
    v_mfma_f32_16x16x32_bf16 a[28:31], v[140:143], v[132:135], a[28:31]
    ds_read_b64_tr_b16 v[52:53], v11 offset:32768
    v_mfma_f32_16x16x32_bf16 a[128:131], v[168:171], v[120:123], a[128:131]
    buffer_load_dwordx4 v3, s[92:95], s24 offen offset:2048 lds
    v_mfma_f32_16x16x32_bf16 a[132:135], v[168:171], v[124:127], a[132:135]
    ds_read_b64_tr_b16 v[54:55], v11 offset:33792
    v_mfma_f32_16x16x32_bf16 a[136:139], v[168:171], v[128:131], a[136:139]
    ds_read_b64_tr_b16 v[80:81], v11 offset:40960
    v_mfma_f32_16x16x32_bf16 a[140:143], v[168:171], v[132:135], a[140:143]
    ds_read_b64_tr_b16 v[82:83], v11 offset:41984
    v_mfma_f32_16x16x32_bf16 a[32:35], v[144:147], v[120:123], a[32:35]
    buffer_load_dwordx4 v4, s[92:95], s24 offen offset:3072 lds
    v_mfma_f32_16x16x32_bf16 a[36:39], v[144:147], v[124:127], a[36:39]
    ds_read_b64_tr_b16 v[56:57], v12 offset:32768
    v_mfma_f32_16x16x32_bf16 a[40:43], v[144:147], v[128:131], a[40:43]
    ds_read_b64_tr_b16 v[58:59], v12 offset:33792
    v_mfma_f32_16x16x32_bf16 a[44:47], v[144:147], v[132:135], a[44:47]
    ds_read_b64_tr_b16 v[84:85], v12 offset:40960
    v_mfma_f32_16x16x32_bf16 a[144:147], v[172:175], v[120:123], a[144:147]
    s_add_u32 m0, s28, 16640
    v_mfma_f32_16x16x32_bf16 a[148:151], v[172:175], v[124:127], a[148:151]
    ds_read_b64_tr_b16 v[86:87], v12 offset:41984
    v_mfma_f32_16x16x32_bf16 a[152:155], v[172:175], v[128:131], a[152:155]
    ds_read_b64_tr_b16 v[60:61], v13 offset:32768
    v_mfma_f32_16x16x32_bf16 a[156:159], v[172:175], v[132:135], a[156:159]
    ds_read_b64_tr_b16 v[62:63], v13 offset:33792
    v_mfma_f32_16x16x32_bf16 a[48:51], v[148:151], v[120:123], a[48:51]
    buffer_load_dwordx4 v5, s[12:15], s25 offen offset:0 lds
    v_mfma_f32_16x16x32_bf16 a[52:55], v[148:151], v[124:127], a[52:55]
    ds_read_b64_tr_b16 v[88:89], v13 offset:40960
    v_mfma_f32_16x16x32_bf16 a[56:59], v[148:151], v[128:131], a[56:59]
    ds_read_b64_tr_b16 v[90:91], v13 offset:41984
    v_mfma_f32_16x16x32_bf16 a[60:63], v[148:151], v[132:135], a[60:63]
    ds_read_b64_tr_b16 v[64:65], v14 offset:32768
    v_mfma_f32_16x16x32_bf16 a[160:163], v[176:179], v[120:123], a[160:163]
    buffer_load_dwordx4 v6, s[12:15], s25 offen offset:1024 lds
    v_mfma_f32_16x16x32_bf16 a[164:167], v[176:179], v[124:127], a[164:167]
    ds_read_b64_tr_b16 v[66:67], v14 offset:33792
    v_mfma_f32_16x16x32_bf16 a[168:171], v[176:179], v[128:131], a[168:171]
    ds_read_b64_tr_b16 v[92:93], v14 offset:40960
    v_mfma_f32_16x16x32_bf16 a[172:175], v[176:179], v[132:135], a[172:175]
    ds_read_b64_tr_b16 v[94:95], v14 offset:41984
    v_mfma_f32_16x16x32_bf16 a[64:67], v[152:155], v[120:123], a[64:67]
    s_add_u32 m0, s28, 24832
    v_mfma_f32_16x16x32_bf16 a[68:71], v[152:155], v[124:127], a[68:71]
    ds_read_b64_tr_b16 v[68:69], v15 offset:32768
    v_mfma_f32_16x16x32_bf16 a[72:75], v[152:155], v[128:131], a[72:75]
    ds_read_b64_tr_b16 v[70:71], v15 offset:33792
    v_mfma_f32_16x16x32_bf16 a[76:79], v[152:155], v[132:135], a[76:79]
    ds_read_b64_tr_b16 v[96:97], v15 offset:40960
    v_mfma_f32_16x16x32_bf16 a[176:179], v[180:183], v[120:123], a[176:179]
    buffer_load_dwordx4 v5, s[16:19], s25 offen offset:0 lds
    v_mfma_f32_16x16x32_bf16 a[180:183], v[180:183], v[124:127], a[180:183]
    ds_read_b64_tr_b16 v[98:99], v15 offset:41984
    v_mfma_f32_16x16x32_bf16 a[184:187], v[180:183], v[128:131], a[184:187]
    ds_read_b64_tr_b16 v[72:73], v16 offset:32768
    v_mfma_f32_16x16x32_bf16 a[188:191], v[180:183], v[132:135], a[188:191]
    ds_read_b64_tr_b16 v[74:75], v16 offset:33792
    v_mfma_f32_16x16x32_bf16 a[80:83], v[156:159], v[120:123], a[80:83]
    buffer_load_dwordx4 v6, s[16:19], s25 offen offset:1024 lds
    v_mfma_f32_16x16x32_bf16 a[84:87], v[156:159], v[124:127], a[84:87]
    ds_read_b64_tr_b16 v[100:101], v16 offset:40960
    v_mfma_f32_16x16x32_bf16 a[88:91], v[156:159], v[128:131], a[88:91]
    ds_read_b64_tr_b16 v[102:103], v16 offset:41984
    v_mfma_f32_16x16x32_bf16 a[92:95], v[156:159], v[132:135], a[92:95]
    ds_read_b128 v[104:107], v9 offset:8192
    v_mfma_f32_16x16x32_bf16 a[192:195], v[184:187], v[120:123], a[192:195]
    s_add_u32 m0, s29, 4352
    v_mfma_f32_16x16x32_bf16 a[196:199], v[184:187], v[124:127], a[196:199]
    ds_read_b128 v[108:111], v9 offset:9216
    v_mfma_f32_16x16x32_bf16 a[200:203], v[184:187], v[128:131], a[200:203]
    ds_read_b128 v[112:115], v9 offset:10240
    v_mfma_f32_16x16x32_bf16 a[204:207], v[184:187], v[132:135], a[204:207]
    ds_read_b128 v[116:119], v9 offset:11264
    v_mfma_f32_16x16x32_bf16 a[96:99], v[160:163], v[120:123], a[96:99]
    buffer_load_dwordx4 v7, s[20:23], s26 offen lds
    v_mfma_f32_16x16x32_bf16 a[100:103], v[160:163], v[124:127], a[100:103]
    v_mfma_f32_16x16x32_bf16 a[104:107], v[160:163], v[128:131], a[104:107]
    s_set_gpr_idx_on s59, gpr_idx(SRC0)
    v_mov_b64 v[240:241], v[136:137]
    v_mov_b64 v[242:243], v[138:139]
    s_set_gpr_idx_off
    v_mfma_f32_16x16x32_bf16 a[108:111], v[160:163], v[132:135], a[108:111]
    v_mfma_f32_16x16x32_bf16 a[208:211], v[188:191], v[120:123], a[208:211]
    s_add_u32 s24, s24, 4294951040
    v_mfma_f32_16x16x32_bf16 a[212:215], v[188:191], v[124:127], a[212:215]
    v_mfma_f32_16x16x32_bf16 a[216:219], v[188:191], v[128:131], a[216:219]
    v_mfma_f32_16x16x32_bf16 v[248:251], v[240:243], v[244:247], v[248:251]
    v_mfma_f32_16x16x32_bf16 a[220:223], v[188:191], v[132:135], a[220:223]
    v_mfma_f32_16x16x32_bf16 a[224:227], v[120:123], v[192:195], a[224:227]
    s_add_u32 s25, s25, 229376
    v_mfma_f32_16x16x32_bf16 a[240:243], v[124:127], v[192:195], a[240:243]
    v_mfma_f32_16x16x32_bf16 v[208:211], v[128:131], v[192:195], v[208:211]
    v_mfma_f32_16x16x32_bf16 v[224:227], v[132:135], v[192:195], v[224:227]
    v_mfma_f32_16x16x32_bf16 a[228:231], v[120:123], v[196:199], a[228:231]
    s_sub_u32 s26, s26, -64
    buffer_load_dword v21, v22, s[16:19], s97 offen
    v_mfma_f32_16x16x32_bf16 a[244:247], v[124:127], v[196:199], a[244:247]
    s_add_u32 s97, s97, 917504
    v_mfma_f32_16x16x32_bf16 v[212:215], v[128:131], v[196:199], v[212:215]
    v_mfma_f32_16x16x32_bf16 v[228:231], v[132:135], v[196:199], v[228:231]
    v_mfma_f32_16x16x32_bf16 a[232:235], v[120:123], v[200:203], a[232:235]
    v_mfma_f32_16x16x32_bf16 a[248:251], v[124:127], v[200:203], a[248:251]
    v_mfma_f32_16x16x32_bf16 v[216:219], v[128:131], v[200:203], v[216:219]
    buffer_store_dwordx4 v[24:27], v30, s[44:47], s58 offen sc1
    v_mfma_f32_16x16x32_bf16 v[232:235], v[132:135], v[200:203], v[232:235]
    s_add_u32 s58, s58, 512
    v_mfma_f32_16x16x32_bf16 a[236:239], v[120:123], v[204:207], a[236:239]
    v_mfma_f32_16x16x32_bf16 a[252:255], v[124:127], v[204:207], a[252:255]
    v_mfma_f32_16x16x32_bf16 v[220:223], v[128:131], v[204:207], v[220:223]
    v_mfma_f32_16x16x32_bf16 v[236:239], v[132:135], v[204:207], v[236:239]
    s_waitcnt vmcnt(24) lgkmcnt(0)
    s_barrier
    v_mfma_f32_16x16x32_bf16 a[0:3], v[48:51], v[32:35], a[0:3]
    s_add_u32 m0, s28, 33024
    v_mfma_f32_16x16x32_bf16 a[4:7], v[48:51], v[36:39], a[4:7]
    ds_read_b128 v[120:123], v20 offset:32768
    v_mfma_f32_16x16x32_bf16 a[8:11], v[48:51], v[40:43], a[8:11]
    ds_read_b128 v[124:127], v20 offset:34816
    v_mfma_f32_16x16x32_bf16 a[12:15], v[48:51], v[44:47], a[12:15]
    ds_read_b128 v[128:131], v20 offset:36864
    v_mfma_f32_16x16x32_bf16 a[112:115], v[76:79], v[32:35], a[112:115]
    buffer_load_dwordx4 v5, s[12:15], s25 offen offset:0 lds
    v_mfma_f32_16x16x32_bf16 a[116:119], v[76:79], v[36:39], a[116:119]
    ds_read_b128 v[132:135], v20 offset:38912
    v_mfma_f32_16x16x32_bf16 a[120:123], v[76:79], v[40:43], a[120:123]
    ds_read_b64_tr_b16 v[136:137], v10 offset:49152
    v_mfma_f32_16x16x32_bf16 a[124:127], v[76:79], v[44:47], a[124:127]
    ds_read_b64_tr_b16 v[138:139], v10 offset:50176
    v_mfma_f32_16x16x32_bf16 a[16:19], v[52:55], v[32:35], a[16:19]
    buffer_load_dwordx4 v6, s[12:15], s25 offen offset:1024 lds
    v_mfma_f32_16x16x32_bf16 a[20:23], v[52:55], v[36:39], a[20:23]
    ds_read_b64_tr_b16 v[164:165], v10 offset:57344
    v_mfma_f32_16x16x32_bf16 a[24:27], v[52:55], v[40:43], a[24:27]
    ds_read_b64_tr_b16 v[166:167], v10 offset:58368
    v_mfma_f32_16x16x32_bf16 a[28:31], v[52:55], v[44:47], a[28:31]
    ds_read_b64_tr_b16 v[140:141], v11 offset:49152
    v_mfma_f32_16x16x32_bf16 a[128:131], v[80:83], v[32:35], a[128:131]
    s_add_u32 m0, s28, 41216
    v_mfma_f32_16x16x32_bf16 a[132:135], v[80:83], v[36:39], a[132:135]
    ds_read_b64_tr_b16 v[142:143], v11 offset:50176
    v_mfma_f32_16x16x32_bf16 a[136:139], v[80:83], v[40:43], a[136:139]
    ds_read_b64_tr_b16 v[168:169], v11 offset:57344
    v_mfma_f32_16x16x32_bf16 a[140:143], v[80:83], v[44:47], a[140:143]
    ds_read_b64_tr_b16 v[170:171], v11 offset:58368
    v_mfma_f32_16x16x32_bf16 a[32:35], v[56:59], v[32:35], a[32:35]
    buffer_load_dwordx4 v5, s[16:19], s25 offen offset:0 lds
    v_mfma_f32_16x16x32_bf16 a[36:39], v[56:59], v[36:39], a[36:39]
    ds_read_b64_tr_b16 v[144:145], v12 offset:49152
    v_mfma_f32_16x16x32_bf16 a[40:43], v[56:59], v[40:43], a[40:43]
    ds_read_b64_tr_b16 v[146:147], v12 offset:50176
    v_mfma_f32_16x16x32_bf16 a[44:47], v[56:59], v[44:47], a[44:47]
    ds_read_b64_tr_b16 v[172:173], v12 offset:57344
    v_mfma_f32_16x16x32_bf16 a[144:147], v[84:87], v[32:35], a[144:147]
    buffer_load_dwordx4 v6, s[16:19], s25 offen offset:1024 lds
    v_mfma_f32_16x16x32_bf16 a[148:151], v[84:87], v[36:39], a[148:151]
    ds_read_b64_tr_b16 v[174:175], v12 offset:58368
    v_mfma_f32_16x16x32_bf16 a[152:155], v[84:87], v[40:43], a[152:155]
    ds_read_b64_tr_b16 v[148:149], v13 offset:49152
    v_mfma_f32_16x16x32_bf16 a[156:159], v[84:87], v[44:47], a[156:159]
    ds_read_b64_tr_b16 v[150:151], v13 offset:50176
    v_mfma_f32_16x16x32_bf16 a[48:51], v[60:63], v[32:35], a[48:51]
    s_add_u32 m0, s29, 8448
    v_mfma_f32_16x16x32_bf16 a[52:55], v[60:63], v[36:39], a[52:55]
    ds_read_b64_tr_b16 v[176:177], v13 offset:57344
    v_mfma_f32_16x16x32_bf16 a[56:59], v[60:63], v[40:43], a[56:59]
    ds_read_b64_tr_b16 v[178:179], v13 offset:58368
    v_mfma_f32_16x16x32_bf16 a[60:63], v[60:63], v[44:47], a[60:63]
    ds_read_b64_tr_b16 v[152:153], v14 offset:49152
    v_mfma_f32_16x16x32_bf16 a[160:163], v[88:91], v[32:35], a[160:163]
    buffer_load_dwordx4 v7, s[20:23], s26 offen lds
    v_mfma_f32_16x16x32_bf16 a[164:167], v[88:91], v[36:39], a[164:167]
    ds_read_b64_tr_b16 v[154:155], v14 offset:50176
    v_mfma_f32_16x16x32_bf16 a[168:171], v[88:91], v[40:43], a[168:171]
    s_waitcnt lgkmcnt(15)
    s_nop 0
    v_mfma_f32_16x16x32_bf16 a[172:175], v[88:91], v[44:47], a[172:175]
    ds_read_b64_tr_b16 v[180:181], v14 offset:57344
    v_mfma_f32_16x16x32_bf16 a[64:67], v[64:67], v[32:35], a[64:67]
    s_add_u32 m0, s27, 33024
    v_mfma_f32_16x16x32_bf16 a[68:71], v[64:67], v[36:39], a[68:71]
    ds_read_b64_tr_b16 v[182:183], v14 offset:58368
    v_mfma_f32_16x16x32_bf16 a[72:75], v[64:67], v[40:43], a[72:75]
    ds_read_b64_tr_b16 v[156:157], v15 offset:49152
    v_mfma_f32_16x16x32_bf16 a[76:79], v[64:67], v[44:47], a[76:79]
    ds_read_b64_tr_b16 v[158:159], v15 offset:50176
    v_mfma_f32_16x16x32_bf16 a[176:179], v[92:95], v[32:35], a[176:179]
    buffer_load_dwordx4 v1, s[92:95], s24 offen offset:0 lds
    v_mfma_f32_16x16x32_bf16 a[180:183], v[92:95], v[36:39], a[180:183]
    ds_read_b64_tr_b16 v[184:185], v15 offset:57344
    v_mfma_f32_16x16x32_bf16 a[184:187], v[92:95], v[40:43], a[184:187]
    ds_read_b64_tr_b16 v[186:187], v15 offset:58368
    v_mfma_f32_16x16x32_bf16 a[188:191], v[92:95], v[44:47], a[188:191]
    ds_read_b64_tr_b16 v[160:161], v16 offset:49152
    v_mfma_f32_16x16x32_bf16 a[80:83], v[68:71], v[32:35], a[80:83]
    buffer_load_dwordx4 v2, s[92:95], s24 offen offset:1024 lds
    v_mfma_f32_16x16x32_bf16 a[84:87], v[68:71], v[36:39], a[84:87]
    ds_read_b64_tr_b16 v[162:163], v16 offset:50176
    v_mfma_f32_16x16x32_bf16 a[88:91], v[68:71], v[40:43], a[88:91]
    ds_read_b64_tr_b16 v[188:189], v16 offset:57344
    v_mfma_f32_16x16x32_bf16 a[92:95], v[68:71], v[44:47], a[92:95]
    ds_read_b64_tr_b16 v[190:191], v16 offset:58368
    v_mfma_f32_16x16x32_bf16 a[192:195], v[96:99], v[32:35], a[192:195]
    buffer_load_dwordx4 v3, s[92:95], s24 offen offset:2048 lds
    v_mfma_f32_16x16x32_bf16 a[196:199], v[96:99], v[36:39], a[196:199]
    ds_read_b128 v[192:195], v9 offset:12288
    v_mfma_f32_16x16x32_bf16 a[200:203], v[96:99], v[40:43], a[200:203]
    ds_read_b128 v[196:199], v9 offset:13312
    v_mfma_f32_16x16x32_bf16 a[204:207], v[96:99], v[44:47], a[204:207]
    ds_read_b128 v[200:203], v9 offset:14336
    v_mfma_f32_16x16x32_bf16 a[96:99], v[72:75], v[32:35], a[96:99]
    buffer_load_dwordx4 v4, s[92:95], s24 offen offset:3072 lds
    v_mfma_f32_16x16x32_bf16 a[100:103], v[72:75], v[36:39], a[100:103]
    ds_read_b128 v[204:207], v9 offset:15360
    v_mfma_f32_16x16x32_bf16 a[104:107], v[72:75], v[40:43], a[104:107]
    s_set_gpr_idx_on s59, gpr_idx(SRC0)
    v_mov_b64 v[240:241], v[48:49]
    v_mov_b64 v[242:243], v[50:51]
    s_set_gpr_idx_off
    v_mfma_f32_16x16x32_bf16 a[108:111], v[72:75], v[44:47], a[108:111]
    v_mfma_f32_16x16x32_bf16 a[208:211], v[100:103], v[32:35], a[208:211]
    s_add_u32 s24, s24, 16384
    v_mfma_f32_16x16x32_bf16 a[212:215], v[100:103], v[36:39], a[212:215]
    v_mfma_f32_16x16x32_bf16 a[216:219], v[100:103], v[40:43], a[216:219]
    v_mfma_f32_16x16x32_bf16 v[248:251], v[240:243], v[244:247], v[248:251]
    v_mfma_f32_16x16x32_bf16 a[220:223], v[100:103], v[44:47], a[220:223]
    v_mfma_f32_16x16x32_bf16 a[224:227], v[32:35], v[104:107], a[224:227]
    s_add_u32 s25, s25, 229376
    v_mfma_f32_16x16x32_bf16 a[240:243], v[36:39], v[104:107], a[240:243]
    v_mfma_f32_16x16x32_bf16 v[208:211], v[40:43], v[104:107], v[208:211]
    v_mfma_f32_16x16x32_bf16 v[224:227], v[44:47], v[104:107], v[224:227]
    v_mfma_f32_16x16x32_bf16 a[228:231], v[32:35], v[108:111], a[228:231]
    s_sub_u32 s26, s26, -64
    buffer_load_dword v21, v23, s[20:23], s98 offen
    v_mfma_f32_16x16x32_bf16 a[244:247], v[36:39], v[108:111], a[244:247]
    s_add_u32 s98, s98, 256
    v_mfma_f32_16x16x32_bf16 v[212:215], v[40:43], v[108:111], v[212:215]
    v_mfma_f32_16x16x32_bf16 v[228:231], v[44:47], v[108:111], v[228:231]
    v_mfma_f32_16x16x32_bf16 a[232:235], v[32:35], v[112:115], a[232:235]
    v_mfma_f32_16x16x32_bf16 a[248:251], v[36:39], v[112:115], a[248:251]
    v_mfma_f32_16x16x32_bf16 v[216:219], v[40:43], v[112:115], v[216:219]
    buffer_store_dwordx4 v[24:27], v30, s[44:47], s58 offen sc1
    v_mfma_f32_16x16x32_bf16 v[232:235], v[44:47], v[112:115], v[232:235]
    s_add_u32 s58, s58, 512
    v_mfma_f32_16x16x32_bf16 a[236:239], v[32:35], v[116:119], a[236:239]
    v_mfma_f32_16x16x32_bf16 a[252:255], v[36:39], v[116:119], a[252:255]
    v_mfma_f32_16x16x32_bf16 v[220:223], v[40:43], v[116:119], v[220:223]
    v_mfma_f32_16x16x32_bf16 v[236:239], v[44:47], v[116:119], v[236:239]
    s_waitcnt vmcnt(18) lgkmcnt(0)
    s_barrier
    v_mfma_f32_16x16x32_bf16 a[0:3], v[136:139], v[120:123], a[0:3]
    s_add_u32 m0, s27, 37120
    v_mfma_f32_16x16x32_bf16 a[4:7], v[136:139], v[124:127], a[4:7]
    ds_read_b128 v[32:35], v8 offset:0
    v_mfma_f32_16x16x32_bf16 a[8:11], v[136:139], v[128:131], a[8:11]
    ds_read_b128 v[36:39], v8 offset:2048
    v_mfma_f32_16x16x32_bf16 a[12:15], v[136:139], v[132:135], a[12:15]
    ds_read_b128 v[40:43], v8 offset:4096
    v_mfma_f32_16x16x32_bf16 a[112:115], v[164:167], v[120:123], a[112:115]
    buffer_load_dwordx4 v1, s[92:95], s24 offen offset:0 lds
    v_mfma_f32_16x16x32_bf16 a[116:119], v[164:167], v[124:127], a[116:119]
    ds_read_b128 v[44:47], v8 offset:6144
    v_mfma_f32_16x16x32_bf16 a[120:123], v[164:167], v[128:131], a[120:123]
    ds_read_b64_tr_b16 v[48:49], v10 offset:0
    v_mfma_f32_16x16x32_bf16 a[124:127], v[164:167], v[132:135], a[124:127]
    ds_read_b64_tr_b16 v[50:51], v10 offset:1024
    v_mfma_f32_16x16x32_bf16 a[16:19], v[140:143], v[120:123], a[16:19]
    buffer_load_dwordx4 v2, s[92:95], s24 offen offset:1024 lds
    v_mfma_f32_16x16x32_bf16 a[20:23], v[140:143], v[124:127], a[20:23]
    ds_read_b64_tr_b16 v[76:77], v10 offset:8192
    v_mfma_f32_16x16x32_bf16 a[24:27], v[140:143], v[128:131], a[24:27]
    ds_read_b64_tr_b16 v[78:79], v10 offset:9216
    v_mfma_f32_16x16x32_bf16 a[28:31], v[140:143], v[132:135], a[28:31]
    ds_read_b64_tr_b16 v[52:53], v11 offset:0
    v_mfma_f32_16x16x32_bf16 a[128:131], v[168:171], v[120:123], a[128:131]
    buffer_load_dwordx4 v3, s[92:95], s24 offen offset:2048 lds
    v_mfma_f32_16x16x32_bf16 a[132:135], v[168:171], v[124:127], a[132:135]
    ds_read_b64_tr_b16 v[54:55], v11 offset:1024
    v_mfma_f32_16x16x32_bf16 a[136:139], v[168:171], v[128:131], a[136:139]
    ds_read_b64_tr_b16 v[80:81], v11 offset:8192
    v_mfma_f32_16x16x32_bf16 a[140:143], v[168:171], v[132:135], a[140:143]
    ds_read_b64_tr_b16 v[82:83], v11 offset:9216
    v_mfma_f32_16x16x32_bf16 a[32:35], v[144:147], v[120:123], a[32:35]
    buffer_load_dwordx4 v4, s[92:95], s24 offen offset:3072 lds
    v_mfma_f32_16x16x32_bf16 a[36:39], v[144:147], v[124:127], a[36:39]
    ds_read_b64_tr_b16 v[56:57], v12 offset:0
    v_mfma_f32_16x16x32_bf16 a[40:43], v[144:147], v[128:131], a[40:43]
    ds_read_b64_tr_b16 v[58:59], v12 offset:1024
    v_mfma_f32_16x16x32_bf16 a[44:47], v[144:147], v[132:135], a[44:47]
    ds_read_b64_tr_b16 v[84:85], v12 offset:8192
    v_mfma_f32_16x16x32_bf16 a[144:147], v[172:175], v[120:123], a[144:147]
    s_add_u32 m0, s28, 49408
    v_mfma_f32_16x16x32_bf16 a[148:151], v[172:175], v[124:127], a[148:151]
    ds_read_b64_tr_b16 v[86:87], v12 offset:9216
    v_mfma_f32_16x16x32_bf16 a[152:155], v[172:175], v[128:131], a[152:155]
    ds_read_b64_tr_b16 v[60:61], v13 offset:0
    v_mfma_f32_16x16x32_bf16 a[156:159], v[172:175], v[132:135], a[156:159]
    ds_read_b64_tr_b16 v[62:63], v13 offset:1024
    v_mfma_f32_16x16x32_bf16 a[48:51], v[148:151], v[120:123], a[48:51]
    buffer_load_dwordx4 v5, s[12:15], s25 offen offset:0 lds
    v_mfma_f32_16x16x32_bf16 a[52:55], v[148:151], v[124:127], a[52:55]
    ds_read_b64_tr_b16 v[88:89], v13 offset:8192
    v_mfma_f32_16x16x32_bf16 a[56:59], v[148:151], v[128:131], a[56:59]
    ds_read_b64_tr_b16 v[90:91], v13 offset:9216
    v_mfma_f32_16x16x32_bf16 a[60:63], v[148:151], v[132:135], a[60:63]
    ds_read_b64_tr_b16 v[64:65], v14 offset:0
    v_mfma_f32_16x16x32_bf16 a[160:163], v[176:179], v[120:123], a[160:163]
    buffer_load_dwordx4 v6, s[12:15], s25 offen offset:1024 lds
    v_mfma_f32_16x16x32_bf16 a[164:167], v[176:179], v[124:127], a[164:167]
    ds_read_b64_tr_b16 v[66:67], v14 offset:1024
    v_mfma_f32_16x16x32_bf16 a[168:171], v[176:179], v[128:131], a[168:171]
    ds_read_b64_tr_b16 v[92:93], v14 offset:8192
    v_mfma_f32_16x16x32_bf16 a[172:175], v[176:179], v[132:135], a[172:175]
    ds_read_b64_tr_b16 v[94:95], v14 offset:9216
    v_mfma_f32_16x16x32_bf16 a[64:67], v[152:155], v[120:123], a[64:67]
    s_add_u32 m0, s28, 57600
    v_mfma_f32_16x16x32_bf16 a[68:71], v[152:155], v[124:127], a[68:71]
    ds_read_b64_tr_b16 v[68:69], v15 offset:0
    v_mfma_f32_16x16x32_bf16 a[72:75], v[152:155], v[128:131], a[72:75]
    ds_read_b64_tr_b16 v[70:71], v15 offset:1024
    v_mfma_f32_16x16x32_bf16 a[76:79], v[152:155], v[132:135], a[76:79]
    ds_read_b64_tr_b16 v[96:97], v15 offset:8192
    v_mfma_f32_16x16x32_bf16 a[176:179], v[180:183], v[120:123], a[176:179]
    buffer_load_dwordx4 v5, s[16:19], s25 offen offset:0 lds
    v_mfma_f32_16x16x32_bf16 a[180:183], v[180:183], v[124:127], a[180:183]
    ds_read_b64_tr_b16 v[98:99], v15 offset:9216
    v_mfma_f32_16x16x32_bf16 a[184:187], v[180:183], v[128:131], a[184:187]
    ds_read_b64_tr_b16 v[72:73], v16 offset:0
    v_mfma_f32_16x16x32_bf16 a[188:191], v[180:183], v[132:135], a[188:191]
    ds_read_b64_tr_b16 v[74:75], v16 offset:1024
    v_mfma_f32_16x16x32_bf16 a[80:83], v[156:159], v[120:123], a[80:83]
    buffer_load_dwordx4 v6, s[16:19], s25 offen offset:1024 lds
    v_mfma_f32_16x16x32_bf16 a[84:87], v[156:159], v[124:127], a[84:87]
    ds_read_b64_tr_b16 v[100:101], v16 offset:8192
    v_mfma_f32_16x16x32_bf16 a[88:91], v[156:159], v[128:131], a[88:91]
    ds_read_b64_tr_b16 v[102:103], v16 offset:9216
    v_mfma_f32_16x16x32_bf16 a[92:95], v[156:159], v[132:135], a[92:95]
    ds_read_b128 v[104:107], v9 offset:0
    v_mfma_f32_16x16x32_bf16 a[192:195], v[184:187], v[120:123], a[192:195]
    s_add_u32 m0, s29, 12544
    v_mfma_f32_16x16x32_bf16 a[196:199], v[184:187], v[124:127], a[196:199]
    ds_read_b128 v[108:111], v9 offset:1024
    v_mfma_f32_16x16x32_bf16 a[200:203], v[184:187], v[128:131], a[200:203]
    ds_read_b128 v[112:115], v9 offset:2048
    v_mfma_f32_16x16x32_bf16 a[204:207], v[184:187], v[132:135], a[204:207]
    ds_read_b128 v[116:119], v9 offset:3072
    v_mfma_f32_16x16x32_bf16 a[96:99], v[160:163], v[120:123], a[96:99]
    buffer_load_dwordx4 v7, s[20:23], s26 offen lds
    v_mfma_f32_16x16x32_bf16 a[100:103], v[160:163], v[124:127], a[100:103]
    v_mfma_f32_16x16x32_bf16 a[104:107], v[160:163], v[128:131], a[104:107]
    s_set_gpr_idx_on s59, gpr_idx(SRC0)
    v_mov_b64 v[240:241], v[136:137]
    v_mov_b64 v[242:243], v[138:139]
    s_set_gpr_idx_off
    v_mfma_f32_16x16x32_bf16 a[108:111], v[160:163], v[132:135], a[108:111]
    v_mfma_f32_16x16x32_bf16 a[208:211], v[188:191], v[120:123], a[208:211]
    s_add_u32 s24, s24, 4294951040
    v_mfma_f32_16x16x32_bf16 a[212:215], v[188:191], v[124:127], a[212:215]
    v_mfma_f32_16x16x32_bf16 a[216:219], v[188:191], v[128:131], a[216:219]
    v_mfma_f32_16x16x32_bf16 v[248:251], v[240:243], v[244:247], v[248:251]
    v_mfma_f32_16x16x32_bf16 a[220:223], v[188:191], v[132:135], a[220:223]
    v_mfma_f32_16x16x32_bf16 a[224:227], v[120:123], v[192:195], a[224:227]
    s_add_u32 s25, s25, 229376
    v_mfma_f32_16x16x32_bf16 a[240:243], v[124:127], v[192:195], a[240:243]
    v_mfma_f32_16x16x32_bf16 v[208:211], v[128:131], v[192:195], v[208:211]
    v_mfma_f32_16x16x32_bf16 v[224:227], v[132:135], v[192:195], v[224:227]
    v_mfma_f32_16x16x32_bf16 a[228:231], v[120:123], v[196:199], a[228:231]
    s_sub_u32 s26, s26, -64
    buffer_load_dword v21, v28, s[92:95], s99 offen
    v_mfma_f32_16x16x32_bf16 a[244:247], v[124:127], v[196:199], a[244:247]
    s_add_u32 s99, s99, 256
    v_mfma_f32_16x16x32_bf16 v[212:215], v[128:131], v[196:199], v[212:215]
    v_mfma_f32_16x16x32_bf16 v[228:231], v[132:135], v[196:199], v[228:231]
    v_mfma_f32_16x16x32_bf16 a[232:235], v[120:123], v[200:203], a[232:235]
    v_mfma_f32_16x16x32_bf16 a[248:251], v[124:127], v[200:203], a[248:251]
    v_mfma_f32_16x16x32_bf16 v[216:219], v[128:131], v[200:203], v[216:219]
    buffer_store_dwordx4 v[24:27], v30, s[44:47], s58 offen sc1
    v_mfma_f32_16x16x32_bf16 v[232:235], v[132:135], v[200:203], v[232:235]
    s_add_u32 s58, s58, 512
    v_mfma_f32_16x16x32_bf16 a[236:239], v[120:123], v[204:207], a[236:239]
    v_mfma_f32_16x16x32_bf16 a[252:255], v[124:127], v[204:207], a[252:255]
    v_mfma_f32_16x16x32_bf16 v[220:223], v[128:131], v[204:207], v[220:223]
    v_mfma_f32_16x16x32_bf16 v[236:239], v[132:135], v[204:207], v[236:239]
    s_sub_u32 s30, s30, 1
    s_cbranch_scc0 L_k1_loop
    s_waitcnt vmcnt(24) lgkmcnt(0)
    s_barrier
    v_mfma_f32_16x16x32_bf16 a[0:3], v[48:51], v[32:35], a[0:3]
    buffer_store_dwordx4 v[248:251], v31, s[8:11], s100 offen sc1
    v_mfma_f32_16x16x32_bf16 a[4:7], v[48:51], v[36:39], a[4:7]
    buffer_load_dword v1, v253, s[60:63], 0 offen sc1
    v_mfma_f32_16x16x32_bf16 a[8:11], v[48:51], v[40:43], a[8:11]
    v_lshlrev_b32_e64 v22, 2, v0
    v_mfma_f32_16x16x32_bf16 a[12:15], v[48:51], v[44:47], a[12:15]
    ds_read_b128 v[120:123], v20 offset:0
    v_mfma_f32_16x16x32_bf16 a[112:115], v[76:79], v[32:35], a[112:115]
    ds_read_b128 v[124:127], v20 offset:2048
    v_mfma_f32_16x16x32_bf16 a[116:119], v[76:79], v[36:39], a[116:119]
    ds_read_b128 v[128:131], v20 offset:4096
    v_mfma_f32_16x16x32_bf16 a[120:123], v[76:79], v[40:43], a[120:123]
    ds_read_b128 v[132:135], v20 offset:6144
    v_mfma_f32_16x16x32_bf16 a[124:127], v[76:79], v[44:47], a[124:127]
    s_set_gpr_idx_on s96, gpr_idx(SRC0)
    v_mov_b64 v[240:241], v[48:49]
    v_mov_b64 v[242:243], v[50:51]
    s_set_gpr_idx_off
    v_mfma_f32_16x16x32_bf16 a[16:19], v[52:55], v[32:35], a[16:19]
    ds_read_b64_tr_b16 v[136:137], v10 offset:16384
    v_mfma_f32_16x16x32_bf16 a[20:23], v[52:55], v[36:39], a[20:23]
    ds_read_b64_tr_b16 v[138:139], v10 offset:17408
    v_mfma_f32_16x16x32_bf16 a[24:27], v[52:55], v[40:43], a[24:27]
    v_mfma_f32_16x16x32_bf16 v[248:251], v[240:243], v[244:247], 0
    v_mfma_f32_16x16x32_bf16 a[28:31], v[52:55], v[44:47], a[28:31]
    ds_read_b64_tr_b16 v[164:165], v10 offset:24576
    v_mfma_f32_16x16x32_bf16 a[128:131], v[80:83], v[32:35], a[128:131]
    v_and_b32_e64 v6, 63, v0
    v_mfma_f32_16x16x32_bf16 a[132:135], v[80:83], v[36:39], a[132:135]
    v_min_u32_e64 v6, 55, v6
    v_mfma_f32_16x16x32_bf16 a[136:139], v[80:83], v[40:43], a[136:139]
    v_lshlrev_b32_e64 v6, 7, v6
    v_mfma_f32_16x16x32_bf16 a[140:143], v[80:83], v[44:47], a[140:143]
    v_and_b32_e64 v23, 31, v0
    v_mfma_f32_16x16x32_bf16 a[32:35], v[56:59], v[32:35], a[32:35]
    v_lshlrev_b32_e64 v23, 7, v23
    v_mfma_f32_16x16x32_bf16 a[36:39], v[56:59], v[36:39], a[36:39]
    s_lshl_b32 s34, s2, 2
    s_nop 0
    v_mfma_f32_16x16x32_bf16 a[40:43], v[56:59], v[40:43], a[40:43]
    s_add_u32 s34, s34, s31
    s_nop 0
    v_mfma_f32_16x16x32_bf16 a[44:47], v[56:59], v[44:47], a[44:47]
    s_lshl_b32 s34, s34, 12
    s_nop 0
    v_mfma_f32_16x16x32_bf16 a[144:147], v[84:87], v[32:35], a[144:147]
    s_cmp_lt_u32 s34, 0x200000
    v_mfma_f32_16x16x32_bf16 a[148:151], v[84:87], v[36:39], a[148:151]
    s_set_gpr_idx_on s96, gpr_idx(SRC0)
    v_mov_b64 v[240:241], v[64:65]
    v_mov_b64 v[242:243], v[66:67]
    s_set_gpr_idx_off
    v_mfma_f32_16x16x32_bf16 a[152:155], v[84:87], v[40:43], a[152:155]
    s_cselect_b32 s64, s64, s66
    s_nop 0
    v_mfma_f32_16x16x32_bf16 a[156:159], v[84:87], v[44:47], a[156:159]
    s_cselect_b32 s65, s65, s67
    s_nop 0
    v_mfma_f32_16x16x32_bf16 a[48:51], v[60:63], v[32:35], a[48:51]
    v_mfma_f32_16x16x32_bf16 v[24:27], v[240:243], v[244:247], 0
    v_mfma_f32_16x16x32_bf16 a[52:55], v[60:63], v[36:39], a[52:55]
    s_and_b32 s65, s65, 0xffff
    v_mfma_f32_16x16x32_bf16 a[56:59], v[60:63], v[40:43], a[56:59]
    s_mov_b32 s66, 0x200000
    v_mfma_f32_16x16x32_bf16 a[60:63], v[60:63], v[44:47], a[60:63]
    s_mov_b32 s67, 0x20000
    v_mfma_f32_16x16x32_bf16 a[160:163], v[88:91], v[32:35], a[160:163]
    s_and_b32 s34, s34, 0x1fffff
    v_mfma_f32_16x16x32_bf16 a[164:167], v[88:91], v[36:39], a[164:167]
    ds_read_b64_tr_b16 v[166:167], v10 offset:25600
    v_mfma_f32_16x16x32_bf16 a[168:171], v[88:91], v[40:43], a[168:171]
    ds_read_b64_tr_b16 v[140:141], v11 offset:16384
    v_mfma_f32_16x16x32_bf16 a[172:175], v[88:91], v[44:47], a[172:175]
    ds_read_b64_tr_b16 v[142:143], v11 offset:17408
    v_mfma_f32_16x16x32_bf16 a[64:67], v[64:67], v[32:35], a[64:67]
    ds_read_b64_tr_b16 v[168:169], v11 offset:24576
    v_mfma_f32_16x16x32_bf16 a[68:71], v[64:67], v[36:39], a[68:71]
    ds_read_b64_tr_b16 v[170:171], v11 offset:25600
    v_mfma_f32_16x16x32_bf16 a[72:75], v[64:67], v[40:43], a[72:75]
    ds_read_b64_tr_b16 v[144:145], v12 offset:16384
    v_mfma_f32_16x16x32_bf16 a[76:79], v[64:67], v[44:47], a[76:79]
    s_set_gpr_idx_on s96, gpr_idx(SRC0)
    v_mov_b64 v[240:241], v[80:81]
    v_mov_b64 v[242:243], v[82:83]
    s_set_gpr_idx_off
    v_mfma_f32_16x16x32_bf16 a[176:179], v[92:95], v[32:35], a[176:179]
    ds_read_b64_tr_b16 v[146:147], v12 offset:17408
    v_mfma_f32_16x16x32_bf16 a[180:183], v[92:95], v[36:39], a[180:183]
    ds_read_b64_tr_b16 v[172:173], v12 offset:24576
    v_mfma_f32_16x16x32_bf16 a[184:187], v[92:95], v[40:43], a[184:187]
    v_mfma_f32_16x16x32_bf16 v[2:5], v[240:243], v[244:247], 0
    v_mfma_f32_16x16x32_bf16 a[188:191], v[92:95], v[44:47], a[188:191]
    ds_read_b64_tr_b16 v[174:175], v12 offset:25600
    v_mfma_f32_16x16x32_bf16 a[80:83], v[68:71], v[32:35], a[80:83]
    ds_read_b64_tr_b16 v[148:149], v13 offset:16384
    v_mfma_f32_16x16x32_bf16 a[84:87], v[68:71], v[36:39], a[84:87]
    ds_read_b64_tr_b16 v[150:151], v13 offset:17408
    v_mfma_f32_16x16x32_bf16 a[88:91], v[68:71], v[40:43], a[88:91]
    ds_read_b64_tr_b16 v[176:177], v13 offset:24576
    v_mfma_f32_16x16x32_bf16 a[92:95], v[68:71], v[44:47], a[92:95]
    ds_read_b64_tr_b16 v[178:179], v13 offset:25600
    v_mfma_f32_16x16x32_bf16 a[192:195], v[96:99], v[32:35], a[192:195]
    buffer_load_dword v21, v6, s[88:91], s87 offen
    v_mfma_f32_16x16x32_bf16 a[196:199], v[96:99], v[36:39], a[196:199]
    ds_read_b64_tr_b16 v[152:153], v14 offset:16384
    v_mfma_f32_16x16x32_bf16 a[200:203], v[96:99], v[40:43], a[200:203]
    ds_read_b64_tr_b16 v[154:155], v14 offset:17408
    v_mfma_f32_16x16x32_bf16 a[204:207], v[96:99], v[44:47], a[204:207]
    ds_read_b64_tr_b16 v[180:181], v14 offset:24576
    v_mfma_f32_16x16x32_bf16 a[96:99], v[72:75], v[32:35], a[96:99]
    buffer_load_dword v21, v23, s[64:67], s34 offen
    v_mfma_f32_16x16x32_bf16 a[100:103], v[72:75], v[36:39], a[100:103]
    s_set_gpr_idx_on s96, gpr_idx(SRC0)
    v_mov_b64 v[240:241], v[96:97]
    v_mov_b64 v[242:243], v[98:99]
    s_set_gpr_idx_off
    v_mfma_f32_16x16x32_bf16 a[104:107], v[72:75], v[40:43], a[104:107]
    ds_read_b64_tr_b16 v[182:183], v14 offset:25600
    v_mfma_f32_16x16x32_bf16 a[108:111], v[72:75], v[44:47], a[108:111]
    ds_read_b64_tr_b16 v[156:157], v15 offset:16384
    v_mfma_f32_16x16x32_bf16 a[208:211], v[100:103], v[32:35], a[208:211]
    v_mfma_f32_16x16x32_bf16 v[28:31], v[240:243], v[244:247], 0
    v_mfma_f32_16x16x32_bf16 a[212:215], v[100:103], v[36:39], a[212:215]
    ds_read_b64_tr_b16 v[158:159], v15 offset:17408
    v_mfma_f32_16x16x32_bf16 a[216:219], v[100:103], v[40:43], a[216:219]
    ds_read_b64_tr_b16 v[184:185], v15 offset:24576
    v_mfma_f32_16x16x32_bf16 a[220:223], v[100:103], v[44:47], a[220:223]
    ds_read_b64_tr_b16 v[186:187], v15 offset:25600
    v_mfma_f32_16x16x32_bf16 a[224:227], v[32:35], v[104:107], a[224:227]
    ds_read_b64_tr_b16 v[160:161], v16 offset:16384
    v_mfma_f32_16x16x32_bf16 a[240:243], v[36:39], v[104:107], a[240:243]
    ds_read_b64_tr_b16 v[162:163], v16 offset:17408
    v_mfma_f32_16x16x32_bf16 v[208:211], v[40:43], v[104:107], v[208:211]
    ds_read_b64_tr_b16 v[188:189], v16 offset:24576
    v_mfma_f32_16x16x32_bf16 v[224:227], v[44:47], v[104:107], v[224:227]
    ds_read_b64_tr_b16 v[190:191], v16 offset:25600
    v_mfma_f32_16x16x32_bf16 a[228:231], v[32:35], v[108:111], a[228:231]
    ds_read_b128 v[192:195], v9 offset:4096
    v_mfma_f32_16x16x32_bf16 a[244:247], v[36:39], v[108:111], a[244:247]
    ds_read_b128 v[196:199], v9 offset:5120
    v_mfma_f32_16x16x32_bf16 v[212:215], v[40:43], v[108:111], v[212:215]
    ds_read_b128 v[200:203], v9 offset:6144
    v_mfma_f32_16x16x32_bf16 v[228:231], v[44:47], v[108:111], v[228:231]
    s_set_gpr_idx_on s96, gpr_idx(SRC0)
    v_mov_b64 v[240:241], v[112:113]
    v_mov_b64 v[242:243], v[114:115]
    s_set_gpr_idx_off
    v_mfma_f32_16x16x32_bf16 a[232:235], v[32:35], v[112:115], a[232:235]
    ds_read_b128 v[204:207], v9 offset:7168
    v_mfma_f32_16x16x32_bf16 a[248:251], v[36:39], v[112:115], a[248:251]
    v_mfma_f32_16x16x32_bf16 v[216:219], v[40:43], v[112:115], v[216:219]
    v_mfma_f32_16x16x32_bf16 v[252:255], v[240:243], v[244:247], 0
    v_mfma_f32_16x16x32_bf16 v[232:235], v[44:47], v[112:115], v[232:235]
    v_mfma_f32_16x16x32_bf16 a[236:239], v[32:35], v[116:119], a[236:239]
    v_mfma_f32_16x16x32_bf16 a[252:255], v[36:39], v[116:119], a[252:255]
    v_mfma_f32_16x16x32_bf16 v[220:223], v[40:43], v[116:119], v[220:223]
    v_mfma_f32_16x16x32_bf16 v[236:239], v[44:47], v[116:119], v[236:239]
    s_waitcnt vmcnt(11) lgkmcnt(0)
    s_barrier
    v_mfma_f32_16x16x32_bf16 a[0:3], v[136:139], v[120:123], a[0:3]
    s_getpc_b64 s[40:41]
    L_k1_pcb:
    s_nop 0
    v_mfma_f32_16x16x32_bf16 a[4:7], v[136:139], v[124:127], a[4:7]
    s_and_b32 s41, s41, 0xffff
    s_mov_b32 s42, L_k2_end-L_k1_pcb
    v_mfma_f32_16x16x32_bf16 a[8:11], v[136:139], v[128:131], a[8:11]
    s_mov_b32 s43, 0x20000
    s_and_b32 s35, s2, 56
    s_nop 0
    v_mfma_f32_16x16x32_bf16 a[12:15], v[136:139], v[132:135], a[12:15]
    s_cmp_eq_u32 s35, 0
    s_cselect_b32 s35, 0, 0x40000000
    v_mfma_f32_16x16x32_bf16 a[112:115], v[164:167], v[120:123], a[112:115]
    v_lshlrev_b32_e64 v23, 7, v0
    v_mfma_f32_16x16x32_bf16 a[116:119], v[164:167], v[124:127], a[116:119]
    buffer_load_dword v21, v23, s[40:43], s35 offen
    v_mfma_f32_16x16x32_bf16 a[120:123], v[164:167], v[128:131], a[120:123]
    ds_read_b128 v[32:35], v8 offset:32768
    v_mfma_f32_16x16x32_bf16 a[124:127], v[164:167], v[132:135], a[124:127]
    s_set_gpr_idx_on s96, gpr_idx(SRC0)
    v_mov_b64 v[240:241], v[136:137]
    v_mov_b64 v[242:243], v[138:139]
    s_set_gpr_idx_off
    v_mfma_f32_16x16x32_bf16 a[16:19], v[140:143], v[120:123], a[16:19]
    ds_read_b128 v[36:39], v8 offset:34816
    v_mfma_f32_16x16x32_bf16 a[20:23], v[140:143], v[124:127], a[20:23]
    ds_read_b128 v[40:43], v8 offset:36864
    v_mfma_f32_16x16x32_bf16 a[24:27], v[140:143], v[128:131], a[24:27]
    v_mfma_f32_16x16x32_bf16 v[248:251], v[240:243], v[244:247], v[248:251]
    v_mfma_f32_16x16x32_bf16 a[28:31], v[140:143], v[132:135], a[28:31]
    ds_read_b128 v[44:47], v8 offset:38912
    v_mfma_f32_16x16x32_bf16 a[128:131], v[168:171], v[120:123], a[128:131]
    ds_read_b64_tr_b16 v[48:49], v10 offset:32768
    v_mfma_f32_16x16x32_bf16 a[132:135], v[168:171], v[124:127], a[132:135]
    ds_read_b64_tr_b16 v[50:51], v10 offset:33792
    v_mfma_f32_16x16x32_bf16 a[136:139], v[168:171], v[128:131], a[136:139]
    ds_read_b64_tr_b16 v[76:77], v10 offset:40960
    v_mfma_f32_16x16x32_bf16 a[140:143], v[168:171], v[132:135], a[140:143]
    ds_read_b64_tr_b16 v[78:79], v10 offset:41984
    v_mfma_f32_16x16x32_bf16 a[32:35], v[144:147], v[120:123], a[32:35]
    ds_read_b64_tr_b16 v[52:53], v11 offset:32768
    v_mfma_f32_16x16x32_bf16 a[36:39], v[144:147], v[124:127], a[36:39]
    ds_read_b64_tr_b16 v[54:55], v11 offset:33792
    v_mfma_f32_16x16x32_bf16 a[40:43], v[144:147], v[128:131], a[40:43]
    ds_read_b64_tr_b16 v[80:81], v11 offset:40960
    v_mfma_f32_16x16x32_bf16 a[44:47], v[144:147], v[132:135], a[44:47]
    ds_read_b64_tr_b16 v[82:83], v11 offset:41984
    v_mfma_f32_16x16x32_bf16 a[144:147], v[172:175], v[120:123], a[144:147]
    ds_read_b64_tr_b16 v[56:57], v12 offset:32768
    v_mfma_f32_16x16x32_bf16 a[148:151], v[172:175], v[124:127], a[148:151]
    s_set_gpr_idx_on s96, gpr_idx(SRC0)
    v_mov_b64 v[240:241], v[152:153]
    v_mov_b64 v[242:243], v[154:155]
    s_set_gpr_idx_off
    v_mfma_f32_16x16x32_bf16 a[152:155], v[172:175], v[128:131], a[152:155]
    ds_read_b64_tr_b16 v[58:59], v12 offset:33792
    v_mfma_f32_16x16x32_bf16 a[156:159], v[172:175], v[132:135], a[156:159]
    ds_read_b64_tr_b16 v[84:85], v12 offset:40960
    v_mfma_f32_16x16x32_bf16 a[48:51], v[148:151], v[120:123], a[48:51]
    v_mfma_f32_16x16x32_bf16 v[24:27], v[240:243], v[244:247], v[24:27]
    v_mfma_f32_16x16x32_bf16 a[52:55], v[148:151], v[124:127], a[52:55]
    ds_read_b64_tr_b16 v[86:87], v12 offset:41984
    v_mfma_f32_16x16x32_bf16 a[56:59], v[148:151], v[128:131], a[56:59]
    ds_read_b64_tr_b16 v[60:61], v13 offset:32768
    v_mfma_f32_16x16x32_bf16 a[60:63], v[148:151], v[132:135], a[60:63]
    ds_read_b64_tr_b16 v[62:63], v13 offset:33792
    v_mfma_f32_16x16x32_bf16 a[160:163], v[176:179], v[120:123], a[160:163]
    ds_read_b64_tr_b16 v[88:89], v13 offset:40960
    v_mfma_f32_16x16x32_bf16 a[164:167], v[176:179], v[124:127], a[164:167]
    ds_read_b64_tr_b16 v[90:91], v13 offset:41984
    v_mfma_f32_16x16x32_bf16 a[168:171], v[176:179], v[128:131], a[168:171]
    ds_read_b64_tr_b16 v[64:65], v14 offset:32768
    v_mfma_f32_16x16x32_bf16 a[172:175], v[176:179], v[132:135], a[172:175]
    ds_read_b64_tr_b16 v[66:67], v14 offset:33792
    v_mfma_f32_16x16x32_bf16 a[64:67], v[152:155], v[120:123], a[64:67]
    ds_read_b64_tr_b16 v[92:93], v14 offset:40960
    v_mfma_f32_16x16x32_bf16 a[68:71], v[152:155], v[124:127], a[68:71]
    ds_read_b64_tr_b16 v[94:95], v14 offset:41984
    v_mfma_f32_16x16x32_bf16 a[72:75], v[152:155], v[128:131], a[72:75]
    ds_read_b64_tr_b16 v[68:69], v15 offset:32768
    v_mfma_f32_16x16x32_bf16 a[76:79], v[152:155], v[132:135], a[76:79]
    s_set_gpr_idx_on s96, gpr_idx(SRC0)
    v_mov_b64 v[240:241], v[168:169]
    v_mov_b64 v[242:243], v[170:171]
    s_set_gpr_idx_off
    v_mfma_f32_16x16x32_bf16 a[176:179], v[180:183], v[120:123], a[176:179]
    ds_read_b64_tr_b16 v[70:71], v15 offset:33792
    v_mfma_f32_16x16x32_bf16 a[180:183], v[180:183], v[124:127], a[180:183]
    ds_read_b64_tr_b16 v[96:97], v15 offset:40960
    v_mfma_f32_16x16x32_bf16 a[184:187], v[180:183], v[128:131], a[184:187]
    v_mfma_f32_16x16x32_bf16 v[2:5], v[240:243], v[244:247], v[2:5]
    v_mfma_f32_16x16x32_bf16 a[188:191], v[180:183], v[132:135], a[188:191]
    ds_read_b64_tr_b16 v[98:99], v15 offset:41984
    v_mfma_f32_16x16x32_bf16 a[80:83], v[156:159], v[120:123], a[80:83]
    ds_read_b64_tr_b16 v[72:73], v16 offset:32768
    v_mfma_f32_16x16x32_bf16 a[84:87], v[156:159], v[124:127], a[84:87]
    ds_read_b64_tr_b16 v[74:75], v16 offset:33792
    v_mfma_f32_16x16x32_bf16 a[88:91], v[156:159], v[128:131], a[88:91]
    ds_read_b64_tr_b16 v[100:101], v16 offset:40960
    v_mfma_f32_16x16x32_bf16 a[92:95], v[156:159], v[132:135], a[92:95]
    ds_read_b64_tr_b16 v[102:103], v16 offset:41984
    v_mfma_f32_16x16x32_bf16 a[192:195], v[184:187], v[120:123], a[192:195]
    ds_read_b128 v[104:107], v9 offset:8192
    v_mfma_f32_16x16x32_bf16 a[196:199], v[184:187], v[124:127], a[196:199]
    ds_read_b128 v[108:111], v9 offset:9216
    v_mfma_f32_16x16x32_bf16 a[200:203], v[184:187], v[128:131], a[200:203]
    ds_read_b128 v[112:115], v9 offset:10240
    v_mfma_f32_16x16x32_bf16 a[204:207], v[184:187], v[132:135], a[204:207]
    ds_read_b128 v[116:119], v9 offset:11264
    v_mfma_f32_16x16x32_bf16 a[96:99], v[160:163], v[120:123], a[96:99]
    v_mfma_f32_16x16x32_bf16 a[100:103], v[160:163], v[124:127], a[100:103]
    s_set_gpr_idx_on s96, gpr_idx(SRC0)
    v_mov_b64 v[240:241], v[184:185]
    v_mov_b64 v[242:243], v[186:187]
    s_set_gpr_idx_off
    v_mfma_f32_16x16x32_bf16 a[104:107], v[160:163], v[128:131], a[104:107]
    v_mfma_f32_16x16x32_bf16 a[108:111], v[160:163], v[132:135], a[108:111]
    v_mfma_f32_16x16x32_bf16 a[208:211], v[188:191], v[120:123], a[208:211]
    v_mfma_f32_16x16x32_bf16 v[28:31], v[240:243], v[244:247], v[28:31]
    v_mfma_f32_16x16x32_bf16 a[212:215], v[188:191], v[124:127], a[212:215]
    v_mfma_f32_16x16x32_bf16 a[216:219], v[188:191], v[128:131], a[216:219]
    v_mfma_f32_16x16x32_bf16 a[220:223], v[188:191], v[132:135], a[220:223]
    v_mfma_f32_16x16x32_bf16 a[224:227], v[120:123], v[192:195], a[224:227]
    v_mfma_f32_16x16x32_bf16 a[240:243], v[124:127], v[192:195], a[240:243]
    v_mfma_f32_16x16x32_bf16 v[208:211], v[128:131], v[192:195], v[208:211]
    v_mfma_f32_16x16x32_bf16 v[224:227], v[132:135], v[192:195], v[224:227]
    v_mfma_f32_16x16x32_bf16 a[228:231], v[120:123], v[196:199], a[228:231]
    v_mfma_f32_16x16x32_bf16 a[244:247], v[124:127], v[196:199], a[244:247]
    v_mfma_f32_16x16x32_bf16 v[212:215], v[128:131], v[196:199], v[212:215]
    v_mfma_f32_16x16x32_bf16 v[228:231], v[132:135], v[196:199], v[228:231]
    s_set_gpr_idx_on s96, gpr_idx(SRC0)
    v_mov_b64 v[240:241], v[200:201]
    v_mov_b64 v[242:243], v[202:203]
    s_set_gpr_idx_off
    v_mfma_f32_16x16x32_bf16 a[232:235], v[120:123], v[200:203], a[232:235]
    v_mfma_f32_16x16x32_bf16 a[248:251], v[124:127], v[200:203], a[248:251]
    v_mfma_f32_16x16x32_bf16 v[216:219], v[128:131], v[200:203], v[216:219]
    v_mfma_f32_16x16x32_bf16 v[252:255], v[240:243], v[244:247], v[252:255]
    v_mfma_f32_16x16x32_bf16 v[232:235], v[132:135], v[200:203], v[232:235]
    v_mfma_f32_16x16x32_bf16 a[236:239], v[120:123], v[204:207], a[236:239]
    v_mfma_f32_16x16x32_bf16 a[252:255], v[124:127], v[204:207], a[252:255]
    v_mfma_f32_16x16x32_bf16 v[220:223], v[128:131], v[204:207], v[220:223]
    v_mfma_f32_16x16x32_bf16 v[236:239], v[132:135], v[204:207], v[236:239]
    s_waitcnt vmcnt(3) lgkmcnt(0)
    s_barrier
    v_mfma_f32_16x16x32_bf16 a[0:3], v[48:51], v[32:35], a[0:3]
    v_and_b32_e64 v1, s86, v1
    v_cmp_eq_u32_e64 s[68:69], s86, v1
    v_mfma_f32_16x16x32_bf16 a[4:7], v[48:51], v[36:39], a[4:7]
    buffer_load_dword v7, v22, s[8:11], s101 offen sc1
    v_mfma_f32_16x16x32_bf16 a[8:11], v[48:51], v[40:43], a[8:11]
    ds_read_b128 v[120:123], v20 offset:32768
    v_mfma_f32_16x16x32_bf16 a[12:15], v[48:51], v[44:47], a[12:15]
    ds_read_b128 v[124:127], v20 offset:34816
    v_mfma_f32_16x16x32_bf16 a[112:115], v[76:79], v[32:35], a[112:115]
    ds_read_b128 v[128:131], v20 offset:36864
    v_mfma_f32_16x16x32_bf16 a[116:119], v[76:79], v[36:39], a[116:119]
    ds_read_b128 v[132:135], v20 offset:38912
    v_mfma_f32_16x16x32_bf16 a[120:123], v[76:79], v[40:43], a[120:123]
    ds_read_b64_tr_b16 v[136:137], v10 offset:49152
    v_mfma_f32_16x16x32_bf16 a[124:127], v[76:79], v[44:47], a[124:127]
    s_set_gpr_idx_on s96, gpr_idx(SRC0)
    v_mov_b64 v[240:241], v[48:49]
    v_mov_b64 v[242:243], v[50:51]
    s_set_gpr_idx_off
    v_mfma_f32_16x16x32_bf16 a[16:19], v[52:55], v[32:35], a[16:19]
    ds_read_b64_tr_b16 v[138:139], v10 offset:50176
    v_mfma_f32_16x16x32_bf16 a[20:23], v[52:55], v[36:39], a[20:23]
    ds_read_b64_tr_b16 v[164:165], v10 offset:57344
    v_mfma_f32_16x16x32_bf16 a[24:27], v[52:55], v[40:43], a[24:27]
    v_mfma_f32_16x16x32_bf16 v[248:251], v[240:243], v[244:247], v[248:251]
    v_mfma_f32_16x16x32_bf16 a[28:31], v[52:55], v[44:47], a[28:31]
    ds_read_b64_tr_b16 v[166:167], v10 offset:58368
    v_mfma_f32_16x16x32_bf16 a[128:131], v[80:83], v[32:35], a[128:131]
    ds_read_b64_tr_b16 v[140:141], v11 offset:49152
    v_mfma_f32_16x16x32_bf16 a[132:135], v[80:83], v[36:39], a[132:135]
    ds_read_b64_tr_b16 v[142:143], v11 offset:50176
    v_mfma_f32_16x16x32_bf16 a[136:139], v[80:83], v[40:43], a[136:139]
    ds_read_b64_tr_b16 v[168:169], v11 offset:57344
    v_mfma_f32_16x16x32_bf16 a[140:143], v[80:83], v[44:47], a[140:143]
    ds_read_b64_tr_b16 v[170:171], v11 offset:58368
    v_mfma_f32_16x16x32_bf16 a[32:35], v[56:59], v[32:35], a[32:35]
    ds_read_b64_tr_b16 v[144:145], v12 offset:49152
    v_mfma_f32_16x16x32_bf16 a[36:39], v[56:59], v[36:39], a[36:39]
    ds_read_b64_tr_b16 v[146:147], v12 offset:50176
    v_mfma_f32_16x16x32_bf16 a[40:43], v[56:59], v[40:43], a[40:43]
    ds_read_b64_tr_b16 v[172:173], v12 offset:57344
    v_mfma_f32_16x16x32_bf16 a[44:47], v[56:59], v[44:47], a[44:47]
    ds_read_b64_tr_b16 v[174:175], v12 offset:58368
    v_mfma_f32_16x16x32_bf16 a[144:147], v[84:87], v[32:35], a[144:147]
    ds_read_b64_tr_b16 v[148:149], v13 offset:49152
    v_mfma_f32_16x16x32_bf16 a[148:151], v[84:87], v[36:39], a[148:151]
    s_set_gpr_idx_on s96, gpr_idx(SRC0)
    v_mov_b64 v[240:241], v[64:65]
    v_mov_b64 v[242:243], v[66:67]
    s_set_gpr_idx_off
    v_mfma_f32_16x16x32_bf16 a[152:155], v[84:87], v[40:43], a[152:155]
    ds_read_b64_tr_b16 v[150:151], v13 offset:50176
    v_mfma_f32_16x16x32_bf16 a[156:159], v[84:87], v[44:47], a[156:159]
    ds_read_b64_tr_b16 v[176:177], v13 offset:57344
    v_mfma_f32_16x16x32_bf16 a[48:51], v[60:63], v[32:35], a[48:51]
    v_mfma_f32_16x16x32_bf16 v[24:27], v[240:243], v[244:247], v[24:27]
    v_mfma_f32_16x16x32_bf16 a[52:55], v[60:63], v[36:39], a[52:55]
    ds_read_b64_tr_b16 v[178:179], v13 offset:58368
    v_mfma_f32_16x16x32_bf16 a[56:59], v[60:63], v[40:43], a[56:59]
    ds_read_b64_tr_b16 v[152:153], v14 offset:49152
    v_mfma_f32_16x16x32_bf16 a[60:63], v[60:63], v[44:47], a[60:63]
    ds_read_b64_tr_b16 v[154:155], v14 offset:50176
    v_mfma_f32_16x16x32_bf16 a[160:163], v[88:91], v[32:35], a[160:163]
    ds_read_b64_tr_b16 v[180:181], v14 offset:57344
    v_mfma_f32_16x16x32_bf16 a[164:167], v[88:91], v[36:39], a[164:167]
    ds_read_b64_tr_b16 v[182:183], v14 offset:58368
    v_mfma_f32_16x16x32_bf16 a[168:171], v[88:91], v[40:43], a[168:171]
    ds_read_b64_tr_b16 v[156:157], v15 offset:49152
    v_mfma_f32_16x16x32_bf16 a[172:175], v[88:91], v[44:47], a[172:175]
    ds_read_b64_tr_b16 v[158:159], v15 offset:50176
    v_mfma_f32_16x16x32_bf16 a[64:67], v[64:67], v[32:35], a[64:67]
    ds_read_b64_tr_b16 v[184:185], v15 offset:57344
    v_mfma_f32_16x16x32_bf16 a[68:71], v[64:67], v[36:39], a[68:71]
    ds_read_b64_tr_b16 v[186:187], v15 offset:58368
    v_mfma_f32_16x16x32_bf16 a[72:75], v[64:67], v[40:43], a[72:75]
    ds_read_b64_tr_b16 v[160:161], v16 offset:49152
    v_mfma_f32_16x16x32_bf16 a[76:79], v[64:67], v[44:47], a[76:79]
    s_set_gpr_idx_on s96, gpr_idx(SRC0)
    v_mov_b64 v[240:241], v[80:81]
    v_mov_b64 v[242:243], v[82:83]
    s_set_gpr_idx_off
    v_mfma_f32_16x16x32_bf16 a[176:179], v[92:95], v[32:35], a[176:179]
    ds_read_b64_tr_b16 v[162:163], v16 offset:50176
    v_mfma_f32_16x16x32_bf16 a[180:183], v[92:95], v[36:39], a[180:183]
    ds_read_b64_tr_b16 v[188:189], v16 offset:57344
    v_mfma_f32_16x16x32_bf16 a[184:187], v[92:95], v[40:43], a[184:187]
    v_mfma_f32_16x16x32_bf16 v[2:5], v[240:243], v[244:247], v[2:5]
    v_mfma_f32_16x16x32_bf16 a[188:191], v[92:95], v[44:47], a[188:191]
    ds_read_b64_tr_b16 v[190:191], v16 offset:58368
    v_mfma_f32_16x16x32_bf16 a[80:83], v[68:71], v[32:35], a[80:83]
    v_bfe_u32 v22, v0, 4, 2
    v_mfma_f32_16x16x32_bf16 a[84:87], v[68:71], v[36:39], a[84:87]
    v_lshlrev_b32_e64 v22, 4, v22
    v_mfma_f32_16x16x32_bf16 a[88:91], v[68:71], v[40:43], a[88:91]
    s_lshl_b32 s34, s33, 11
    s_nop 0
    v_mfma_f32_16x16x32_bf16 a[92:95], v[68:71], v[44:47], a[92:95]
    s_lshl_b32 s35, s31, 6
    s_nop 0
    v_mfma_f32_16x16x32_bf16 a[192:195], v[96:99], v[32:35], a[192:195]
    s_add_u32 s34, s34, s35
    s_nop 0
    v_mfma_f32_16x16x32_bf16 a[196:199], v[96:99], v[36:39], a[196:199]
    s_add_u32 s34, s34, 42074112
    v_mfma_f32_16x16x32_bf16 a[200:203], v[96:99], v[40:43], a[200:203]
    s_cmp_lt_u32 s31, 2
    s_nop 0
    v_mfma_f32_16x16x32_bf16 a[204:207], v[96:99], v[44:47], a[204:207]
    s_cselect_b32 s35, s34, 536870912
    v_mfma_f32_16x16x32_bf16 a[96:99], v[72:75], v[32:35], a[96:99]
    s_mov_b32 s36, 0xffff0000
    v_mfma_f32_16x16x32_bf16 a[100:103], v[72:75], v[36:39], a[100:103]
    s_set_gpr_idx_on s96, gpr_idx(SRC0)
    v_mov_b64 v[240:241], v[96:97]
    v_mov_b64 v[242:243], v[98:99]
    s_set_gpr_idx_off
    v_mfma_f32_16x16x32_bf16 a[104:107], v[72:75], v[40:43], a[104:107]
    s_mov_b32 s37, 0xffff0000
    v_mfma_f32_16x16x32_bf16 a[108:111], v[72:75], v[44:47], a[108:111]
    s_mov_b32 s38, 0
    s_nop 0
    v_mfma_f32_16x16x32_bf16 a[208:211], v[100:103], v[32:35], a[208:211]
    v_mfma_f32_16x16x32_bf16 v[28:31], v[240:243], v[244:247], v[28:31]
    v_mfma_f32_16x16x32_bf16 a[212:215], v[100:103], v[36:39], a[212:215]
    s_mov_b32 s39, -1
    s_nop 0
    v_mfma_f32_16x16x32_bf16 a[216:219], v[100:103], v[40:43], a[216:219]
    s_bitcmp1_b32 s31, 0
    s_nop 0
    v_mfma_f32_16x16x32_bf16 a[220:223], v[100:103], v[44:47], a[220:223]
    s_cselect_b64 s[40:41], -1, 0
    s_nop 0
    v_mfma_f32_16x16x32_bf16 a[224:227], v[32:35], v[104:107], a[224:227]
    s_bitcmp1_b32 s31, 1
    s_nop 0
    v_mfma_f32_16x16x32_bf16 a[240:243], v[36:39], v[104:107], a[240:243]
    s_cselect_b64 s[42:43], -1, 0
    s_nop 0
    v_mfma_f32_16x16x32_bf16 v[208:211], v[40:43], v[104:107], v[208:211]
    ds_read_b128 v[192:195], v9 offset:12288
    v_mfma_f32_16x16x32_bf16 v[224:227], v[44:47], v[104:107], v[224:227]
    ds_read_b128 v[196:199], v9 offset:13312
    v_mfma_f32_16x16x32_bf16 a[228:231], v[32:35], v[108:111], a[228:231]
    ds_read_b128 v[200:203], v9 offset:14336
    v_mfma_f32_16x16x32_bf16 a[244:247], v[36:39], v[108:111], a[244:247]
    ds_read_b128 v[204:207], v9 offset:15360
    v_mfma_f32_16x16x32_bf16 v[212:215], v[40:43], v[108:111], v[212:215]
    v_mfma_f32_16x16x32_bf16 v[228:231], v[44:47], v[108:111], v[228:231]
    s_set_gpr_idx_on s96, gpr_idx(SRC0)
    v_mov_b64 v[240:241], v[112:113]
    v_mov_b64 v[242:243], v[114:115]
    s_set_gpr_idx_off
    v_mfma_f32_16x16x32_bf16 a[232:235], v[32:35], v[112:115], a[232:235]
    v_mfma_f32_16x16x32_bf16 a[248:251], v[36:39], v[112:115], a[248:251]
    v_mfma_f32_16x16x32_bf16 v[216:219], v[40:43], v[112:115], v[216:219]
    v_mfma_f32_16x16x32_bf16 v[252:255], v[240:243], v[244:247], v[252:255]
    v_mfma_f32_16x16x32_bf16 v[232:235], v[44:47], v[112:115], v[232:235]
    v_mfma_f32_16x16x32_bf16 a[236:239], v[32:35], v[116:119], a[236:239]
    v_mfma_f32_16x16x32_bf16 a[252:255], v[36:39], v[116:119], a[252:255]
    v_mfma_f32_16x16x32_bf16 v[220:223], v[40:43], v[116:119], v[220:223]
    v_mfma_f32_16x16x32_bf16 v[236:239], v[44:47], v[116:119], v[236:239]
    s_waitcnt lgkmcnt(0)
    s_nop 0
    v_mfma_f32_16x16x32_bf16 a[0:3], v[136:139], v[120:123], a[0:3]
    v_lshlrev_b32 v32, 16, v17
    v_lshlrev_b32 v48, 16, v18
    v_lshlrev_b32_e64 v90, 2, v0
    v_mfma_f32_16x16x32_bf16 a[4:7], v[136:139], v[124:127], a[4:7]
    buffer_load_dwordx4 v[100:103], v22, s[8:11], s34 offen offset:0 sc1
    v_and_b32 v33, 0xffff0000, v17
    v_and_b32 v49, 0xffff0000, v18
    v_mfma_f32_16x16x32_bf16 a[8:11], v[136:139], v[128:131], a[8:11]
    buffer_load_dwordx4 v[104:107], v22, s[8:11], s34 offen offset:256 sc1
    v_lshlrev_b32_e64 v34, 16, v19
    v_and_b32 v50, 0xffff0000, v19
    v_mfma_f32_16x16x32_bf16 a[12:15], v[136:139], v[132:135], a[12:15]
    buffer_load_dwordx4 v[108:111], v22, s[8:11], s34 offen offset:512 sc1
    v_mul_f32 v34, 1069066811, v34
    v_mul_f32 v50, 1069066811, v50
    v_mfma_f32_16x16x32_bf16 a[112:115], v[164:167], v[120:123], a[112:115]
    buffer_load_dwordx4 v[112:115], v22, s[8:11], s34 offen offset:768 sc1
    v_exp_f32 v34, v34
    v_exp_f32 v50, v50
    v_mfma_f32_16x16x32_bf16 a[116:119], v[164:167], v[124:127], a[116:119]
    buffer_load_dwordx4 v[116:119], v22, s[8:11], s35 offen offset:1024 sc1
    v_cvt_pk_bf16_f32 v34, v34, v34
    v_cvt_pk_bf16_f32 v50, v50, v50
    v_mfma_f32_16x16x32_bf16 a[120:123], v[164:167], v[128:131], a[120:123]
    v_lshlrev_b32 v34, 16, v34
    v_lshlrev_b32 v50, 16, v50
    v_and_b32 v91, 0xf0, v0
    v_mfma_f32_16x16x32_bf16 a[124:127], v[164:167], v[132:135], a[124:127]
    s_set_gpr_idx_on s96, gpr_idx(SRC0)
    v_mov_b64 v[240:241], v[136:137]
    v_mov_b64 v[242:243], v[138:139]
    s_set_gpr_idx_off
    v_mfma_f32_16x16x32_bf16 a[16:19], v[140:143], v[120:123], a[16:19]
    v_mul_f32 v36, v34, v32
    v_mul_f32 v52, v50, v48
    v_and_b32_e64 v92, 3, v0
    v_mfma_f32_16x16x32_bf16 a[20:23], v[140:143], v[124:127], a[20:23]
    v_mul_f32 v37, v34, v33
    v_mul_f32 v53, v50, v49
    v_lshl_add_u32 v91, v92, 2, v91
    v_mfma_f32_16x16x32_bf16 a[24:27], v[140:143], v[128:131], a[24:27]
    v_mfma_f32_16x16x32_bf16 v[248:251], v[240:243], v[244:247], v[248:251]
    v_mul_f32 v36, 1069066811, v36
    v_mul_f32 v52, 1069066811, v52
    v_mfma_f32_16x16x32_bf16 a[28:31], v[140:143], v[132:135], a[28:31]
    v_mul_f32 v37, 1042479491, v37
    v_mul_f32 v53, 1042479491, v53
    v_bfe_u32 v92, v0, 2, 2
    v_mfma_f32_16x16x32_bf16 a[128:131], v[168:171], v[120:123], a[128:131]
    v_exp_f32 v36, v36
    v_exp_f32 v52, v52
    v_add_u32_e64 v91, v91, v92
    v_mfma_f32_16x16x32_bf16 a[132:135], v[168:171], v[124:127], a[132:135]
    v_cos_f32 v38, v37
    v_cos_f32 v54, v53
    v_lshlrev_b32_e64 v91, 2, v91
    v_mfma_f32_16x16x32_bf16 a[136:139], v[168:171], v[128:131], a[136:139]
    v_sin_f32 v39, v37
    v_sin_f32 v55, v53
    v_mfma_f32_16x16x32_bf16 a[140:143], v[168:171], v[132:135], a[140:143]
    v_mul_f32 v41, v32, v32
    v_mul_f32 v57, v48, v48
    v_mfma_f32_16x16x32_bf16 a[32:35], v[144:147], v[120:123], a[32:35]
    v_pk_mul_f32 v[64:65], v[38:39], v[36:37] op_sel:[0,0] op_sel_hi:[1,0]
    v_pk_mul_f32 v[66:67], v[54:55], v[52:53] op_sel:[0,0] op_sel_hi:[1,0]
    v_mfma_f32_16x16x32_bf16 a[36:39], v[144:147], v[124:127], a[36:39]
    v_fma_f32 v41, v33, v33, v41
    v_fma_f32 v57, v49, v49, v57
    v_mfma_f32_16x16x32_bf16 a[40:43], v[144:147], v[128:131], a[40:43]
    v_rcp_f32 v41, v41
    v_rcp_f32 v57, v57
    v_mfma_f32_16x16x32_bf16 a[44:47], v[144:147], v[132:135], a[44:47]
    v_add_f32 v40, -1.0, v64
    v_add_f32 v56, -1.0, v66
    v_mfma_f32_16x16x32_bf16 a[144:147], v[172:175], v[120:123], a[144:147]
    v_mul_f32 v42, v40, v32
    v_mul_f32 v58, v56, v48
    v_mfma_f32_16x16x32_bf16 a[148:151], v[172:175], v[124:127], a[148:151]
    s_set_gpr_idx_on s96, gpr_idx(SRC0)
    v_mov_b64 v[240:241], v[152:153]
    v_mov_b64 v[242:243], v[154:155]
    s_set_gpr_idx_off
    v_mfma_f32_16x16x32_bf16 a[152:155], v[172:175], v[128:131], a[152:155]
    v_fma_f32 v42, v65, v33, v42
    v_fma_f32 v58, v67, v49, v58
    v_mfma_f32_16x16x32_bf16 a[156:159], v[172:175], v[132:135], a[156:159]
    v_mul_f32 v43, v65, v32
    v_mul_f32 v59, v67, v48
    v_mfma_f32_16x16x32_bf16 a[48:51], v[148:151], v[120:123], a[48:51]
    v_mfma_f32_16x16x32_bf16 v[24:27], v[240:243], v[244:247], v[24:27]
    v_fma_f32 v43, -v40, v33, v43
    v_fma_f32 v59, -v56, v49, v59
    v_mfma_f32_16x16x32_bf16 a[52:55], v[148:151], v[124:127], a[52:55]
    v_add_f32 v41, v41, v41
    v_add_f32 v57, v57, v57
    v_mfma_f32_16x16x32_bf16 a[56:59], v[148:151], v[128:131], a[56:59]
    v_mul_f32 v17, v42, v41
    v_mul_f32 v19, v58, v57
    v_mfma_f32_16x16x32_bf16 a[60:63], v[148:151], v[132:135], a[60:63]
    v_mul_f32 v18, v43, v41
    v_mul_f32 v20, v59, v57
    v_mfma_f32_16x16x32_bf16 a[160:163], v[176:179], v[120:123], a[160:163]
    v_pk_mul_f32 v[34:35], v[64:65], v[64:65] op_sel:[0,0] op_sel_hi:[0,1]
    v_pk_mul_f32 v[50:51], v[66:67], v[66:67] op_sel:[0,0] op_sel_hi:[0,1]
    v_mfma_f32_16x16x32_bf16 a[164:167], v[176:179], v[124:127], a[164:167]
    v_pk_fma_f32 v[44:45], v[64:65], v[64:65], v[34:35] op_sel:[1,1,0] op_sel_hi:[1,0,1] neg_lo:[0,1,0]
    v_pk_fma_f32 v[60:61], v[66:67], v[66:67], v[50:51] op_sel:[1,1,0] op_sel_hi:[1,0,1] neg_lo:[0,1,0]
    v_mfma_f32_16x16x32_bf16 a[168:171], v[176:179], v[128:131], a[168:171]
    v_pk_mul_f32 v[34:35], v[44:45], v[44:45] op_sel:[0,0] op_sel_hi:[0,1]
    v_pk_mul_f32 v[50:51], v[60:61], v[60:61] op_sel:[0,0] op_sel_hi:[0,1]
    v_mfma_f32_16x16x32_bf16 a[172:175], v[176:179], v[132:135], a[172:175]
    v_pk_fma_f32 v[44:45], v[44:45], v[44:45], v[34:35] op_sel:[1,1,0] op_sel_hi:[1,0,1] neg_lo:[0,1,0]
    v_pk_fma_f32 v[60:61], v[60:61], v[60:61], v[50:51] op_sel:[1,1,0] op_sel_hi:[1,0,1] neg_lo:[0,1,0]
    v_mfma_f32_16x16x32_bf16 a[64:67], v[152:155], v[120:123], a[64:67]
    v_pk_mul_f32 v[34:35], v[44:45], v[44:45] op_sel:[0,0] op_sel_hi:[0,1]
    v_pk_mul_f32 v[50:51], v[60:61], v[60:61] op_sel:[0,0] op_sel_hi:[0,1]
    v_mfma_f32_16x16x32_bf16 a[68:71], v[152:155], v[124:127], a[68:71]
    v_pk_fma_f32 v[44:45], v[44:45], v[44:45], v[34:35] op_sel:[1,1,0] op_sel_hi:[1,0,1] neg_lo:[0,1,0]
    v_pk_fma_f32 v[60:61], v[60:61], v[60:61], v[50:51] op_sel:[1,1,0] op_sel_hi:[1,0,1] neg_lo:[0,1,0]
    v_mfma_f32_16x16x32_bf16 a[72:75], v[152:155], v[128:131], a[72:75]
    v_pk_mul_f32 v[34:35], v[44:45], v[44:45] op_sel:[0,0] op_sel_hi:[0,1]
    v_pk_mul_f32 v[50:51], v[60:61], v[60:61] op_sel:[0,0] op_sel_hi:[0,1]
    v_mfma_f32_16x16x32_bf16 a[76:79], v[152:155], v[132:135], a[76:79]
    s_set_gpr_idx_on s96, gpr_idx(SRC0)
    v_mov_b64 v[240:241], v[168:169]
    v_mov_b64 v[242:243], v[170:171]
    s_set_gpr_idx_off
    v_mfma_f32_16x16x32_bf16 a[176:179], v[180:183], v[120:123], a[176:179]
    v_pk_fma_f32 v[68:69], v[44:45], v[44:45], v[34:35] op_sel:[1,1,0] op_sel_hi:[1,0,1] neg_lo:[0,1,0]
    v_pk_fma_f32 v[70:71], v[60:61], v[60:61], v[50:51] op_sel:[1,1,0] op_sel_hi:[1,0,1] neg_lo:[0,1,0]
    v_mfma_f32_16x16x32_bf16 a[180:183], v[180:183], v[124:127], a[180:183]
    v_cndmask_b32_e64 v72, 1.0, v68, s[36:37]
    v_cndmask_b32_e64 v74, 1.0, v70, s[36:37]
    v_mfma_f32_16x16x32_bf16 a[184:187], v[180:183], v[128:131], a[184:187]
    v_mfma_f32_16x16x32_bf16 v[2:5], v[240:243], v[244:247], v[2:5]
    v_cndmask_b32_e64 v73, 0, v69, s[36:37]
    v_cndmask_b32_e64 v75, 0, v71, s[36:37]
    v_mfma_f32_16x16x32_bf16 a[188:191], v[180:183], v[132:135], a[188:191]
    v_pk_mul_f32 v[34:35], v[68:69], v[68:69] op_sel:[0,0] op_sel_hi:[0,1]
    v_pk_mul_f32 v[50:51], v[70:71], v[70:71] op_sel:[0,0] op_sel_hi:[0,1]
    v_mfma_f32_16x16x32_bf16 a[80:83], v[156:159], v[120:123], a[80:83]
    v_pk_fma_f32 v[44:45], v[68:69], v[68:69], v[34:35] op_sel:[1,1,0] op_sel_hi:[1,0,1] neg_lo:[0,1,0]
    v_pk_fma_f32 v[60:61], v[70:71], v[70:71], v[50:51] op_sel:[1,1,0] op_sel_hi:[1,0,1] neg_lo:[0,1,0]
    v_mfma_f32_16x16x32_bf16 a[84:87], v[156:159], v[124:127], a[84:87]
    v_pk_mul_f32 v[34:35], v[72:73], v[44:45] op_sel:[0,0] op_sel_hi:[0,1]
    v_pk_mul_f32 v[50:51], v[74:75], v[60:61] op_sel:[0,0] op_sel_hi:[0,1]
    v_mfma_f32_16x16x32_bf16 a[88:91], v[156:159], v[128:131], a[88:91]
    v_pk_fma_f32 v[46:47], v[72:73], v[44:45], v[34:35] op_sel:[1,1,0] op_sel_hi:[1,0,1] neg_lo:[0,1,0]
    v_pk_fma_f32 v[62:63], v[74:75], v[60:61], v[50:51] op_sel:[1,1,0] op_sel_hi:[1,0,1] neg_lo:[0,1,0]
    v_mfma_f32_16x16x32_bf16 a[92:95], v[156:159], v[132:135], a[92:95]
    v_cndmask_b32_e64 v72, v72, v46, s[38:39]
    v_cndmask_b32_e64 v74, v74, v62, s[38:39]
    v_mfma_f32_16x16x32_bf16 a[192:195], v[184:187], v[120:123], a[192:195]
    v_cndmask_b32_e64 v73, v73, v47, s[38:39]
    v_cndmask_b32_e64 v75, v75, v63, s[38:39]
    s_waitcnt vmcnt(5)
    s_nop 0
    v_and_b32 v95, 0xffff0000, v7
    v_mfma_f32_16x16x32_bf16 a[196:199], v[184:187], v[124:127], a[196:199]
    v_pk_mul_f32 v[34:35], v[44:45], v[44:45] op_sel:[0,0] op_sel_hi:[0,1]
    v_pk_mul_f32 v[50:51], v[60:61], v[60:61] op_sel:[0,0] op_sel_hi:[0,1]
    v_lshlrev_b32_e64 v96, 16, v7
    v_mfma_f32_16x16x32_bf16 a[200:203], v[184:187], v[128:131], a[200:203]
    v_pk_fma_f32 v[44:45], v[44:45], v[44:45], v[34:35] op_sel:[1,1,0] op_sel_hi:[1,0,1] neg_lo:[0,1,0]
    v_pk_fma_f32 v[60:61], v[60:61], v[60:61], v[50:51] op_sel:[1,1,0] op_sel_hi:[1,0,1] neg_lo:[0,1,0]
    v_rcp_f32_e64 v94, v95
    v_mfma_f32_16x16x32_bf16 a[204:207], v[184:187], v[132:135], a[204:207]
    v_pk_mul_f32 v[34:35], v[72:73], v[44:45] op_sel:[0,0] op_sel_hi:[0,1]
    v_pk_mul_f32 v[50:51], v[74:75], v[60:61] op_sel:[0,0] op_sel_hi:[0,1]
    ds_write_b32 v90, v96 offset:6144
    v_mfma_f32_16x16x32_bf16 a[96:99], v[160:163], v[120:123], a[96:99]
    v_pk_fma_f32 v[46:47], v[72:73], v[44:45], v[34:35] op_sel:[1,1,0] op_sel_hi:[1,0,1] neg_lo:[0,1,0]
    v_pk_fma_f32 v[62:63], v[74:75], v[60:61], v[50:51] op_sel:[1,1,0] op_sel_hi:[1,0,1] neg_lo:[0,1,0]
    ds_write_b32 v91, v96 offset:8192
    v_mfma_f32_16x16x32_bf16 a[100:103], v[160:163], v[124:127], a[100:103]
    s_set_gpr_idx_on s96, gpr_idx(SRC0)
    v_mov_b64 v[240:241], v[184:185]
    v_mov_b64 v[242:243], v[186:187]
    s_set_gpr_idx_off
    v_mfma_f32_16x16x32_bf16 a[104:107], v[160:163], v[128:131], a[104:107]
    v_cndmask_b32_e64 v72, v72, v46, s[40:41]
    v_cndmask_b32_e64 v74, v74, v62, s[40:41]
    ds_write_b32 v91, v95 offset:10240
    v_mfma_f32_16x16x32_bf16 a[108:111], v[160:163], v[132:135], a[108:111]
    v_cndmask_b32_e64 v73, v73, v47, s[40:41]
    v_cndmask_b32_e64 v75, v75, v63, s[40:41]
    v_fma_f32 v93, -v95, v94, 1.0
    v_mfma_f32_16x16x32_bf16 a[208:211], v[188:191], v[120:123], a[208:211]
    v_mfma_f32_16x16x32_bf16 v[28:31], v[240:243], v[244:247], v[28:31]
    v_pk_mul_f32 v[34:35], v[44:45], v[44:45] op_sel:[0,0] op_sel_hi:[0,1]
    v_pk_mul_f32 v[50:51], v[60:61], v[60:61] op_sel:[0,0] op_sel_hi:[0,1]
    v_fma_f32 v94, v93, v94, v94
    v_mfma_f32_16x16x32_bf16 a[212:215], v[188:191], v[124:127], a[212:215]
    v_pk_fma_f32 v[44:45], v[44:45], v[44:45], v[34:35] op_sel:[1,1,0] op_sel_hi:[1,0,1] neg_lo:[0,1,0]
    v_pk_fma_f32 v[60:61], v[60:61], v[60:61], v[50:51] op_sel:[1,1,0] op_sel_hi:[1,0,1] neg_lo:[0,1,0]
    v_mul_f32 v93, 3216550459, v94
    v_mfma_f32_16x16x32_bf16 a[216:219], v[188:191], v[128:131], a[216:219]
    v_pk_mul_f32 v[34:35], v[72:73], v[44:45] op_sel:[0,0] op_sel_hi:[0,1]
    v_pk_mul_f32 v[50:51], v[74:75], v[60:61] op_sel:[0,0] op_sel_hi:[0,1]
    ds_write_b32 v90, v94 offset:7168
    v_mfma_f32_16x16x32_bf16 a[220:223], v[188:191], v[132:135], a[220:223]
    v_pk_fma_f32 v[46:47], v[72:73], v[44:45], v[34:35] op_sel:[1,1,0] op_sel_hi:[1,0,1] neg_lo:[0,1,0]
    v_pk_fma_f32 v[62:63], v[74:75], v[60:61], v[50:51] op_sel:[1,1,0] op_sel_hi:[1,0,1] neg_lo:[0,1,0]
    ds_write_b32 v91, v93 offset:9216
    v_mfma_f32_16x16x32_bf16 a[224:227], v[120:123], v[192:195], a[224:227]
    v_cndmask_b32_e64 v72, v72, v46, s[42:43]
    v_cndmask_b32_e64 v74, v74, v62, s[42:43]
    v_mfma_f32_16x16x32_bf16 a[240:243], v[124:127], v[192:195], a[240:243]
    v_cndmask_b32_e64 v73, v73, v47, s[42:43]
    v_cndmask_b32_e64 v75, v75, v63, s[42:43]
    v_mfma_f32_16x16x32_bf16 v[208:211], v[128:131], v[192:195], v[208:211]
    v_pk_mul_f32 v[34:35], v[44:45], v[44:45] op_sel:[0,0] op_sel_hi:[0,1]
    v_pk_mul_f32 v[50:51], v[60:61], v[60:61] op_sel:[0,0] op_sel_hi:[0,1]
    v_mfma_f32_16x16x32_bf16 v[224:227], v[132:135], v[192:195], v[224:227]
    v_pk_fma_f32 v[76:77], v[44:45], v[44:45], v[34:35] op_sel:[1,1,0] op_sel_hi:[1,0,1] neg_lo:[0,1,0]
    v_pk_fma_f32 v[78:79], v[60:61], v[60:61], v[50:51] op_sel:[1,1,0] op_sel_hi:[1,0,1] neg_lo:[0,1,0]
    v_mfma_f32_16x16x32_bf16 a[228:231], v[120:123], v[196:199], a[228:231]
    v_mfma_f32_16x16x32_bf16 a[244:247], v[124:127], v[196:199], a[244:247]
    v_mfma_f32_16x16x32_bf16 v[212:215], v[128:131], v[196:199], v[212:215]
    v_mfma_f32_16x16x32_bf16 v[228:231], v[132:135], v[196:199], v[228:231]
    s_set_gpr_idx_on s96, gpr_idx(SRC0)
    v_mov_b64 v[240:241], v[200:201]
    v_mov_b64 v[242:243], v[202:203]
    s_set_gpr_idx_off
    v_mfma_f32_16x16x32_bf16 a[232:235], v[120:123], v[200:203], a[232:235]
    v_mfma_f32_16x16x32_bf16 a[248:251], v[124:127], v[200:203], a[248:251]
    v_mfma_f32_16x16x32_bf16 v[216:219], v[128:131], v[200:203], v[216:219]
    v_mfma_f32_16x16x32_bf16 v[252:255], v[240:243], v[244:247], v[252:255]
    v_mfma_f32_16x16x32_bf16 v[232:235], v[132:135], v[200:203], v[232:235]
    v_mfma_f32_16x16x32_bf16 a[236:239], v[120:123], v[204:207], a[236:239]
    v_mfma_f32_16x16x32_bf16 a[252:255], v[124:127], v[204:207], a[252:255]
    v_mfma_f32_16x16x32_bf16 v[220:223], v[128:131], v[204:207], v[220:223]
    v_mfma_f32_16x16x32_bf16 v[236:239], v[132:135], v[204:207], v[236:239]
    s_nop 7
    s_nop 1
    s_waitcnt vmcnt(0)
    s_nop 0
    s_mov_b32 s42, 0x10000
L_k1_fchk:
    v_max3_u32 v98, v100, v101, v102
    v_max3_u32 v98, v103, v104, v98
    v_max3_u32 v98, v105, v106, v98
    v_max3_u32 v98, v107, v108, v98
    v_max3_u32 v98, v109, v110, v98
    v_max3_u32 v98, v111, v112, v98
    v_max3_u32 v98, v113, v114, v98
    v_max3_u32 v98, v115, v116, v98
    v_max3_u32 v98, v117, v118, v98
    v_max_u32 v98, v119, v98
    v_cmp_ne_u32 vcc, -1, v98
    s_and_b64 vcc, vcc, s[68:69]
    s_sub_u32 s42, s42, 1
    s_cbranch_scc1 L_k1_fok
    s_cmp_eq_u64 vcc, -1
    s_cbranch_scc1 L_k1_fok
    v_and_b32 v98, 63, v0
    v_lshlrev_b32_e64 v98, 2, v98
    buffer_load_dword v99, v98, s[60:63], 0 offen sc1
    s_waitcnt vmcnt(0)
    v_and_b32 v99, s86, v99
    v_cmp_eq_u32_e64 s[68:69], s86, v99
    v_lshlrev_b32_e64 v98, 2, v0
    buffer_load_dword v7, v98, s[8:11], s101 offen sc1
    buffer_load_dwordx4 v[100:103], v22, s[8:11], s34 offen offset:0 sc1
    buffer_load_dwordx4 v[104:107], v22, s[8:11], s34 offen offset:256 sc1
    buffer_load_dwordx4 v[108:111], v22, s[8:11], s34 offen offset:512 sc1
    buffer_load_dwordx4 v[112:115], v22, s[8:11], s34 offen offset:768 sc1
    buffer_load_dwordx4 v[116:119], v22, s[8:11], s35 offen offset:1024 sc1
    s_waitcnt vmcnt(0)
    s_nop 0
    v_and_b32 v95, 0xffff0000, v7
    v_lshlrev_b32 v96, 16, v7
    v_rcp_f32 v94, v95
    ds_write_b32 v90, v96 offset:6144
    ds_write_b32 v91, v96 offset:8192
    ds_write_b32 v91, v95 offset:10240
    v_fma_f32 v93, -v95, v94, 1.0
    v_fma_f32 v94, v93, v94, v94
    s_nop 0
    s_nop 0
    v_mul_f32 v93, 3216550459, v94
    ds_write_b32 v90, v94 offset:7168
    s_nop 0
    s_nop 0
    ds_write_b32 v91, v93 offset:9216
    s_branch L_k1_fchk
L_k1_fok:
    s_lshl_b32 s36, s31, 6
    s_add_u32 s36, s36, 4096
    v_add_u32_e64 v97, s36, v22
    v_pk_add_f32 v[100:101], v[100:101], v[248:249]
    v_pk_add_f32 v[102:103], v[102:103], v[250:251]
    v_pk_add_f32 v[104:105], v[104:105], v[24:25]
    v_pk_add_f32 v[106:107], v[106:107], v[26:27]
    v_pk_add_f32 v[108:109], v[108:109], v[2:3]
    v_pk_add_f32 v[110:111], v[110:111], v[4:5]
    v_pk_add_f32 v[112:113], v[112:113], v[28:29]
    v_pk_add_f32 v[114:115], v[114:115], v[30:31]
    v_pk_add_f32 v[116:117], v[116:117], v[252:253]
    v_pk_add_f32 v[118:119], v[118:119], v[254:255]
    s_mov_b32 exec_lo, 0x00010001
    s_mov_b32 exec_hi, 0x00010001
    ds_write_b128 v97, v[100:103] offset:0
    ds_write_b128 v97, v[104:107] offset:256
    ds_write_b128 v97, v[108:111] offset:512
    ds_write_b128 v97, v[112:115] offset:768
    ds_write_b128 v97, v[116:119] offset:1024
    s_mov_b64 exec, -1
    v_mov_b64 v[240:241], v[64:65]
    v_mov_b64 v[242:243], v[66:67]
    v_mov_b64 v[244:245], v[68:69]
    v_mov_b64 v[246:247], v[70:71]
    v_mov_b64 v[248:249], v[72:73]
    v_mov_b64 v[250:251], v[74:75]
    v_mov_b64 v[252:253], v[76:77]
    v_mov_b64 v[254:255], v[78:79]
    s_nop 0
    v_accvgpr_read_b32 v32, a224
    v_accvgpr_read_b32 v33, a225
    v_accvgpr_read_b32 v34, a226
    v_accvgpr_read_b32 v35, a227
    v_accvgpr_read_b32 v36, a228
    v_accvgpr_read_b32 v37, a229
    v_accvgpr_read_b32 v38, a230
    v_accvgpr_read_b32 v39, a231
    v_accvgpr_read_b32 v40, a232
    v_accvgpr_read_b32 v41, a233
    v_accvgpr_read_b32 v42, a234
    v_accvgpr_read_b32 v43, a235
    v_accvgpr_read_b32 v44, a236
    v_accvgpr_read_b32 v45, a237
    v_accvgpr_read_b32 v46, a238
    v_accvgpr_read_b32 v47, a239
    v_accvgpr_read_b32 v48, a240
    v_accvgpr_read_b32 v49, a241
    v_accvgpr_read_b32 v50, a242
    v_accvgpr_read_b32 v51, a243
    v_accvgpr_read_b32 v52, a244
    v_accvgpr_read_b32 v53, a245
    v_accvgpr_read_b32 v54, a246
    v_accvgpr_read_b32 v55, a247
    v_accvgpr_read_b32 v56, a248
    v_accvgpr_read_b32 v57, a249
    v_accvgpr_read_b32 v58, a250
    v_accvgpr_read_b32 v59, a251
    v_accvgpr_read_b32 v60, a252
    v_accvgpr_read_b32 v61, a253
    v_accvgpr_read_b32 v62, a254
    v_accvgpr_read_b32 v63, a255
    s_waitcnt lgkmcnt(0)
    s_barrier
    v_and_b32 v88, 15, v0
    v_lshlrev_b32 v88, 2, v88
    v_lshrrev_b32 v89, 4, v0
    v_lshlrev_b32 v89, 6, v89
    ds_read_b32 v140, v88 offset:4992
    ds_read_b32 v141, v88 offset:5056
    ds_read_b32 v142, v88 offset:5120
    ds_read_b32 v143, v88 offset:5184
    ds_read_b128 v[144:147], v89 offset:6144
    ds_read_b128 v[160:163], v89 offset:7168
    ds_read_b128 v[148:151], v89 offset:6160
    ds_read_b128 v[164:167], v89 offset:7184
    ds_read_b128 v[152:155], v89 offset:6176
    ds_read_b128 v[168:171], v89 offset:7200
    ds_read_b128 v[156:159], v89 offset:6192
    ds_read_b128 v[172:175], v89 offset:7216
    s_waitcnt lgkmcnt(6)
    s_nop 0
    v_pk_fma_f32 v[32:33], v[144:145], v[140:141], v[32:33] op_sel:[0,0,0] op_sel_hi:[1,0,1] neg_lo:[0,1,0] neg_hi:[0,1,0]
    v_pk_fma_f32 v[34:35], v[146:147], v[140:141], v[34:35] op_sel:[0,0,0] op_sel_hi:[1,0,1] neg_lo:[0,1,0] neg_hi:[0,1,0]
    v_pk_fma_f32 v[36:37], v[144:145], v[140:141], v[36:37] op_sel:[0,1,0] op_sel_hi:[1,1,1] neg_lo:[0,1,0] neg_hi:[0,1,0]
    v_pk_fma_f32 v[38:39], v[146:147], v[140:141], v[38:39] op_sel:[0,1,0] op_sel_hi:[1,1,1] neg_lo:[0,1,0] neg_hi:[0,1,0]
    v_pk_fma_f32 v[40:41], v[144:145], v[142:143], v[40:41] op_sel:[0,0,0] op_sel_hi:[1,0,1] neg_lo:[0,1,0] neg_hi:[0,1,0]
    v_pk_fma_f32 v[42:43], v[146:147], v[142:143], v[42:43] op_sel:[0,0,0] op_sel_hi:[1,0,1] neg_lo:[0,1,0] neg_hi:[0,1,0]
    v_pk_fma_f32 v[44:45], v[144:145], v[142:143], v[44:45] op_sel:[0,1,0] op_sel_hi:[1,1,1] neg_lo:[0,1,0] neg_hi:[0,1,0]
    v_pk_fma_f32 v[46:47], v[146:147], v[142:143], v[46:47] op_sel:[0,1,0] op_sel_hi:[1,1,1] neg_lo:[0,1,0] neg_hi:[0,1,0]
    v_pk_mul_f32 v[32:33], v[32:33], v[160:161]
    v_pk_mul_f32 v[34:35], v[34:35], v[162:163]
    v_pk_mul_f32 v[36:37], v[36:37], v[160:161]
    v_pk_mul_f32 v[38:39], v[38:39], v[162:163]
    v_pk_mul_f32 v[40:41], v[40:41], v[160:161]
    v_pk_mul_f32 v[42:43], v[42:43], v[162:163]
    v_pk_mul_f32 v[44:45], v[44:45], v[160:161]
    v_pk_mul_f32 v[46:47], v[46:47], v[162:163]
    s_waitcnt lgkmcnt(4)
    s_nop 0
    v_pk_fma_f32 v[48:49], v[148:149], v[140:141], v[48:49] op_sel:[0,0,0] op_sel_hi:[1,0,1] neg_lo:[0,1,0] neg_hi:[0,1,0]
    v_pk_fma_f32 v[50:51], v[150:151], v[140:141], v[50:51] op_sel:[0,0,0] op_sel_hi:[1,0,1] neg_lo:[0,1,0] neg_hi:[0,1,0]
    v_pk_fma_f32 v[52:53], v[148:149], v[140:141], v[52:53] op_sel:[0,1,0] op_sel_hi:[1,1,1] neg_lo:[0,1,0] neg_hi:[0,1,0]
    v_pk_fma_f32 v[54:55], v[150:151], v[140:141], v[54:55] op_sel:[0,1,0] op_sel_hi:[1,1,1] neg_lo:[0,1,0] neg_hi:[0,1,0]
    v_pk_fma_f32 v[56:57], v[148:149], v[142:143], v[56:57] op_sel:[0,0,0] op_sel_hi:[1,0,1] neg_lo:[0,1,0] neg_hi:[0,1,0]
    v_pk_fma_f32 v[58:59], v[150:151], v[142:143], v[58:59] op_sel:[0,0,0] op_sel_hi:[1,0,1] neg_lo:[0,1,0] neg_hi:[0,1,0]
    v_pk_fma_f32 v[60:61], v[148:149], v[142:143], v[60:61] op_sel:[0,1,0] op_sel_hi:[1,1,1] neg_lo:[0,1,0] neg_hi:[0,1,0]
    v_pk_fma_f32 v[62:63], v[150:151], v[142:143], v[62:63] op_sel:[0,1,0] op_sel_hi:[1,1,1] neg_lo:[0,1,0] neg_hi:[0,1,0]
    v_pk_mul_f32 v[48:49], v[48:49], v[164:165]
    v_pk_mul_f32 v[50:51], v[50:51], v[166:167]
    v_pk_mul_f32 v[52:53], v[52:53], v[164:165]
    v_pk_mul_f32 v[54:55], v[54:55], v[166:167]
    v_pk_mul_f32 v[56:57], v[56:57], v[164:165]
    v_pk_mul_f32 v[58:59], v[58:59], v[166:167]
    v_pk_mul_f32 v[60:61], v[60:61], v[164:165]
    v_pk_mul_f32 v[62:63], v[62:63], v[166:167]
    s_waitcnt lgkmcnt(2)
    s_nop 0
    v_pk_fma_f32 v[208:209], v[152:153], v[140:141], v[208:209] op_sel:[0,0,0] op_sel_hi:[1,0,1] neg_lo:[0,1,0] neg_hi:[0,1,0]
    v_pk_fma_f32 v[210:211], v[154:155], v[140:141], v[210:211] op_sel:[0,0,0] op_sel_hi:[1,0,1] neg_lo:[0,1,0] neg_hi:[0,1,0]
    v_pk_fma_f32 v[212:213], v[152:153], v[140:141], v[212:213] op_sel:[0,1,0] op_sel_hi:[1,1,1] neg_lo:[0,1,0] neg_hi:[0,1,0]
    v_pk_fma_f32 v[214:215], v[154:155], v[140:141], v[214:215] op_sel:[0,1,0] op_sel_hi:[1,1,1] neg_lo:[0,1,0] neg_hi:[0,1,0]
    v_pk_fma_f32 v[216:217], v[152:153], v[142:143], v[216:217] op_sel:[0,0,0] op_sel_hi:[1,0,1] neg_lo:[0,1,0] neg_hi:[0,1,0]
    v_pk_fma_f32 v[218:219], v[154:155], v[142:143], v[218:219] op_sel:[0,0,0] op_sel_hi:[1,0,1] neg_lo:[0,1,0] neg_hi:[0,1,0]
    v_pk_fma_f32 v[220:221], v[152:153], v[142:143], v[220:221] op_sel:[0,1,0] op_sel_hi:[1,1,1] neg_lo:[0,1,0] neg_hi:[0,1,0]
    v_pk_fma_f32 v[222:223], v[154:155], v[142:143], v[222:223] op_sel:[0,1,0] op_sel_hi:[1,1,1] neg_lo:[0,1,0] neg_hi:[0,1,0]
    v_pk_mul_f32 v[208:209], v[208:209], v[168:169]
    v_pk_mul_f32 v[210:211], v[210:211], v[170:171]
    v_pk_mul_f32 v[212:213], v[212:213], v[168:169]
    v_pk_mul_f32 v[214:215], v[214:215], v[170:171]
    v_pk_mul_f32 v[216:217], v[216:217], v[168:169]
    v_pk_mul_f32 v[218:219], v[218:219], v[170:171]
    v_pk_mul_f32 v[220:221], v[220:221], v[168:169]
    v_pk_mul_f32 v[222:223], v[222:223], v[170:171]
    s_waitcnt lgkmcnt(0)
    s_nop 0
    v_pk_fma_f32 v[224:225], v[156:157], v[140:141], v[224:225] op_sel:[0,0,0] op_sel_hi:[1,0,1] neg_lo:[0,1,0] neg_hi:[0,1,0]
    v_pk_fma_f32 v[226:227], v[158:159], v[140:141], v[226:227] op_sel:[0,0,0] op_sel_hi:[1,0,1] neg_lo:[0,1,0] neg_hi:[0,1,0]
    v_pk_fma_f32 v[228:229], v[156:157], v[140:141], v[228:229] op_sel:[0,1,0] op_sel_hi:[1,1,1] neg_lo:[0,1,0] neg_hi:[0,1,0]
    v_pk_fma_f32 v[230:231], v[158:159], v[140:141], v[230:231] op_sel:[0,1,0] op_sel_hi:[1,1,1] neg_lo:[0,1,0] neg_hi:[0,1,0]
    v_pk_fma_f32 v[232:233], v[156:157], v[142:143], v[232:233] op_sel:[0,0,0] op_sel_hi:[1,0,1] neg_lo:[0,1,0] neg_hi:[0,1,0]
    v_pk_fma_f32 v[234:235], v[158:159], v[142:143], v[234:235] op_sel:[0,0,0] op_sel_hi:[1,0,1] neg_lo:[0,1,0] neg_hi:[0,1,0]
    v_pk_fma_f32 v[236:237], v[156:157], v[142:143], v[236:237] op_sel:[0,1,0] op_sel_hi:[1,1,1] neg_lo:[0,1,0] neg_hi:[0,1,0]
    v_pk_fma_f32 v[238:239], v[158:159], v[142:143], v[238:239] op_sel:[0,1,0] op_sel_hi:[1,1,1] neg_lo:[0,1,0] neg_hi:[0,1,0]
    v_pk_mul_f32 v[224:225], v[224:225], v[172:173]
    v_pk_mul_f32 v[226:227], v[226:227], v[174:175]
    v_pk_mul_f32 v[228:229], v[228:229], v[172:173]
    v_pk_mul_f32 v[230:231], v[230:231], v[174:175]
    v_pk_mul_f32 v[232:233], v[232:233], v[172:173]
    v_pk_mul_f32 v[234:235], v[234:235], v[174:175]
    v_pk_mul_f32 v[236:237], v[236:237], v[172:173]
    v_pk_mul_f32 v[238:239], v[238:239], v[174:175]
    v_mov_b32 v64, v32
    v_mov_b32 v65, v40
    v_mov_b32 v66, v36
    v_mov_b32 v67, v44
    v_fma_f32 v68, v240, v64, v33
    v_fma_f32 v69, v240, v65, v41
    v_fma_f32 v70, v242, v66, v37
    v_fma_f32 v71, v242, v67, v45
    v_fma_f32 v68, -v241, v65, v68
    v_fma_f32 v65, v241, v64, v69
    v_mov_b32_e64 v64, v68
    v_fma_f32 v70, -v243, v67, v70
    v_fma_f32 v67, v243, v66, v71
    v_mov_b32_e64 v66, v70
    v_fma_f32 v68, v240, v64, v34
    v_fma_f32 v69, v240, v65, v42
    v_fma_f32 v70, v242, v66, v38
    v_fma_f32 v71, v242, v67, v46
    v_fma_f32 v68, -v241, v65, v68
    v_fma_f32 v65, v241, v64, v69
    v_mov_b32_e64 v64, v68
    v_fma_f32 v70, -v243, v67, v70
    v_fma_f32 v67, v243, v66, v71
    v_mov_b32_e64 v66, v70
    v_fma_f32 v68, v240, v64, v35
    v_fma_f32 v69, v240, v65, v43
    v_fma_f32 v70, v242, v66, v39
    v_fma_f32 v71, v242, v67, v47
    v_fma_f32 v68, -v241, v65, v68
    v_fma_f32 v65, v241, v64, v69
    v_mov_b32_e64 v64, v68
    v_fma_f32 v70, -v243, v67, v70
    v_fma_f32 v67, v243, v66, v71
    v_mov_b32_e64 v66, v70
    v_fma_f32 v68, v240, v64, v48
    v_fma_f32 v69, v240, v65, v56
    v_fma_f32 v70, v242, v66, v52
    v_fma_f32 v71, v242, v67, v60
    v_fma_f32 v68, -v241, v65, v68
    v_fma_f32 v65, v241, v64, v69
    v_mov_b32_e64 v64, v68
    v_fma_f32 v70, -v243, v67, v70
    v_fma_f32 v67, v243, v66, v71
    v_mov_b32_e64 v66, v70
    v_fma_f32 v68, v240, v64, v49
    v_fma_f32 v69, v240, v65, v57
    v_fma_f32 v70, v242, v66, v53
    v_fma_f32 v71, v242, v67, v61
    v_fma_f32 v68, -v241, v65, v68
    v_fma_f32 v65, v241, v64, v69
    v_mov_b32_e64 v64, v68
    v_fma_f32 v70, -v243, v67, v70
    v_fma_f32 v67, v243, v66, v71
    v_mov_b32_e64 v66, v70
    v_fma_f32 v68, v240, v64, v50
    v_fma_f32 v69, v240, v65, v58
    v_fma_f32 v70, v242, v66, v54
    v_fma_f32 v71, v242, v67, v62
    v_fma_f32 v68, -v241, v65, v68
    v_fma_f32 v65, v241, v64, v69
    v_mov_b32_e64 v64, v68
    v_fma_f32 v70, -v243, v67, v70
    v_fma_f32 v67, v243, v66, v71
    v_mov_b32_e64 v66, v70
    v_fma_f32 v68, v240, v64, v51
    v_fma_f32 v69, v240, v65, v59
    v_fma_f32 v70, v242, v66, v55
    v_fma_f32 v71, v242, v67, v63
    v_fma_f32 v68, -v241, v65, v68
    v_fma_f32 v65, v241, v64, v69
    v_mov_b32_e64 v64, v68
    v_fma_f32 v70, -v243, v67, v70
    v_fma_f32 v67, v243, v66, v71
    v_mov_b32_e64 v66, v70
    v_fma_f32 v68, v240, v64, v208
    v_fma_f32 v69, v240, v65, v216
    v_fma_f32 v70, v242, v66, v212
    v_fma_f32 v71, v242, v67, v220
    v_fma_f32 v68, -v241, v65, v68
    v_fma_f32 v65, v241, v64, v69
    v_mov_b32_e64 v64, v68
    v_fma_f32 v70, -v243, v67, v70
    v_fma_f32 v67, v243, v66, v71
    v_mov_b32_e64 v66, v70
    v_fma_f32 v68, v240, v64, v209
    v_fma_f32 v69, v240, v65, v217
    v_fma_f32 v70, v242, v66, v213
    v_fma_f32 v71, v242, v67, v221
    v_fma_f32 v68, -v241, v65, v68
    v_fma_f32 v65, v241, v64, v69
    v_mov_b32_e64 v64, v68
    v_fma_f32 v70, -v243, v67, v70
    v_fma_f32 v67, v243, v66, v71
    v_mov_b32_e64 v66, v70
    v_fma_f32 v68, v240, v64, v210
    v_fma_f32 v69, v240, v65, v218
    v_fma_f32 v70, v242, v66, v214
    v_fma_f32 v71, v242, v67, v222
    v_fma_f32 v68, -v241, v65, v68
    v_fma_f32 v65, v241, v64, v69
    v_mov_b32_e64 v64, v68
    v_fma_f32 v70, -v243, v67, v70
    v_fma_f32 v67, v243, v66, v71
    v_mov_b32_e64 v66, v70
    v_fma_f32 v68, v240, v64, v211
    v_fma_f32 v69, v240, v65, v219
    v_fma_f32 v70, v242, v66, v215
    v_fma_f32 v71, v242, v67, v223
    v_fma_f32 v68, -v241, v65, v68
    v_fma_f32 v65, v241, v64, v69
    v_mov_b32_e64 v64, v68
    v_fma_f32 v70, -v243, v67, v70
    v_fma_f32 v67, v243, v66, v71
    v_mov_b32_e64 v66, v70
    v_fma_f32 v68, v240, v64, v224
    v_fma_f32 v69, v240, v65, v232
    v_fma_f32 v70, v242, v66, v228
    v_fma_f32 v71, v242, v67, v236
    v_fma_f32 v68, -v241, v65, v68
    v_fma_f32 v65, v241, v64, v69
    v_mov_b32_e64 v64, v68
    v_fma_f32 v70, -v243, v67, v70
    v_fma_f32 v67, v243, v66, v71
    v_mov_b32_e64 v66, v70
    v_fma_f32 v68, v240, v64, v225
    v_fma_f32 v69, v240, v65, v233
    v_fma_f32 v70, v242, v66, v229
    v_fma_f32 v71, v242, v67, v237
    v_fma_f32 v68, -v241, v65, v68
    v_fma_f32 v65, v241, v64, v69
    v_mov_b32_e64 v64, v68
    v_fma_f32 v70, -v243, v67, v70
    v_fma_f32 v67, v243, v66, v71
    v_mov_b32_e64 v66, v70
    v_fma_f32 v68, v240, v64, v226
    v_fma_f32 v69, v240, v65, v234
    v_fma_f32 v70, v242, v66, v230
    v_fma_f32 v71, v242, v67, v238
    v_fma_f32 v68, -v241, v65, v68
    v_fma_f32 v65, v241, v64, v69
    v_mov_b32_e64 v64, v68
    v_fma_f32 v70, -v243, v67, v70
    v_fma_f32 v67, v243, v66, v71
    v_mov_b32_e64 v66, v70
    v_fma_f32 v68, v240, v64, v227
    v_fma_f32 v69, v240, v65, v235
    v_fma_f32 v70, v242, v66, v231
    v_fma_f32 v71, v242, v67, v239
    v_fma_f32 v68, -v241, v65, v68
    v_fma_f32 v65, v241, v64, v69
    v_mov_b32_e64 v64, v68
    v_fma_f32 v70, -v243, v67, v70
    v_fma_f32 v67, v243, v66, v71
    v_mov_b32 v66, v70
    v_lshlrev_b32 v72, 4, v0
    ds_write_b128 v72, v[64:67]
    s_waitcnt lgkmcnt(0)
    s_barrier
    v_and_b32 v72, 15, v0
    v_lshlrev_b32 v72, 4, v72
    ds_read_b128 v[80:83], v72 offset:0
    ds_read_b128 v[84:87], v72 offset:256
    ds_read_b128 v[88:91], v72 offset:512
    ds_read_b128 v[92:95], v72 offset:768
    ds_read_b128 v[96:99], v72 offset:1024
    ds_read_b128 v[100:103], v72 offset:1280
    ds_read_b128 v[104:107], v72 offset:1536
    ds_read_b128 v[108:111], v72 offset:1792
    ds_read_b128 v[112:115], v72 offset:2048
    ds_read_b128 v[116:119], v72 offset:2304
    ds_read_b128 v[120:123], v72 offset:2560
    ds_read_b128 v[124:127], v72 offset:2816
    ds_read_b128 v[128:131], v72 offset:3072
    ds_read_b128 v[132:135], v72 offset:3328
    ds_read_b128 v[136:139], v72 offset:3584
    v_lshrrev_b32 v73, 4, v0
    v_mov_b32 v74, 0
    v_mov_b32 v75, 0
    v_mov_b32 v76, 0
    v_mov_b32 v77, 0
    s_mov_b64 s[36:37], exec
    s_waitcnt lgkmcnt(0)
    v_cmpx_lt_u32 vcc, 0, v73
    v_fma_f32 v68, v244, v74, v80
    v_fma_f32 v69, v244, v75, v81
    v_fma_f32 v70, v246, v76, v82
    v_fma_f32 v71, v246, v77, v83
    v_fma_f32 v68, -v245, v75, v68
    v_fma_f32 v75, v245, v74, v69
    v_mov_b32_e64 v74, v68
    v_fma_f32 v70, -v247, v77, v70
    v_fma_f32 v77, v247, v76, v71
    v_mov_b32 v76, v70
    v_cmpx_lt_u32 vcc, 1, v73
    v_fma_f32 v68, v244, v74, v84
    v_fma_f32 v69, v244, v75, v85
    v_fma_f32 v70, v246, v76, v86
    v_fma_f32 v71, v246, v77, v87
    v_fma_f32 v68, -v245, v75, v68
    v_fma_f32 v75, v245, v74, v69
    v_mov_b32_e64 v74, v68
    v_fma_f32 v70, -v247, v77, v70
    v_fma_f32 v77, v247, v76, v71
    v_mov_b32 v76, v70
    v_cmpx_lt_u32 vcc, 2, v73
    v_fma_f32 v68, v244, v74, v88
    v_fma_f32 v69, v244, v75, v89
    v_fma_f32 v70, v246, v76, v90
    v_fma_f32 v71, v246, v77, v91
    v_fma_f32 v68, -v245, v75, v68
    v_fma_f32 v75, v245, v74, v69
    v_mov_b32_e64 v74, v68
    v_fma_f32 v70, -v247, v77, v70
    v_fma_f32 v77, v247, v76, v71
    v_mov_b32 v76, v70
    v_cmpx_lt_u32 vcc, 3, v73
    v_fma_f32 v68, v244, v74, v92
    v_fma_f32 v69, v244, v75, v93
    v_fma_f32 v70, v246, v76, v94
    v_fma_f32 v71, v246, v77, v95
    v_fma_f32 v68, -v245, v75, v68
    v_fma_f32 v75, v245, v74, v69
    v_mov_b32_e64 v74, v68
    v_fma_f32 v70, -v247, v77, v70
    v_fma_f32 v77, v247, v76, v71
    v_mov_b32 v76, v70
    v_cmpx_lt_u32 vcc, 4, v73
    v_fma_f32 v68, v244, v74, v96
    v_fma_f32 v69, v244, v75, v97
    v_fma_f32 v70, v246, v76, v98
    v_fma_f32 v71, v246, v77, v99
    v_fma_f32 v68, -v245, v75, v68
    v_fma_f32 v75, v245, v74, v69
    v_mov_b32_e64 v74, v68
    v_fma_f32 v70, -v247, v77, v70
    v_fma_f32 v77, v247, v76, v71
    v_mov_b32 v76, v70
    v_cmpx_lt_u32 vcc, 5, v73
    v_fma_f32 v68, v244, v74, v100
    v_fma_f32 v69, v244, v75, v101
    v_fma_f32 v70, v246, v76, v102
    v_fma_f32 v71, v246, v77, v103
    v_fma_f32 v68, -v245, v75, v68
    v_fma_f32 v75, v245, v74, v69
    v_mov_b32_e64 v74, v68
    v_fma_f32 v70, -v247, v77, v70
    v_fma_f32 v77, v247, v76, v71
    v_mov_b32 v76, v70
    v_cmpx_lt_u32 vcc, 6, v73
    v_fma_f32 v68, v244, v74, v104
    v_fma_f32 v69, v244, v75, v105
    v_fma_f32 v70, v246, v76, v106
    v_fma_f32 v71, v246, v77, v107
    v_fma_f32 v68, -v245, v75, v68
    v_fma_f32 v75, v245, v74, v69
    v_mov_b32_e64 v74, v68
    v_fma_f32 v70, -v247, v77, v70
    v_fma_f32 v77, v247, v76, v71
    v_mov_b32 v76, v70
    v_cmpx_lt_u32 vcc, 7, v73
    v_fma_f32 v68, v244, v74, v108
    v_fma_f32 v69, v244, v75, v109
    v_fma_f32 v70, v246, v76, v110
    v_fma_f32 v71, v246, v77, v111
    v_fma_f32 v68, -v245, v75, v68
    v_fma_f32 v75, v245, v74, v69
    v_mov_b32_e64 v74, v68
    v_fma_f32 v70, -v247, v77, v70
    v_fma_f32 v77, v247, v76, v71
    v_mov_b32 v76, v70
    v_cmpx_lt_u32 vcc, 8, v73
    v_fma_f32 v68, v244, v74, v112
    v_fma_f32 v69, v244, v75, v113
    v_fma_f32 v70, v246, v76, v114
    v_fma_f32 v71, v246, v77, v115
    v_fma_f32 v68, -v245, v75, v68
    v_fma_f32 v75, v245, v74, v69
    v_mov_b32_e64 v74, v68
    v_fma_f32 v70, -v247, v77, v70
    v_fma_f32 v77, v247, v76, v71
    v_mov_b32 v76, v70
    v_cmpx_lt_u32 vcc, 9, v73
    v_fma_f32 v68, v244, v74, v116
    v_fma_f32 v69, v244, v75, v117
    v_fma_f32 v70, v246, v76, v118
    v_fma_f32 v71, v246, v77, v119
    v_fma_f32 v68, -v245, v75, v68
    v_fma_f32 v75, v245, v74, v69
    v_mov_b32_e64 v74, v68
    v_fma_f32 v70, -v247, v77, v70
    v_fma_f32 v77, v247, v76, v71
    v_mov_b32 v76, v70
    v_cmpx_lt_u32 vcc, 10, v73
    v_fma_f32 v68, v244, v74, v120
    v_fma_f32 v69, v244, v75, v121
    v_fma_f32 v70, v246, v76, v122
    v_fma_f32 v71, v246, v77, v123
    v_fma_f32 v68, -v245, v75, v68
    v_fma_f32 v75, v245, v74, v69
    v_mov_b32_e64 v74, v68
    v_fma_f32 v70, -v247, v77, v70
    v_fma_f32 v77, v247, v76, v71
    v_mov_b32 v76, v70
    v_cmpx_lt_u32 vcc, 11, v73
    v_fma_f32 v68, v244, v74, v124
    v_fma_f32 v69, v244, v75, v125
    v_fma_f32 v70, v246, v76, v126
    v_fma_f32 v71, v246, v77, v127
    v_fma_f32 v68, -v245, v75, v68
    v_fma_f32 v75, v245, v74, v69
    v_mov_b32_e64 v74, v68
    v_fma_f32 v70, -v247, v77, v70
    v_fma_f32 v77, v247, v76, v71
    v_mov_b32 v76, v70
    v_cmpx_lt_u32 vcc, 12, v73
    v_fma_f32 v68, v244, v74, v128
    v_fma_f32 v69, v244, v75, v129
    v_fma_f32 v70, v246, v76, v130
    v_fma_f32 v71, v246, v77, v131
    v_fma_f32 v68, -v245, v75, v68
    v_fma_f32 v75, v245, v74, v69
    v_mov_b32_e64 v74, v68
    v_fma_f32 v70, -v247, v77, v70
    v_fma_f32 v77, v247, v76, v71
    v_mov_b32 v76, v70
    v_cmpx_lt_u32 vcc, 13, v73
    v_fma_f32 v68, v244, v74, v132
    v_fma_f32 v69, v244, v75, v133
    v_fma_f32 v70, v246, v76, v134
    v_fma_f32 v71, v246, v77, v135
    v_fma_f32 v68, -v245, v75, v68
    v_fma_f32 v75, v245, v74, v69
    v_mov_b32_e64 v74, v68
    v_fma_f32 v70, -v247, v77, v70
    v_fma_f32 v77, v247, v76, v71
    v_mov_b32 v76, v70
    v_cmpx_lt_u32 vcc, 14, v73
    v_fma_f32 v68, v244, v74, v136
    v_fma_f32 v69, v244, v75, v137
    v_fma_f32 v70, v246, v76, v138
    v_fma_f32 v71, v246, v77, v139
    v_fma_f32 v68, -v245, v75, v68
    v_fma_f32 v75, v245, v74, v69
    v_mov_b32_e64 v74, v68
    v_fma_f32 v70, -v247, v77, v70
    v_fma_f32 v77, v247, v76, v71
    v_mov_b32 v76, v70
    s_mov_b64 exec, s[36:37]
    v_fma_f32 v78, v244, v74, v64
    v_fma_f32 v79, v244, v75, v65
    v_fma_f32 v68, -v245, v75, v78
    v_fma_f32 v69, v245, v74, v79
    v_fma_f32 v78, v246, v76, v66
    v_fma_f32 v79, v246, v77, v67
    v_fma_f32 v70, -v247, v77, v78
    v_fma_f32 v71, v247, v76, v79
    s_cmp_lg_u32 s31, 3
    s_cbranch_scc1 L_k1_nopub
    s_lshl_b32 s34, s33, 3
    s_add_u32 s34, s34, s32
    s_lshl_b32 s35, s34, 8
    s_nop 0
    s_add_u32 s35, s35, 41943040
    v_cmp_lt_u32 vcc, 239, v0
    s_and_saveexec_b64 s[36:37], vcc
    s_nop 0
    buffer_store_dwordx4 v[68:71], v72, s[8:11], s35 offen sc1
    s_mov_b64 exec, s[36:37]
L_k1_nopub:
    v_and_b32 v81, 15, v0
    v_lshlrev_b32 v81, 4, v81
    s_lshl_b32 s36, s31, 8
    v_add_u32_e64 v81, s36, v81
    ds_read_b128 v[164:167], v81 offset:8192
    ds_read_b128 v[168:171], v81 offset:9216
    ds_read_b128 v[172:175], v81 offset:10240
    v_bfe_u32 v73, v0, 4, 2
    v_lshlrev_b32_e64 v73, 4, v73
    ds_read_b128 v[64:67], v73 offset:4096
    ds_read_b128 v[68:71], v73 offset:4544
    v_and_b32 v81, 63, v0
    v_lshlrev_b32_e64 v81, 4, v81
    s_lshl_b32 s35, s32, 14
    s_lshl_b32 s36, s31, 12
    s_add_u32 s35, s35, s36
    s_add_u32 s35, s35, 25165824
    s_mul_i32 s34, s33, 7
    s_add_u32 s38, s34, 6
    s_bitcmp1_b32 s33, 0
    s_cselect_b32 s38, s34, s38
    s_add_u32 s34, s34, 1
    s_lshr_b32 s34, s34, 1
    s_lshl_b32 s34, s34, 17
    s_add_u32 s34, s34, s35
    ds_read_b128 v[176:179], v73 offset:4160
    ds_read_b128 v[180:183], v73 offset:4608
    v_accvgpr_read_b32 v84, a0
    v_accvgpr_read_b32 v85, a1
    v_accvgpr_read_b32 v86, a2
    v_accvgpr_read_b32 v87, a3
    v_accvgpr_read_b32 v88, a4
    v_accvgpr_read_b32 v89, a5
    v_accvgpr_read_b32 v90, a6
    v_accvgpr_read_b32 v91, a7
    v_accvgpr_read_b32 v92, a8
    v_accvgpr_read_b32 v93, a9
    v_accvgpr_read_b32 v94, a10
    v_accvgpr_read_b32 v95, a11
    v_accvgpr_read_b32 v96, a12
    v_accvgpr_read_b32 v97, a13
    v_accvgpr_read_b32 v98, a14
    v_accvgpr_read_b32 v99, a15
    s_waitcnt lgkmcnt(2)
    s_nop 0
    v_pk_fma_f32 v[84:85], v[64:65], v[164:165], v[84:85] op_sel:[0,0,0] op_sel_hi:[1,0,1] neg_lo:[0,1,0] neg_hi:[0,1,0]
    v_pk_fma_f32 v[86:87], v[66:67], v[164:165], v[86:87] op_sel:[0,0,0] op_sel_hi:[1,0,1] neg_lo:[0,1,0] neg_hi:[0,1,0]
    v_pk_fma_f32 v[88:89], v[64:65], v[164:165], v[88:89] op_sel:[0,1,0] op_sel_hi:[1,1,1] neg_lo:[0,1,0] neg_hi:[0,1,0]
    v_pk_fma_f32 v[90:91], v[66:67], v[164:165], v[90:91] op_sel:[0,1,0] op_sel_hi:[1,1,1] neg_lo:[0,1,0] neg_hi:[0,1,0]
    v_pk_fma_f32 v[92:93], v[64:65], v[166:167], v[92:93] op_sel:[0,0,0] op_sel_hi:[1,0,1] neg_lo:[0,1,0] neg_hi:[0,1,0]
    v_pk_fma_f32 v[94:95], v[66:67], v[166:167], v[94:95] op_sel:[0,0,0] op_sel_hi:[1,0,1] neg_lo:[0,1,0] neg_hi:[0,1,0]
    v_pk_fma_f32 v[96:97], v[64:65], v[166:167], v[96:97] op_sel:[0,1,0] op_sel_hi:[1,1,1] neg_lo:[0,1,0] neg_hi:[0,1,0]
    v_pk_fma_f32 v[98:99], v[66:67], v[166:167], v[98:99] op_sel:[0,1,0] op_sel_hi:[1,1,1] neg_lo:[0,1,0] neg_hi:[0,1,0]
    v_pk_mul_f32 v[84:85], v[84:85], v[168:169] op_sel:[0,0] op_sel_hi:[1,0]
    v_pk_mul_f32 v[86:87], v[86:87], v[168:169] op_sel:[0,0] op_sel_hi:[1,0]
    v_pk_mul_f32 v[88:89], v[88:89], v[168:169] op_sel:[0,1] op_sel_hi:[1,1]
    v_pk_mul_f32 v[90:91], v[90:91], v[168:169] op_sel:[0,1] op_sel_hi:[1,1]
    v_pk_mul_f32 v[92:93], v[92:93], v[170:171] op_sel:[0,0] op_sel_hi:[1,0]
    v_pk_mul_f32 v[94:95], v[94:95], v[170:171] op_sel:[0,0] op_sel_hi:[1,0]
    v_pk_mul_f32 v[96:97], v[96:97], v[170:171] op_sel:[0,1] op_sel_hi:[1,1]
    v_pk_mul_f32 v[98:99], v[98:99], v[170:171] op_sel:[0,1] op_sel_hi:[1,1]
    v_exp_f32 v84, v84
    v_exp_f32 v85, v85
    v_exp_f32 v86, v86
    v_exp_f32 v87, v87
    v_exp_f32 v88, v88
    v_exp_f32 v89, v89
    v_exp_f32 v90, v90
    v_exp_f32 v91, v91
    v_exp_f32 v92, v92
    v_exp_f32 v93, v93
    v_exp_f32 v94, v94
    v_exp_f32 v95, v95
    v_exp_f32 v96, v96
    v_exp_f32 v97, v97
    v_exp_f32 v98, v98
    v_exp_f32 v99, v99
    v_accvgpr_read_b32 v100, a112
    v_accvgpr_read_b32 v101, a113
    v_accvgpr_read_b32 v102, a114
    v_accvgpr_read_b32 v103, a115
    v_accvgpr_read_b32 v104, a116
    v_accvgpr_read_b32 v105, a117
    v_accvgpr_read_b32 v106, a118
    v_accvgpr_read_b32 v107, a119
    v_accvgpr_read_b32 v108, a120
    v_accvgpr_read_b32 v109, a121
    v_accvgpr_read_b32 v110, a122
    v_accvgpr_read_b32 v111, a123
    v_accvgpr_read_b32 v112, a124
    v_accvgpr_read_b32 v113, a125
    v_accvgpr_read_b32 v114, a126
    v_accvgpr_read_b32 v115, a127
    v_pk_fma_f32 v[84:85], v[84:85], v[172:173], v[172:173] op_sel:[0,0,0] op_sel_hi:[1,0,0]
    v_pk_fma_f32 v[86:87], v[86:87], v[172:173], v[172:173] op_sel:[0,0,0] op_sel_hi:[1,0,0]
    v_pk_fma_f32 v[88:89], v[88:89], v[172:173], v[172:173] op_sel:[0,1,1] op_sel_hi:[1,1,1]
    v_pk_fma_f32 v[90:91], v[90:91], v[172:173], v[172:173] op_sel:[0,1,1] op_sel_hi:[1,1,1]
    v_pk_fma_f32 v[92:93], v[92:93], v[174:175], v[174:175] op_sel:[0,0,0] op_sel_hi:[1,0,0]
    v_pk_fma_f32 v[94:95], v[94:95], v[174:175], v[174:175] op_sel:[0,0,0] op_sel_hi:[1,0,0]
    v_pk_fma_f32 v[96:97], v[96:97], v[174:175], v[174:175] op_sel:[0,1,1] op_sel_hi:[1,1,1]
    v_pk_fma_f32 v[98:99], v[98:99], v[174:175], v[174:175] op_sel:[0,1,1] op_sel_hi:[1,1,1]
    v_rcp_f32 v84, v84
    v_rcp_f32 v85, v85
    v_rcp_f32 v86, v86
    v_rcp_f32 v87, v87
    v_rcp_f32 v88, v88
    v_rcp_f32 v89, v89
    v_rcp_f32 v90, v90
    v_rcp_f32 v91, v91
    v_rcp_f32 v92, v92
    v_rcp_f32 v93, v93
    v_rcp_f32 v94, v94
    v_rcp_f32 v95, v95
    v_rcp_f32 v96, v96
    v_rcp_f32 v97, v97
    v_rcp_f32 v98, v98
    v_rcp_f32 v99, v99
    v_pk_fma_f32 v[100:101], v[68:69], v[164:165], v[100:101] op_sel:[0,0,0] op_sel_hi:[1,0,1] neg_lo:[0,1,0] neg_hi:[0,1,0]
    v_pk_fma_f32 v[102:103], v[70:71], v[164:165], v[102:103] op_sel:[0,0,0] op_sel_hi:[1,0,1] neg_lo:[0,1,0] neg_hi:[0,1,0]
    v_pk_fma_f32 v[104:105], v[68:69], v[164:165], v[104:105] op_sel:[0,1,0] op_sel_hi:[1,1,1] neg_lo:[0,1,0] neg_hi:[0,1,0]
    v_pk_fma_f32 v[106:107], v[70:71], v[164:165], v[106:107] op_sel:[0,1,0] op_sel_hi:[1,1,1] neg_lo:[0,1,0] neg_hi:[0,1,0]
    v_pk_fma_f32 v[108:109], v[68:69], v[166:167], v[108:109] op_sel:[0,0,0] op_sel_hi:[1,0,1] neg_lo:[0,1,0] neg_hi:[0,1,0]
    v_pk_fma_f32 v[110:111], v[70:71], v[166:167], v[110:111] op_sel:[0,0,0] op_sel_hi:[1,0,1] neg_lo:[0,1,0] neg_hi:[0,1,0]
    v_pk_fma_f32 v[112:113], v[68:69], v[166:167], v[112:113] op_sel:[0,1,0] op_sel_hi:[1,1,1] neg_lo:[0,1,0] neg_hi:[0,1,0]
    v_pk_fma_f32 v[114:115], v[70:71], v[166:167], v[114:115] op_sel:[0,1,0] op_sel_hi:[1,1,1] neg_lo:[0,1,0] neg_hi:[0,1,0]
    v_pk_mul_f32 v[84:85], v[84:85], v[100:101]
    v_pk_mul_f32 v[86:87], v[86:87], v[102:103]
    v_pk_mul_f32 v[88:89], v[88:89], v[104:105]
    v_pk_mul_f32 v[90:91], v[90:91], v[106:107]
    v_pk_mul_f32 v[92:93], v[92:93], v[108:109]
    v_pk_mul_f32 v[94:95], v[94:95], v[110:111]
    v_pk_mul_f32 v[96:97], v[96:97], v[112:113]
    v_pk_mul_f32 v[98:99], v[98:99], v[114:115]
    v_cvt_pk_bf16_f32 v184, v84, v85
    v_cvt_pk_bf16_f32 v185, v86, v87
    v_cvt_pk_bf16_f32 v188, v88, v89
    v_cvt_pk_bf16_f32 v189, v90, v91
    v_cvt_pk_bf16_f32 v192, v92, v93
    v_cvt_pk_bf16_f32 v193, v94, v95
    v_cvt_pk_bf16_f32 v196, v96, v97
    v_cvt_pk_bf16_f32 v197, v98, v99
    ds_read_b128 v[64:67], v73 offset:4224
    ds_read_b128 v[68:71], v73 offset:4672
    v_accvgpr_read_b32 v124, a16
    v_accvgpr_read_b32 v125, a17
    v_accvgpr_read_b32 v126, a18
    v_accvgpr_read_b32 v127, a19
    v_accvgpr_read_b32 v128, a20
    v_accvgpr_read_b32 v129, a21
    v_accvgpr_read_b32 v130, a22
    v_accvgpr_read_b32 v131, a23
    v_accvgpr_read_b32 v132, a24
    v_accvgpr_read_b32 v133, a25
    v_accvgpr_read_b32 v134, a26
    v_accvgpr_read_b32 v135, a27
    v_accvgpr_read_b32 v136, a28
    v_accvgpr_read_b32 v137, a29
    v_accvgpr_read_b32 v138, a30
    v_accvgpr_read_b32 v139, a31
    s_waitcnt lgkmcnt(2)
    s_nop 0
    v_pk_fma_f32 v[124:125], v[176:177], v[164:165], v[124:125] op_sel:[0,0,0] op_sel_hi:[1,0,1] neg_lo:[0,1,0] neg_hi:[0,1,0]
    v_pk_fma_f32 v[126:127], v[178:179], v[164:165], v[126:127] op_sel:[0,0,0] op_sel_hi:[1,0,1] neg_lo:[0,1,0] neg_hi:[0,1,0]
    v_pk_fma_f32 v[128:129], v[176:177], v[164:165], v[128:129] op_sel:[0,1,0] op_sel_hi:[1,1,1] neg_lo:[0,1,0] neg_hi:[0,1,0]
    v_pk_fma_f32 v[130:131], v[178:179], v[164:165], v[130:131] op_sel:[0,1,0] op_sel_hi:[1,1,1] neg_lo:[0,1,0] neg_hi:[0,1,0]
    v_pk_fma_f32 v[132:133], v[176:177], v[166:167], v[132:133] op_sel:[0,0,0] op_sel_hi:[1,0,1] neg_lo:[0,1,0] neg_hi:[0,1,0]
    v_pk_fma_f32 v[134:135], v[178:179], v[166:167], v[134:135] op_sel:[0,0,0] op_sel_hi:[1,0,1] neg_lo:[0,1,0] neg_hi:[0,1,0]
    v_pk_fma_f32 v[136:137], v[176:177], v[166:167], v[136:137] op_sel:[0,1,0] op_sel_hi:[1,1,1] neg_lo:[0,1,0] neg_hi:[0,1,0]
    v_pk_fma_f32 v[138:139], v[178:179], v[166:167], v[138:139] op_sel:[0,1,0] op_sel_hi:[1,1,1] neg_lo:[0,1,0] neg_hi:[0,1,0]
    v_pk_mul_f32 v[124:125], v[124:125], v[168:169] op_sel:[0,0] op_sel_hi:[1,0]
    v_pk_mul_f32 v[126:127], v[126:127], v[168:169] op_sel:[0,0] op_sel_hi:[1,0]
    v_pk_mul_f32 v[128:129], v[128:129], v[168:169] op_sel:[0,1] op_sel_hi:[1,1]
    v_pk_mul_f32 v[130:131], v[130:131], v[168:169] op_sel:[0,1] op_sel_hi:[1,1]
    v_pk_mul_f32 v[132:133], v[132:133], v[170:171] op_sel:[0,0] op_sel_hi:[1,0]
    v_pk_mul_f32 v[134:135], v[134:135], v[170:171] op_sel:[0,0] op_sel_hi:[1,0]
    v_pk_mul_f32 v[136:137], v[136:137], v[170:171] op_sel:[0,1] op_sel_hi:[1,1]
    v_pk_mul_f32 v[138:139], v[138:139], v[170:171] op_sel:[0,1] op_sel_hi:[1,1]
    v_exp_f32 v124, v124
    v_exp_f32 v125, v125
    v_exp_f32 v126, v126
    v_exp_f32 v127, v127
    v_exp_f32 v128, v128
    v_exp_f32 v129, v129
    v_exp_f32 v130, v130
    v_exp_f32 v131, v131
    v_exp_f32 v132, v132
    v_exp_f32 v133, v133
    v_exp_f32 v134, v134
    v_exp_f32 v135, v135
    v_exp_f32 v136, v136
    v_exp_f32 v137, v137
    v_exp_f32 v138, v138
    v_exp_f32 v139, v139
    v_accvgpr_read_b32 v140, a128
    v_accvgpr_read_b32 v141, a129
    v_accvgpr_read_b32 v142, a130
    v_accvgpr_read_b32 v143, a131
    v_accvgpr_read_b32 v144, a132
    v_accvgpr_read_b32 v145, a133
    v_accvgpr_read_b32 v146, a134
    v_accvgpr_read_b32 v147, a135
    v_accvgpr_read_b32 v148, a136
    v_accvgpr_read_b32 v149, a137
    v_accvgpr_read_b32 v150, a138
    v_accvgpr_read_b32 v151, a139
    v_accvgpr_read_b32 v152, a140
    v_accvgpr_read_b32 v153, a141
    v_accvgpr_read_b32 v154, a142
    v_accvgpr_read_b32 v155, a143
    v_pk_fma_f32 v[124:125], v[124:125], v[172:173], v[172:173] op_sel:[0,0,0] op_sel_hi:[1,0,0]
    v_pk_fma_f32 v[126:127], v[126:127], v[172:173], v[172:173] op_sel:[0,0,0] op_sel_hi:[1,0,0]
    v_pk_fma_f32 v[128:129], v[128:129], v[172:173], v[172:173] op_sel:[0,1,1] op_sel_hi:[1,1,1]
    v_pk_fma_f32 v[130:131], v[130:131], v[172:173], v[172:173] op_sel:[0,1,1] op_sel_hi:[1,1,1]
    v_pk_fma_f32 v[132:133], v[132:133], v[174:175], v[174:175] op_sel:[0,0,0] op_sel_hi:[1,0,0]
    v_pk_fma_f32 v[134:135], v[134:135], v[174:175], v[174:175] op_sel:[0,0,0] op_sel_hi:[1,0,0]
    v_pk_fma_f32 v[136:137], v[136:137], v[174:175], v[174:175] op_sel:[0,1,1] op_sel_hi:[1,1,1]
    v_pk_fma_f32 v[138:139], v[138:139], v[174:175], v[174:175] op_sel:[0,1,1] op_sel_hi:[1,1,1]
    v_rcp_f32 v124, v124
    v_rcp_f32 v125, v125
    v_rcp_f32 v126, v126
    v_rcp_f32 v127, v127
    v_rcp_f32 v128, v128
    v_rcp_f32 v129, v129
    v_rcp_f32 v130, v130
    v_rcp_f32 v131, v131
    v_rcp_f32 v132, v132
    v_rcp_f32 v133, v133
    v_rcp_f32 v134, v134
    v_rcp_f32 v135, v135
    v_rcp_f32 v136, v136
    v_rcp_f32 v137, v137
    v_rcp_f32 v138, v138
    v_rcp_f32 v139, v139
    v_pk_fma_f32 v[140:141], v[180:181], v[164:165], v[140:141] op_sel:[0,0,0] op_sel_hi:[1,0,1] neg_lo:[0,1,0] neg_hi:[0,1,0]
    v_pk_fma_f32 v[142:143], v[182:183], v[164:165], v[142:143] op_sel:[0,0,0] op_sel_hi:[1,0,1] neg_lo:[0,1,0] neg_hi:[0,1,0]
    v_pk_fma_f32 v[144:145], v[180:181], v[164:165], v[144:145] op_sel:[0,1,0] op_sel_hi:[1,1,1] neg_lo:[0,1,0] neg_hi:[0,1,0]
    v_pk_fma_f32 v[146:147], v[182:183], v[164:165], v[146:147] op_sel:[0,1,0] op_sel_hi:[1,1,1] neg_lo:[0,1,0] neg_hi:[0,1,0]
    v_pk_fma_f32 v[148:149], v[180:181], v[166:167], v[148:149] op_sel:[0,0,0] op_sel_hi:[1,0,1] neg_lo:[0,1,0] neg_hi:[0,1,0]
    v_pk_fma_f32 v[150:151], v[182:183], v[166:167], v[150:151] op_sel:[0,0,0] op_sel_hi:[1,0,1] neg_lo:[0,1,0] neg_hi:[0,1,0]
    v_pk_fma_f32 v[152:153], v[180:181], v[166:167], v[152:153] op_sel:[0,1,0] op_sel_hi:[1,1,1] neg_lo:[0,1,0] neg_hi:[0,1,0]
    v_pk_fma_f32 v[154:155], v[182:183], v[166:167], v[154:155] op_sel:[0,1,0] op_sel_hi:[1,1,1] neg_lo:[0,1,0] neg_hi:[0,1,0]
    v_pk_mul_f32 v[124:125], v[124:125], v[140:141]
    v_pk_mul_f32 v[126:127], v[126:127], v[142:143]
    v_pk_mul_f32 v[128:129], v[128:129], v[144:145]
    v_pk_mul_f32 v[130:131], v[130:131], v[146:147]
    v_pk_mul_f32 v[132:133], v[132:133], v[148:149]
    v_pk_mul_f32 v[134:135], v[134:135], v[150:151]
    v_pk_mul_f32 v[136:137], v[136:137], v[152:153]
    v_pk_mul_f32 v[138:139], v[138:139], v[154:155]
    v_cvt_pk_bf16_f32 v186, v124, v125
    v_cvt_pk_bf16_f32 v187, v126, v127
    v_cvt_pk_bf16_f32 v190, v128, v129
    v_cvt_pk_bf16_f32 v191, v130, v131
    v_cvt_pk_bf16_f32 v194, v132, v133
    v_cvt_pk_bf16_f32 v195, v134, v135
    v_cvt_pk_bf16_f32 v198, v136, v137
    v_cvt_pk_bf16_f32 v199, v138, v139
    buffer_store_dwordx4 v[184:187], v81, s[8:11], s34 offen offset:0 sc1
    buffer_store_dwordx4 v[188:191], v81, s[8:11], s34 offen offset:1024 sc1
    buffer_store_dwordx4 v[192:195], v81, s[8:11], s34 offen offset:2048 sc1
    buffer_store_dwordx4 v[196:199], v81, s[8:11], s34 offen offset:3072 sc1
    s_add_u32 s34, s34, 131072
    ds_read_b128 v[176:179], v73 offset:4288
    ds_read_b128 v[180:183], v73 offset:4736
    v_accvgpr_read_b32 v84, a32
    v_accvgpr_read_b32 v85, a33
    v_accvgpr_read_b32 v86, a34
    v_accvgpr_read_b32 v87, a35
    v_accvgpr_read_b32 v88, a36
    v_accvgpr_read_b32 v89, a37
    v_accvgpr_read_b32 v90, a38
    v_accvgpr_read_b32 v91, a39
    v_accvgpr_read_b32 v92, a40
    v_accvgpr_read_b32 v93, a41
    v_accvgpr_read_b32 v94, a42
    v_accvgpr_read_b32 v95, a43
    v_accvgpr_read_b32 v96, a44
    v_accvgpr_read_b32 v97, a45
    v_accvgpr_read_b32 v98, a46
    v_accvgpr_read_b32 v99, a47
    s_waitcnt lgkmcnt(2)
    s_nop 0
    v_pk_fma_f32 v[84:85], v[64:65], v[164:165], v[84:85] op_sel:[0,0,0] op_sel_hi:[1,0,1] neg_lo:[0,1,0] neg_hi:[0,1,0]
    v_pk_fma_f32 v[86:87], v[66:67], v[164:165], v[86:87] op_sel:[0,0,0] op_sel_hi:[1,0,1] neg_lo:[0,1,0] neg_hi:[0,1,0]
    v_pk_fma_f32 v[88:89], v[64:65], v[164:165], v[88:89] op_sel:[0,1,0] op_sel_hi:[1,1,1] neg_lo:[0,1,0] neg_hi:[0,1,0]
    v_pk_fma_f32 v[90:91], v[66:67], v[164:165], v[90:91] op_sel:[0,1,0] op_sel_hi:[1,1,1] neg_lo:[0,1,0] neg_hi:[0,1,0]
    v_pk_fma_f32 v[92:93], v[64:65], v[166:167], v[92:93] op_sel:[0,0,0] op_sel_hi:[1,0,1] neg_lo:[0,1,0] neg_hi:[0,1,0]
    v_pk_fma_f32 v[94:95], v[66:67], v[166:167], v[94:95] op_sel:[0,0,0] op_sel_hi:[1,0,1] neg_lo:[0,1,0] neg_hi:[0,1,0]
    v_pk_fma_f32 v[96:97], v[64:65], v[166:167], v[96:97] op_sel:[0,1,0] op_sel_hi:[1,1,1] neg_lo:[0,1,0] neg_hi:[0,1,0]
    v_pk_fma_f32 v[98:99], v[66:67], v[166:167], v[98:99] op_sel:[0,1,0] op_sel_hi:[1,1,1] neg_lo:[0,1,0] neg_hi:[0,1,0]
    v_pk_mul_f32 v[84:85], v[84:85], v[168:169] op_sel:[0,0] op_sel_hi:[1,0]
    v_pk_mul_f32 v[86:87], v[86:87], v[168:169] op_sel:[0,0] op_sel_hi:[1,0]
    v_pk_mul_f32 v[88:89], v[88:89], v[168:169] op_sel:[0,1] op_sel_hi:[1,1]
    v_pk_mul_f32 v[90:91], v[90:91], v[168:169] op_sel:[0,1] op_sel_hi:[1,1]
    v_pk_mul_f32 v[92:93], v[92:93], v[170:171] op_sel:[0,0] op_sel_hi:[1,0]
    v_pk_mul_f32 v[94:95], v[94:95], v[170:171] op_sel:[0,0] op_sel_hi:[1,0]
    v_pk_mul_f32 v[96:97], v[96:97], v[170:171] op_sel:[0,1] op_sel_hi:[1,1]
    v_pk_mul_f32 v[98:99], v[98:99], v[170:171] op_sel:[0,1] op_sel_hi:[1,1]
    v_exp_f32 v84, v84
    v_exp_f32 v85, v85
    v_exp_f32 v86, v86
    v_exp_f32 v87, v87
    v_exp_f32 v88, v88
    v_exp_f32 v89, v89
    v_exp_f32 v90, v90
    v_exp_f32 v91, v91
    v_exp_f32 v92, v92
    v_exp_f32 v93, v93
    v_exp_f32 v94, v94
    v_exp_f32 v95, v95
    v_exp_f32 v96, v96
    v_exp_f32 v97, v97
    v_exp_f32 v98, v98
    v_exp_f32 v99, v99
    v_accvgpr_read_b32 v100, a144
    v_accvgpr_read_b32 v101, a145
    v_accvgpr_read_b32 v102, a146
    v_accvgpr_read_b32 v103, a147
    v_accvgpr_read_b32 v104, a148
    v_accvgpr_read_b32 v105, a149
    v_accvgpr_read_b32 v106, a150
    v_accvgpr_read_b32 v107, a151
    v_accvgpr_read_b32 v108, a152
    v_accvgpr_read_b32 v109, a153
    v_accvgpr_read_b32 v110, a154
    v_accvgpr_read_b32 v111, a155
    v_accvgpr_read_b32 v112, a156
    v_accvgpr_read_b32 v113, a157
    v_accvgpr_read_b32 v114, a158
    v_accvgpr_read_b32 v115, a159
    v_pk_fma_f32 v[84:85], v[84:85], v[172:173], v[172:173] op_sel:[0,0,0] op_sel_hi:[1,0,0]
    v_pk_fma_f32 v[86:87], v[86:87], v[172:173], v[172:173] op_sel:[0,0,0] op_sel_hi:[1,0,0]
    v_pk_fma_f32 v[88:89], v[88:89], v[172:173], v[172:173] op_sel:[0,1,1] op_sel_hi:[1,1,1]
    v_pk_fma_f32 v[90:91], v[90:91], v[172:173], v[172:173] op_sel:[0,1,1] op_sel_hi:[1,1,1]
    v_pk_fma_f32 v[92:93], v[92:93], v[174:175], v[174:175] op_sel:[0,0,0] op_sel_hi:[1,0,0]
    v_pk_fma_f32 v[94:95], v[94:95], v[174:175], v[174:175] op_sel:[0,0,0] op_sel_hi:[1,0,0]
    v_pk_fma_f32 v[96:97], v[96:97], v[174:175], v[174:175] op_sel:[0,1,1] op_sel_hi:[1,1,1]
    v_pk_fma_f32 v[98:99], v[98:99], v[174:175], v[174:175] op_sel:[0,1,1] op_sel_hi:[1,1,1]
    v_rcp_f32 v84, v84
    v_rcp_f32 v85, v85
    v_rcp_f32 v86, v86
    v_rcp_f32 v87, v87
    v_rcp_f32 v88, v88
    v_rcp_f32 v89, v89
    v_rcp_f32 v90, v90
    v_rcp_f32 v91, v91
    v_rcp_f32 v92, v92
    v_rcp_f32 v93, v93
    v_rcp_f32 v94, v94
    v_rcp_f32 v95, v95
    v_rcp_f32 v96, v96
    v_rcp_f32 v97, v97
    v_rcp_f32 v98, v98
    v_rcp_f32 v99, v99
    v_pk_fma_f32 v[100:101], v[68:69], v[164:165], v[100:101] op_sel:[0,0,0] op_sel_hi:[1,0,1] neg_lo:[0,1,0] neg_hi:[0,1,0]
    v_pk_fma_f32 v[102:103], v[70:71], v[164:165], v[102:103] op_sel:[0,0,0] op_sel_hi:[1,0,1] neg_lo:[0,1,0] neg_hi:[0,1,0]
    v_pk_fma_f32 v[104:105], v[68:69], v[164:165], v[104:105] op_sel:[0,1,0] op_sel_hi:[1,1,1] neg_lo:[0,1,0] neg_hi:[0,1,0]
    v_pk_fma_f32 v[106:107], v[70:71], v[164:165], v[106:107] op_sel:[0,1,0] op_sel_hi:[1,1,1] neg_lo:[0,1,0] neg_hi:[0,1,0]
    v_pk_fma_f32 v[108:109], v[68:69], v[166:167], v[108:109] op_sel:[0,0,0] op_sel_hi:[1,0,1] neg_lo:[0,1,0] neg_hi:[0,1,0]
    v_pk_fma_f32 v[110:111], v[70:71], v[166:167], v[110:111] op_sel:[0,0,0] op_sel_hi:[1,0,1] neg_lo:[0,1,0] neg_hi:[0,1,0]
    v_pk_fma_f32 v[112:113], v[68:69], v[166:167], v[112:113] op_sel:[0,1,0] op_sel_hi:[1,1,1] neg_lo:[0,1,0] neg_hi:[0,1,0]
    v_pk_fma_f32 v[114:115], v[70:71], v[166:167], v[114:115] op_sel:[0,1,0] op_sel_hi:[1,1,1] neg_lo:[0,1,0] neg_hi:[0,1,0]
    v_pk_mul_f32 v[84:85], v[84:85], v[100:101]
    v_pk_mul_f32 v[86:87], v[86:87], v[102:103]
    v_pk_mul_f32 v[88:89], v[88:89], v[104:105]
    v_pk_mul_f32 v[90:91], v[90:91], v[106:107]
    v_pk_mul_f32 v[92:93], v[92:93], v[108:109]
    v_pk_mul_f32 v[94:95], v[94:95], v[110:111]
    v_pk_mul_f32 v[96:97], v[96:97], v[112:113]
    v_pk_mul_f32 v[98:99], v[98:99], v[114:115]
    v_cvt_pk_bf16_f32 v184, v84, v85
    v_cvt_pk_bf16_f32 v185, v86, v87
    v_cvt_pk_bf16_f32 v188, v88, v89
    v_cvt_pk_bf16_f32 v189, v90, v91
    v_cvt_pk_bf16_f32 v192, v92, v93
    v_cvt_pk_bf16_f32 v193, v94, v95
    v_cvt_pk_bf16_f32 v196, v96, v97
    v_cvt_pk_bf16_f32 v197, v98, v99
    ds_read_b128 v[64:67], v73 offset:4352
    ds_read_b128 v[68:71], v73 offset:4800
    v_accvgpr_read_b32 v124, a48
    v_accvgpr_read_b32 v125, a49
    v_accvgpr_read_b32 v126, a50
    v_accvgpr_read_b32 v127, a51
    v_accvgpr_read_b32 v128, a52
    v_accvgpr_read_b32 v129, a53
    v_accvgpr_read_b32 v130, a54
    v_accvgpr_read_b32 v131, a55
    v_accvgpr_read_b32 v132, a56
    v_accvgpr_read_b32 v133, a57
    v_accvgpr_read_b32 v134, a58
    v_accvgpr_read_b32 v135, a59
    v_accvgpr_read_b32 v136, a60
    v_accvgpr_read_b32 v137, a61
    v_accvgpr_read_b32 v138, a62
    v_accvgpr_read_b32 v139, a63
    s_waitcnt lgkmcnt(2)
    s_nop 0
    v_pk_fma_f32 v[124:125], v[176:177], v[164:165], v[124:125] op_sel:[0,0,0] op_sel_hi:[1,0,1] neg_lo:[0,1,0] neg_hi:[0,1,0]
    v_pk_fma_f32 v[126:127], v[178:179], v[164:165], v[126:127] op_sel:[0,0,0] op_sel_hi:[1,0,1] neg_lo:[0,1,0] neg_hi:[0,1,0]
    v_pk_fma_f32 v[128:129], v[176:177], v[164:165], v[128:129] op_sel:[0,1,0] op_sel_hi:[1,1,1] neg_lo:[0,1,0] neg_hi:[0,1,0]
    v_pk_fma_f32 v[130:131], v[178:179], v[164:165], v[130:131] op_sel:[0,1,0] op_sel_hi:[1,1,1] neg_lo:[0,1,0] neg_hi:[0,1,0]
    v_pk_fma_f32 v[132:133], v[176:177], v[166:167], v[132:133] op_sel:[0,0,0] op_sel_hi:[1,0,1] neg_lo:[0,1,0] neg_hi:[0,1,0]
    v_pk_fma_f32 v[134:135], v[178:179], v[166:167], v[134:135] op_sel:[0,0,0] op_sel_hi:[1,0,1] neg_lo:[0,1,0] neg_hi:[0,1,0]
    v_pk_fma_f32 v[136:137], v[176:177], v[166:167], v[136:137] op_sel:[0,1,0] op_sel_hi:[1,1,1] neg_lo:[0,1,0] neg_hi:[0,1,0]
    v_pk_fma_f32 v[138:139], v[178:179], v[166:167], v[138:139] op_sel:[0,1,0] op_sel_hi:[1,1,1] neg_lo:[0,1,0] neg_hi:[0,1,0]
    v_pk_mul_f32 v[124:125], v[124:125], v[168:169] op_sel:[0,0] op_sel_hi:[1,0]
    v_pk_mul_f32 v[126:127], v[126:127], v[168:169] op_sel:[0,0] op_sel_hi:[1,0]
    v_pk_mul_f32 v[128:129], v[128:129], v[168:169] op_sel:[0,1] op_sel_hi:[1,1]
    v_pk_mul_f32 v[130:131], v[130:131], v[168:169] op_sel:[0,1] op_sel_hi:[1,1]
    v_pk_mul_f32 v[132:133], v[132:133], v[170:171] op_sel:[0,0] op_sel_hi:[1,0]
    v_pk_mul_f32 v[134:135], v[134:135], v[170:171] op_sel:[0,0] op_sel_hi:[1,0]
    v_pk_mul_f32 v[136:137], v[136:137], v[170:171] op_sel:[0,1] op_sel_hi:[1,1]
    v_pk_mul_f32 v[138:139], v[138:139], v[170:171] op_sel:[0,1] op_sel_hi:[1,1]
    v_exp_f32 v124, v124
    v_exp_f32 v125, v125
    v_exp_f32 v126, v126
    v_exp_f32 v127, v127
    v_exp_f32 v128, v128
    v_exp_f32 v129, v129
    v_exp_f32 v130, v130
    v_exp_f32 v131, v131
    v_exp_f32 v132, v132
    v_exp_f32 v133, v133
    v_exp_f32 v134, v134
    v_exp_f32 v135, v135
    v_exp_f32 v136, v136
    v_exp_f32 v137, v137
    v_exp_f32 v138, v138
    v_exp_f32 v139, v139
    v_accvgpr_read_b32 v140, a160
    v_accvgpr_read_b32 v141, a161
    v_accvgpr_read_b32 v142, a162
    v_accvgpr_read_b32 v143, a163
    v_accvgpr_read_b32 v144, a164
    v_accvgpr_read_b32 v145, a165
    v_accvgpr_read_b32 v146, a166
    v_accvgpr_read_b32 v147, a167
    v_accvgpr_read_b32 v148, a168
    v_accvgpr_read_b32 v149, a169
    v_accvgpr_read_b32 v150, a170
    v_accvgpr_read_b32 v151, a171
    v_accvgpr_read_b32 v152, a172
    v_accvgpr_read_b32 v153, a173
    v_accvgpr_read_b32 v154, a174
    v_accvgpr_read_b32 v155, a175
    v_pk_fma_f32 v[124:125], v[124:125], v[172:173], v[172:173] op_sel:[0,0,0] op_sel_hi:[1,0,0]
    v_pk_fma_f32 v[126:127], v[126:127], v[172:173], v[172:173] op_sel:[0,0,0] op_sel_hi:[1,0,0]
    v_pk_fma_f32 v[128:129], v[128:129], v[172:173], v[172:173] op_sel:[0,1,1] op_sel_hi:[1,1,1]
    v_pk_fma_f32 v[130:131], v[130:131], v[172:173], v[172:173] op_sel:[0,1,1] op_sel_hi:[1,1,1]
    v_pk_fma_f32 v[132:133], v[132:133], v[174:175], v[174:175] op_sel:[0,0,0] op_sel_hi:[1,0,0]
    v_pk_fma_f32 v[134:135], v[134:135], v[174:175], v[174:175] op_sel:[0,0,0] op_sel_hi:[1,0,0]
    v_pk_fma_f32 v[136:137], v[136:137], v[174:175], v[174:175] op_sel:[0,1,1] op_sel_hi:[1,1,1]
    v_pk_fma_f32 v[138:139], v[138:139], v[174:175], v[174:175] op_sel:[0,1,1] op_sel_hi:[1,1,1]
    v_rcp_f32 v124, v124
    v_rcp_f32 v125, v125
    v_rcp_f32 v126, v126
    v_rcp_f32 v127, v127
    v_rcp_f32 v128, v128
    v_rcp_f32 v129, v129
    v_rcp_f32 v130, v130
    v_rcp_f32 v131, v131
    v_rcp_f32 v132, v132
    v_rcp_f32 v133, v133
    v_rcp_f32 v134, v134
    v_rcp_f32 v135, v135
    v_rcp_f32 v136, v136
    v_rcp_f32 v137, v137
    v_rcp_f32 v138, v138
    v_rcp_f32 v139, v139
    v_pk_fma_f32 v[140:141], v[180:181], v[164:165], v[140:141] op_sel:[0,0,0] op_sel_hi:[1,0,1] neg_lo:[0,1,0] neg_hi:[0,1,0]
    v_pk_fma_f32 v[142:143], v[182:183], v[164:165], v[142:143] op_sel:[0,0,0] op_sel_hi:[1,0,1] neg_lo:[0,1,0] neg_hi:[0,1,0]
    v_pk_fma_f32 v[144:145], v[180:181], v[164:165], v[144:145] op_sel:[0,1,0] op_sel_hi:[1,1,1] neg_lo:[0,1,0] neg_hi:[0,1,0]
    v_pk_fma_f32 v[146:147], v[182:183], v[164:165], v[146:147] op_sel:[0,1,0] op_sel_hi:[1,1,1] neg_lo:[0,1,0] neg_hi:[0,1,0]
    v_pk_fma_f32 v[148:149], v[180:181], v[166:167], v[148:149] op_sel:[0,0,0] op_sel_hi:[1,0,1] neg_lo:[0,1,0] neg_hi:[0,1,0]
    v_pk_fma_f32 v[150:151], v[182:183], v[166:167], v[150:151] op_sel:[0,0,0] op_sel_hi:[1,0,1] neg_lo:[0,1,0] neg_hi:[0,1,0]
    v_pk_fma_f32 v[152:153], v[180:181], v[166:167], v[152:153] op_sel:[0,1,0] op_sel_hi:[1,1,1] neg_lo:[0,1,0] neg_hi:[0,1,0]
    v_pk_fma_f32 v[154:155], v[182:183], v[166:167], v[154:155] op_sel:[0,1,0] op_sel_hi:[1,1,1] neg_lo:[0,1,0] neg_hi:[0,1,0]
    v_pk_mul_f32 v[124:125], v[124:125], v[140:141]
    v_pk_mul_f32 v[126:127], v[126:127], v[142:143]
    v_pk_mul_f32 v[128:129], v[128:129], v[144:145]
    v_pk_mul_f32 v[130:131], v[130:131], v[146:147]
    v_pk_mul_f32 v[132:133], v[132:133], v[148:149]
    v_pk_mul_f32 v[134:135], v[134:135], v[150:151]
    v_pk_mul_f32 v[136:137], v[136:137], v[152:153]
    v_pk_mul_f32 v[138:139], v[138:139], v[154:155]
    v_cvt_pk_bf16_f32 v186, v124, v125
    v_cvt_pk_bf16_f32 v187, v126, v127
    v_cvt_pk_bf16_f32 v190, v128, v129
    v_cvt_pk_bf16_f32 v191, v130, v131
    v_cvt_pk_bf16_f32 v194, v132, v133
    v_cvt_pk_bf16_f32 v195, v134, v135
    v_cvt_pk_bf16_f32 v198, v136, v137
    v_cvt_pk_bf16_f32 v199, v138, v139
    buffer_store_dwordx4 v[184:187], v81, s[8:11], s34 offen offset:0 sc1
    buffer_store_dwordx4 v[188:191], v81, s[8:11], s34 offen offset:1024 sc1
    buffer_store_dwordx4 v[192:195], v81, s[8:11], s34 offen offset:2048 sc1
    buffer_store_dwordx4 v[196:199], v81, s[8:11], s34 offen offset:3072 sc1
    s_add_u32 s34, s34, 131072
    ds_read_b128 v[176:179], v73 offset:4416
    ds_read_b128 v[180:183], v73 offset:4864
    v_accvgpr_read_b32 v84, a64
    v_accvgpr_read_b32 v85, a65
    v_accvgpr_read_b32 v86, a66
    v_accvgpr_read_b32 v87, a67
    v_accvgpr_read_b32 v88, a68
    v_accvgpr_read_b32 v89, a69
    v_accvgpr_read_b32 v90, a70
    v_accvgpr_read_b32 v91, a71
    v_accvgpr_read_b32 v92, a72
    v_accvgpr_read_b32 v93, a73
    v_accvgpr_read_b32 v94, a74
    v_accvgpr_read_b32 v95, a75
    v_accvgpr_read_b32 v96, a76
    v_accvgpr_read_b32 v97, a77
    v_accvgpr_read_b32 v98, a78
    v_accvgpr_read_b32 v99, a79
    s_waitcnt lgkmcnt(2)
    s_nop 0
    v_pk_fma_f32 v[84:85], v[64:65], v[164:165], v[84:85] op_sel:[0,0,0] op_sel_hi:[1,0,1] neg_lo:[0,1,0] neg_hi:[0,1,0]
    v_pk_fma_f32 v[86:87], v[66:67], v[164:165], v[86:87] op_sel:[0,0,0] op_sel_hi:[1,0,1] neg_lo:[0,1,0] neg_hi:[0,1,0]
    v_pk_fma_f32 v[88:89], v[64:65], v[164:165], v[88:89] op_sel:[0,1,0] op_sel_hi:[1,1,1] neg_lo:[0,1,0] neg_hi:[0,1,0]
    v_pk_fma_f32 v[90:91], v[66:67], v[164:165], v[90:91] op_sel:[0,1,0] op_sel_hi:[1,1,1] neg_lo:[0,1,0] neg_hi:[0,1,0]
    v_pk_fma_f32 v[92:93], v[64:65], v[166:167], v[92:93] op_sel:[0,0,0] op_sel_hi:[1,0,1] neg_lo:[0,1,0] neg_hi:[0,1,0]
    v_pk_fma_f32 v[94:95], v[66:67], v[166:167], v[94:95] op_sel:[0,0,0] op_sel_hi:[1,0,1] neg_lo:[0,1,0] neg_hi:[0,1,0]
    v_pk_fma_f32 v[96:97], v[64:65], v[166:167], v[96:97] op_sel:[0,1,0] op_sel_hi:[1,1,1] neg_lo:[0,1,0] neg_hi:[0,1,0]
    v_pk_fma_f32 v[98:99], v[66:67], v[166:167], v[98:99] op_sel:[0,1,0] op_sel_hi:[1,1,1] neg_lo:[0,1,0] neg_hi:[0,1,0]
    v_pk_mul_f32 v[84:85], v[84:85], v[168:169] op_sel:[0,0] op_sel_hi:[1,0]
    v_pk_mul_f32 v[86:87], v[86:87], v[168:169] op_sel:[0,0] op_sel_hi:[1,0]
    v_pk_mul_f32 v[88:89], v[88:89], v[168:169] op_sel:[0,1] op_sel_hi:[1,1]
    v_pk_mul_f32 v[90:91], v[90:91], v[168:169] op_sel:[0,1] op_sel_hi:[1,1]
    v_pk_mul_f32 v[92:93], v[92:93], v[170:171] op_sel:[0,0] op_sel_hi:[1,0]
    v_pk_mul_f32 v[94:95], v[94:95], v[170:171] op_sel:[0,0] op_sel_hi:[1,0]
    v_pk_mul_f32 v[96:97], v[96:97], v[170:171] op_sel:[0,1] op_sel_hi:[1,1]
    v_pk_mul_f32 v[98:99], v[98:99], v[170:171] op_sel:[0,1] op_sel_hi:[1,1]
    v_exp_f32 v84, v84
    v_exp_f32 v85, v85
    v_exp_f32 v86, v86
    v_exp_f32 v87, v87
    v_exp_f32 v88, v88
    v_exp_f32 v89, v89
    v_exp_f32 v90, v90
    v_exp_f32 v91, v91
    v_exp_f32 v92, v92
    v_exp_f32 v93, v93
    v_exp_f32 v94, v94
    v_exp_f32 v95, v95
    v_exp_f32 v96, v96
    v_exp_f32 v97, v97
    v_exp_f32 v98, v98
    v_exp_f32 v99, v99
    v_accvgpr_read_b32 v100, a176
    v_accvgpr_read_b32 v101, a177
    v_accvgpr_read_b32 v102, a178
    v_accvgpr_read_b32 v103, a179
    v_accvgpr_read_b32 v104, a180
    v_accvgpr_read_b32 v105, a181
    v_accvgpr_read_b32 v106, a182
    v_accvgpr_read_b32 v107, a183
    v_accvgpr_read_b32 v108, a184
    v_accvgpr_read_b32 v109, a185
    v_accvgpr_read_b32 v110, a186
    v_accvgpr_read_b32 v111, a187
    v_accvgpr_read_b32 v112, a188
    v_accvgpr_read_b32 v113, a189
    v_accvgpr_read_b32 v114, a190
    v_accvgpr_read_b32 v115, a191
    v_pk_fma_f32 v[84:85], v[84:85], v[172:173], v[172:173] op_sel:[0,0,0] op_sel_hi:[1,0,0]
    v_pk_fma_f32 v[86:87], v[86:87], v[172:173], v[172:173] op_sel:[0,0,0] op_sel_hi:[1,0,0]
    v_pk_fma_f32 v[88:89], v[88:89], v[172:173], v[172:173] op_sel:[0,1,1] op_sel_hi:[1,1,1]
    v_pk_fma_f32 v[90:91], v[90:91], v[172:173], v[172:173] op_sel:[0,1,1] op_sel_hi:[1,1,1]
    v_pk_fma_f32 v[92:93], v[92:93], v[174:175], v[174:175] op_sel:[0,0,0] op_sel_hi:[1,0,0]
    v_pk_fma_f32 v[94:95], v[94:95], v[174:175], v[174:175] op_sel:[0,0,0] op_sel_hi:[1,0,0]
    v_pk_fma_f32 v[96:97], v[96:97], v[174:175], v[174:175] op_sel:[0,1,1] op_sel_hi:[1,1,1]
    v_pk_fma_f32 v[98:99], v[98:99], v[174:175], v[174:175] op_sel:[0,1,1] op_sel_hi:[1,1,1]
    v_rcp_f32 v84, v84
    v_rcp_f32 v85, v85
    v_rcp_f32 v86, v86
    v_rcp_f32 v87, v87
    v_rcp_f32 v88, v88
    v_rcp_f32 v89, v89
    v_rcp_f32 v90, v90
    v_rcp_f32 v91, v91
    v_rcp_f32 v92, v92
    v_rcp_f32 v93, v93
    v_rcp_f32 v94, v94
    v_rcp_f32 v95, v95
    v_rcp_f32 v96, v96
    v_rcp_f32 v97, v97
    v_rcp_f32 v98, v98
    v_rcp_f32 v99, v99
    v_pk_fma_f32 v[100:101], v[68:69], v[164:165], v[100:101] op_sel:[0,0,0] op_sel_hi:[1,0,1] neg_lo:[0,1,0] neg_hi:[0,1,0]
    v_pk_fma_f32 v[102:103], v[70:71], v[164:165], v[102:103] op_sel:[0,0,0] op_sel_hi:[1,0,1] neg_lo:[0,1,0] neg_hi:[0,1,0]
    v_pk_fma_f32 v[104:105], v[68:69], v[164:165], v[104:105] op_sel:[0,1,0] op_sel_hi:[1,1,1] neg_lo:[0,1,0] neg_hi:[0,1,0]
    v_pk_fma_f32 v[106:107], v[70:71], v[164:165], v[106:107] op_sel:[0,1,0] op_sel_hi:[1,1,1] neg_lo:[0,1,0] neg_hi:[0,1,0]
    v_pk_fma_f32 v[108:109], v[68:69], v[166:167], v[108:109] op_sel:[0,0,0] op_sel_hi:[1,0,1] neg_lo:[0,1,0] neg_hi:[0,1,0]
    v_pk_fma_f32 v[110:111], v[70:71], v[166:167], v[110:111] op_sel:[0,0,0] op_sel_hi:[1,0,1] neg_lo:[0,1,0] neg_hi:[0,1,0]
    v_pk_fma_f32 v[112:113], v[68:69], v[166:167], v[112:113] op_sel:[0,1,0] op_sel_hi:[1,1,1] neg_lo:[0,1,0] neg_hi:[0,1,0]
    v_pk_fma_f32 v[114:115], v[70:71], v[166:167], v[114:115] op_sel:[0,1,0] op_sel_hi:[1,1,1] neg_lo:[0,1,0] neg_hi:[0,1,0]
    v_pk_mul_f32 v[84:85], v[84:85], v[100:101]
    v_pk_mul_f32 v[86:87], v[86:87], v[102:103]
    v_pk_mul_f32 v[88:89], v[88:89], v[104:105]
    v_pk_mul_f32 v[90:91], v[90:91], v[106:107]
    v_pk_mul_f32 v[92:93], v[92:93], v[108:109]
    v_pk_mul_f32 v[94:95], v[94:95], v[110:111]
    v_pk_mul_f32 v[96:97], v[96:97], v[112:113]
    v_pk_mul_f32 v[98:99], v[98:99], v[114:115]
    v_cvt_pk_bf16_f32 v184, v84, v85
    v_cvt_pk_bf16_f32 v185, v86, v87
    v_cvt_pk_bf16_f32 v188, v88, v89
    v_cvt_pk_bf16_f32 v189, v90, v91
    v_cvt_pk_bf16_f32 v192, v92, v93
    v_cvt_pk_bf16_f32 v193, v94, v95
    v_cvt_pk_bf16_f32 v196, v96, v97
    v_cvt_pk_bf16_f32 v197, v98, v99
    ds_read_b128 v[64:67], v73 offset:4480
    ds_read_b128 v[68:71], v73 offset:4928
    v_accvgpr_read_b32 v124, a80
    v_accvgpr_read_b32 v125, a81
    v_accvgpr_read_b32 v126, a82
    v_accvgpr_read_b32 v127, a83
    v_accvgpr_read_b32 v128, a84
    v_accvgpr_read_b32 v129, a85
    v_accvgpr_read_b32 v130, a86
    v_accvgpr_read_b32 v131, a87
    v_accvgpr_read_b32 v132, a88
    v_accvgpr_read_b32 v133, a89
    v_accvgpr_read_b32 v134, a90
    v_accvgpr_read_b32 v135, a91
    v_accvgpr_read_b32 v136, a92
    v_accvgpr_read_b32 v137, a93
    v_accvgpr_read_b32 v138, a94
    v_accvgpr_read_b32 v139, a95
    s_waitcnt lgkmcnt(2)
    s_nop 0
    v_pk_fma_f32 v[124:125], v[176:177], v[164:165], v[124:125] op_sel:[0,0,0] op_sel_hi:[1,0,1] neg_lo:[0,1,0] neg_hi:[0,1,0]
    v_pk_fma_f32 v[126:127], v[178:179], v[164:165], v[126:127] op_sel:[0,0,0] op_sel_hi:[1,0,1] neg_lo:[0,1,0] neg_hi:[0,1,0]
    v_pk_fma_f32 v[128:129], v[176:177], v[164:165], v[128:129] op_sel:[0,1,0] op_sel_hi:[1,1,1] neg_lo:[0,1,0] neg_hi:[0,1,0]
    v_pk_fma_f32 v[130:131], v[178:179], v[164:165], v[130:131] op_sel:[0,1,0] op_sel_hi:[1,1,1] neg_lo:[0,1,0] neg_hi:[0,1,0]
    v_pk_fma_f32 v[132:133], v[176:177], v[166:167], v[132:133] op_sel:[0,0,0] op_sel_hi:[1,0,1] neg_lo:[0,1,0] neg_hi:[0,1,0]
    v_pk_fma_f32 v[134:135], v[178:179], v[166:167], v[134:135] op_sel:[0,0,0] op_sel_hi:[1,0,1] neg_lo:[0,1,0] neg_hi:[0,1,0]
    v_pk_fma_f32 v[136:137], v[176:177], v[166:167], v[136:137] op_sel:[0,1,0] op_sel_hi:[1,1,1] neg_lo:[0,1,0] neg_hi:[0,1,0]
    v_pk_fma_f32 v[138:139], v[178:179], v[166:167], v[138:139] op_sel:[0,1,0] op_sel_hi:[1,1,1] neg_lo:[0,1,0] neg_hi:[0,1,0]
    v_pk_mul_f32 v[124:125], v[124:125], v[168:169] op_sel:[0,0] op_sel_hi:[1,0]
    v_pk_mul_f32 v[126:127], v[126:127], v[168:169] op_sel:[0,0] op_sel_hi:[1,0]
    v_pk_mul_f32 v[128:129], v[128:129], v[168:169] op_sel:[0,1] op_sel_hi:[1,1]
    v_pk_mul_f32 v[130:131], v[130:131], v[168:169] op_sel:[0,1] op_sel_hi:[1,1]
    v_pk_mul_f32 v[132:133], v[132:133], v[170:171] op_sel:[0,0] op_sel_hi:[1,0]
    v_pk_mul_f32 v[134:135], v[134:135], v[170:171] op_sel:[0,0] op_sel_hi:[1,0]
    v_pk_mul_f32 v[136:137], v[136:137], v[170:171] op_sel:[0,1] op_sel_hi:[1,1]
    v_pk_mul_f32 v[138:139], v[138:139], v[170:171] op_sel:[0,1] op_sel_hi:[1,1]
    v_exp_f32 v124, v124
    v_exp_f32 v125, v125
    v_exp_f32 v126, v126
    v_exp_f32 v127, v127
    v_exp_f32 v128, v128
    v_exp_f32 v129, v129
    v_exp_f32 v130, v130
    v_exp_f32 v131, v131
    v_exp_f32 v132, v132
    v_exp_f32 v133, v133
    v_exp_f32 v134, v134
    v_exp_f32 v135, v135
    v_exp_f32 v136, v136
    v_exp_f32 v137, v137
    v_exp_f32 v138, v138
    v_exp_f32 v139, v139
    v_accvgpr_read_b32 v140, a192
    v_accvgpr_read_b32 v141, a193
    v_accvgpr_read_b32 v142, a194
    v_accvgpr_read_b32 v143, a195
    v_accvgpr_read_b32 v144, a196
    v_accvgpr_read_b32 v145, a197
    v_accvgpr_read_b32 v146, a198
    v_accvgpr_read_b32 v147, a199
    v_accvgpr_read_b32 v148, a200
    v_accvgpr_read_b32 v149, a201
    v_accvgpr_read_b32 v150, a202
    v_accvgpr_read_b32 v151, a203
    v_accvgpr_read_b32 v152, a204
    v_accvgpr_read_b32 v153, a205
    v_accvgpr_read_b32 v154, a206
    v_accvgpr_read_b32 v155, a207
    v_pk_fma_f32 v[124:125], v[124:125], v[172:173], v[172:173] op_sel:[0,0,0] op_sel_hi:[1,0,0]
    v_pk_fma_f32 v[126:127], v[126:127], v[172:173], v[172:173] op_sel:[0,0,0] op_sel_hi:[1,0,0]
    v_pk_fma_f32 v[128:129], v[128:129], v[172:173], v[172:173] op_sel:[0,1,1] op_sel_hi:[1,1,1]
    v_pk_fma_f32 v[130:131], v[130:131], v[172:173], v[172:173] op_sel:[0,1,1] op_sel_hi:[1,1,1]
    v_pk_fma_f32 v[132:133], v[132:133], v[174:175], v[174:175] op_sel:[0,0,0] op_sel_hi:[1,0,0]
    v_pk_fma_f32 v[134:135], v[134:135], v[174:175], v[174:175] op_sel:[0,0,0] op_sel_hi:[1,0,0]
    v_pk_fma_f32 v[136:137], v[136:137], v[174:175], v[174:175] op_sel:[0,1,1] op_sel_hi:[1,1,1]
    v_pk_fma_f32 v[138:139], v[138:139], v[174:175], v[174:175] op_sel:[0,1,1] op_sel_hi:[1,1,1]
    v_rcp_f32 v124, v124
    v_rcp_f32 v125, v125
    v_rcp_f32 v126, v126
    v_rcp_f32 v127, v127
    v_rcp_f32 v128, v128
    v_rcp_f32 v129, v129
    v_rcp_f32 v130, v130
    v_rcp_f32 v131, v131
    v_rcp_f32 v132, v132
    v_rcp_f32 v133, v133
    v_rcp_f32 v134, v134
    v_rcp_f32 v135, v135
    v_rcp_f32 v136, v136
    v_rcp_f32 v137, v137
    v_rcp_f32 v138, v138
    v_rcp_f32 v139, v139
    v_pk_fma_f32 v[140:141], v[180:181], v[164:165], v[140:141] op_sel:[0,0,0] op_sel_hi:[1,0,1] neg_lo:[0,1,0] neg_hi:[0,1,0]
    v_pk_fma_f32 v[142:143], v[182:183], v[164:165], v[142:143] op_sel:[0,0,0] op_sel_hi:[1,0,1] neg_lo:[0,1,0] neg_hi:[0,1,0]
    v_pk_fma_f32 v[144:145], v[180:181], v[164:165], v[144:145] op_sel:[0,1,0] op_sel_hi:[1,1,1] neg_lo:[0,1,0] neg_hi:[0,1,0]
    v_pk_fma_f32 v[146:147], v[182:183], v[164:165], v[146:147] op_sel:[0,1,0] op_sel_hi:[1,1,1] neg_lo:[0,1,0] neg_hi:[0,1,0]
    v_pk_fma_f32 v[148:149], v[180:181], v[166:167], v[148:149] op_sel:[0,0,0] op_sel_hi:[1,0,1] neg_lo:[0,1,0] neg_hi:[0,1,0]
    v_pk_fma_f32 v[150:151], v[182:183], v[166:167], v[150:151] op_sel:[0,0,0] op_sel_hi:[1,0,1] neg_lo:[0,1,0] neg_hi:[0,1,0]
    v_pk_fma_f32 v[152:153], v[180:181], v[166:167], v[152:153] op_sel:[0,1,0] op_sel_hi:[1,1,1] neg_lo:[0,1,0] neg_hi:[0,1,0]
    v_pk_fma_f32 v[154:155], v[182:183], v[166:167], v[154:155] op_sel:[0,1,0] op_sel_hi:[1,1,1] neg_lo:[0,1,0] neg_hi:[0,1,0]
    v_pk_mul_f32 v[124:125], v[124:125], v[140:141]
    v_pk_mul_f32 v[126:127], v[126:127], v[142:143]
    v_pk_mul_f32 v[128:129], v[128:129], v[144:145]
    v_pk_mul_f32 v[130:131], v[130:131], v[146:147]
    v_pk_mul_f32 v[132:133], v[132:133], v[148:149]
    v_pk_mul_f32 v[134:135], v[134:135], v[150:151]
    v_pk_mul_f32 v[136:137], v[136:137], v[152:153]
    v_pk_mul_f32 v[138:139], v[138:139], v[154:155]
    v_cvt_pk_bf16_f32 v186, v124, v125
    v_cvt_pk_bf16_f32 v187, v126, v127
    v_cvt_pk_bf16_f32 v190, v128, v129
    v_cvt_pk_bf16_f32 v191, v130, v131
    v_cvt_pk_bf16_f32 v194, v132, v133
    v_cvt_pk_bf16_f32 v195, v134, v135
    v_cvt_pk_bf16_f32 v198, v136, v137
    v_cvt_pk_bf16_f32 v199, v138, v139
    buffer_store_dwordx4 v[184:187], v81, s[8:11], s34 offen offset:0 sc1
    buffer_store_dwordx4 v[188:191], v81, s[8:11], s34 offen offset:1024 sc1
    buffer_store_dwordx4 v[192:195], v81, s[8:11], s34 offen offset:2048 sc1
    buffer_store_dwordx4 v[196:199], v81, s[8:11], s34 offen offset:3072 sc1
    s_add_u32 s34, s34, 131072
    s_lshl_b32 s43, s33, 11
    s_nop 0
    s_add_u32 s43, s43, 41943040
    buffer_load_dwordx4 v[176:179], v72, s[8:11], s43 offen offset:0 sc1
    buffer_load_dwordx4 v[180:183], v72, s[8:11], s43 offen offset:256 sc1
    buffer_load_dwordx4 v[184:187], v72, s[8:11], s43 offen offset:512 sc1
    buffer_load_dwordx4 v[188:191], v72, s[8:11], s43 offen offset:768 sc1
    buffer_load_dwordx4 v[192:195], v72, s[8:11], s43 offen offset:1024 sc1
    buffer_load_dwordx4 v[196:199], v72, s[8:11], s43 offen offset:1280 sc1
    buffer_load_dwordx4 v[200:203], v72, s[8:11], s43 offen offset:1536 sc1
    v_accvgpr_read_b32 v84, a96
    v_accvgpr_read_b32 v85, a97
    v_accvgpr_read_b32 v86, a98
    v_accvgpr_read_b32 v87, a99
    v_accvgpr_read_b32 v88, a100
    v_accvgpr_read_b32 v89, a101
    v_accvgpr_read_b32 v90, a102
    v_accvgpr_read_b32 v91, a103
    v_accvgpr_read_b32 v92, a104
    v_accvgpr_read_b32 v93, a105
    v_accvgpr_read_b32 v94, a106
    v_accvgpr_read_b32 v95, a107
    v_accvgpr_read_b32 v96, a108
    v_accvgpr_read_b32 v97, a109
    v_accvgpr_read_b32 v98, a110
    v_accvgpr_read_b32 v99, a111
    s_waitcnt lgkmcnt(0)
    s_nop 0
    v_pk_fma_f32 v[84:85], v[64:65], v[164:165], v[84:85] op_sel:[0,0,0] op_sel_hi:[1,0,1] neg_lo:[0,1,0] neg_hi:[0,1,0]
    v_pk_fma_f32 v[86:87], v[66:67], v[164:165], v[86:87] op_sel:[0,0,0] op_sel_hi:[1,0,1] neg_lo:[0,1,0] neg_hi:[0,1,0]
    v_pk_fma_f32 v[88:89], v[64:65], v[164:165], v[88:89] op_sel:[0,1,0] op_sel_hi:[1,1,1] neg_lo:[0,1,0] neg_hi:[0,1,0]
    v_pk_fma_f32 v[90:91], v[66:67], v[164:165], v[90:91] op_sel:[0,1,0] op_sel_hi:[1,1,1] neg_lo:[0,1,0] neg_hi:[0,1,0]
    v_pk_fma_f32 v[92:93], v[64:65], v[166:167], v[92:93] op_sel:[0,0,0] op_sel_hi:[1,0,1] neg_lo:[0,1,0] neg_hi:[0,1,0]
    v_pk_fma_f32 v[94:95], v[66:67], v[166:167], v[94:95] op_sel:[0,0,0] op_sel_hi:[1,0,1] neg_lo:[0,1,0] neg_hi:[0,1,0]
    v_pk_fma_f32 v[96:97], v[64:65], v[166:167], v[96:97] op_sel:[0,1,0] op_sel_hi:[1,1,1] neg_lo:[0,1,0] neg_hi:[0,1,0]
    v_pk_fma_f32 v[98:99], v[66:67], v[166:167], v[98:99] op_sel:[0,1,0] op_sel_hi:[1,1,1] neg_lo:[0,1,0] neg_hi:[0,1,0]
    v_pk_mul_f32 v[84:85], v[84:85], v[168:169] op_sel:[0,0] op_sel_hi:[1,0]
    v_pk_mul_f32 v[86:87], v[86:87], v[168:169] op_sel:[0,0] op_sel_hi:[1,0]
    v_pk_mul_f32 v[88:89], v[88:89], v[168:169] op_sel:[0,1] op_sel_hi:[1,1]
    v_pk_mul_f32 v[90:91], v[90:91], v[168:169] op_sel:[0,1] op_sel_hi:[1,1]
    v_pk_mul_f32 v[92:93], v[92:93], v[170:171] op_sel:[0,0] op_sel_hi:[1,0]
    v_pk_mul_f32 v[94:95], v[94:95], v[170:171] op_sel:[0,0] op_sel_hi:[1,0]
    v_pk_mul_f32 v[96:97], v[96:97], v[170:171] op_sel:[0,1] op_sel_hi:[1,1]
    v_pk_mul_f32 v[98:99], v[98:99], v[170:171] op_sel:[0,1] op_sel_hi:[1,1]
    v_exp_f32 v84, v84
    v_exp_f32 v85, v85
    v_exp_f32 v86, v86
    v_exp_f32 v87, v87
    v_exp_f32 v88, v88
    v_exp_f32 v89, v89
    v_exp_f32 v90, v90
    v_exp_f32 v91, v91
    v_exp_f32 v92, v92
    v_exp_f32 v93, v93
    v_exp_f32 v94, v94
    v_exp_f32 v95, v95
    v_exp_f32 v96, v96
    v_exp_f32 v97, v97
    v_exp_f32 v98, v98
    v_exp_f32 v99, v99
    v_accvgpr_read_b32 v100, a208
    v_accvgpr_read_b32 v101, a209
    v_accvgpr_read_b32 v102, a210
    v_accvgpr_read_b32 v103, a211
    v_accvgpr_read_b32 v104, a212
    v_accvgpr_read_b32 v105, a213
    v_accvgpr_read_b32 v106, a214
    v_accvgpr_read_b32 v107, a215
    v_accvgpr_read_b32 v108, a216
    v_accvgpr_read_b32 v109, a217
    v_accvgpr_read_b32 v110, a218
    v_accvgpr_read_b32 v111, a219
    v_accvgpr_read_b32 v112, a220
    v_accvgpr_read_b32 v113, a221
    v_accvgpr_read_b32 v114, a222
    v_accvgpr_read_b32 v115, a223
    v_pk_fma_f32 v[84:85], v[84:85], v[172:173], v[172:173] op_sel:[0,0,0] op_sel_hi:[1,0,0]
    v_pk_fma_f32 v[86:87], v[86:87], v[172:173], v[172:173] op_sel:[0,0,0] op_sel_hi:[1,0,0]
    v_pk_fma_f32 v[88:89], v[88:89], v[172:173], v[172:173] op_sel:[0,1,1] op_sel_hi:[1,1,1]
    v_pk_fma_f32 v[90:91], v[90:91], v[172:173], v[172:173] op_sel:[0,1,1] op_sel_hi:[1,1,1]
    v_pk_fma_f32 v[92:93], v[92:93], v[174:175], v[174:175] op_sel:[0,0,0] op_sel_hi:[1,0,0]
    v_pk_fma_f32 v[94:95], v[94:95], v[174:175], v[174:175] op_sel:[0,0,0] op_sel_hi:[1,0,0]
    v_pk_fma_f32 v[96:97], v[96:97], v[174:175], v[174:175] op_sel:[0,1,1] op_sel_hi:[1,1,1]
    v_pk_fma_f32 v[98:99], v[98:99], v[174:175], v[174:175] op_sel:[0,1,1] op_sel_hi:[1,1,1]
    v_rcp_f32 v84, v84
    v_rcp_f32 v85, v85
    v_rcp_f32 v86, v86
    v_rcp_f32 v87, v87
    v_rcp_f32 v88, v88
    v_rcp_f32 v89, v89
    v_rcp_f32 v90, v90
    v_rcp_f32 v91, v91
    v_rcp_f32 v92, v92
    v_rcp_f32 v93, v93
    v_rcp_f32 v94, v94
    v_rcp_f32 v95, v95
    v_rcp_f32 v96, v96
    v_rcp_f32 v97, v97
    v_rcp_f32 v98, v98
    v_rcp_f32 v99, v99
    v_pk_fma_f32 v[100:101], v[68:69], v[164:165], v[100:101] op_sel:[0,0,0] op_sel_hi:[1,0,1] neg_lo:[0,1,0] neg_hi:[0,1,0]
    v_pk_fma_f32 v[102:103], v[70:71], v[164:165], v[102:103] op_sel:[0,0,0] op_sel_hi:[1,0,1] neg_lo:[0,1,0] neg_hi:[0,1,0]
    v_pk_fma_f32 v[104:105], v[68:69], v[164:165], v[104:105] op_sel:[0,1,0] op_sel_hi:[1,1,1] neg_lo:[0,1,0] neg_hi:[0,1,0]
    v_pk_fma_f32 v[106:107], v[70:71], v[164:165], v[106:107] op_sel:[0,1,0] op_sel_hi:[1,1,1] neg_lo:[0,1,0] neg_hi:[0,1,0]
    v_pk_fma_f32 v[108:109], v[68:69], v[166:167], v[108:109] op_sel:[0,0,0] op_sel_hi:[1,0,1] neg_lo:[0,1,0] neg_hi:[0,1,0]
    v_pk_fma_f32 v[110:111], v[70:71], v[166:167], v[110:111] op_sel:[0,0,0] op_sel_hi:[1,0,1] neg_lo:[0,1,0] neg_hi:[0,1,0]
    v_pk_fma_f32 v[112:113], v[68:69], v[166:167], v[112:113] op_sel:[0,1,0] op_sel_hi:[1,1,1] neg_lo:[0,1,0] neg_hi:[0,1,0]
    v_pk_fma_f32 v[114:115], v[70:71], v[166:167], v[114:115] op_sel:[0,1,0] op_sel_hi:[1,1,1] neg_lo:[0,1,0] neg_hi:[0,1,0]
    s_mov_b32 s36, s38
    s_lshr_b32 s37, s36, 1
    s_lshl_b32 s37, s37, 17
    s_and_b32 s36, s36, 1
    s_lshl_b32 s36, s36, 3
    s_add_u32 s36, s36, s37
    s_add_u32 s36, s36, s35
    s_nop 0
    v_pk_mul_f32 v[84:85], v[84:85], v[100:101]
    v_pk_mul_f32 v[86:87], v[86:87], v[102:103]
    v_pk_mul_f32 v[88:89], v[88:89], v[104:105]
    v_pk_mul_f32 v[90:91], v[90:91], v[106:107]
    v_pk_mul_f32 v[92:93], v[92:93], v[108:109]
    v_pk_mul_f32 v[94:95], v[94:95], v[110:111]
    v_pk_mul_f32 v[96:97], v[96:97], v[112:113]
    v_pk_mul_f32 v[98:99], v[98:99], v[114:115]
    v_cvt_pk_bf16_f32 v116, v84, v85
    v_cvt_pk_bf16_f32 v117, v86, v87
    v_cvt_pk_bf16_f32 v118, v88, v89
    v_cvt_pk_bf16_f32 v119, v90, v91
    v_cvt_pk_bf16_f32 v120, v92, v93
    v_cvt_pk_bf16_f32 v121, v94, v95
    v_cvt_pk_bf16_f32 v122, v96, v97
    v_cvt_pk_bf16_f32 v123, v98, v99
    buffer_store_dwordx2 v[116:117], v81, s[8:11], s36 offen offset:0 sc1
    buffer_store_dwordx2 v[118:119], v81, s[8:11], s36 offen offset:1024 sc1
    buffer_store_dwordx2 v[120:121], v81, s[8:11], s36 offen offset:2048 sc1
    buffer_store_dwordx2 v[122:123], v81, s[8:11], s36 offen offset:3072 sc1
    v_mov_b32 v64, 0
    v_mov_b32 v65, 0
    v_mov_b32 v66, 0
    v_mov_b32 v67, 0
    s_mov_b32 s42, 0x10000
    s_waitcnt vmcnt(4)
    s_cmp_eq_u32 s32, 0
    s_cbranch_scc1 L_k1_nocarry
L_k1_cchk:
    v_mov_b32 v78, 0
    v_max3_u32 v78, v176, v177, v78
    v_max3_u32 v78, v178, v179, v78
    s_cmp_le_u32 s32, 1
    s_cbranch_scc1 L_k1_chkd
    v_max3_u32 v78, v180, v181, v78
    v_max3_u32 v78, v182, v183, v78
    s_cmp_le_u32 s32, 2
    s_cbranch_scc1 L_k1_chkd
    v_max3_u32 v78, v184, v185, v78
    v_max3_u32 v78, v186, v187, v78
    s_cmp_le_u32 s32, 3
    s_cbranch_scc1 L_k1_chkd
    v_max3_u32 v78, v188, v189, v78
    v_max3_u32 v78, v190, v191, v78
    s_cmp_le_u32 s32, 4
    s_cbranch_scc1 L_k1_chkd
    v_max3_u32 v78, v192, v193, v78
    v_max3_u32 v78, v194, v195, v78
    s_cmp_le_u32 s32, 5
    s_cbranch_scc1 L_k1_chkd
    v_max3_u32 v78, v196, v197, v78
    v_max3_u32 v78, v198, v199, v78
    s_cmp_le_u32 s32, 6
    s_cbranch_scc1 L_k1_chkd
    v_max3_u32 v78, v200, v201, v78
    v_max3_u32 v78, v202, v203, v78
L_k1_chkd:
    v_cmp_ne_u32 vcc, -1, v78
    s_sub_u32 s42, s42, 1
    s_cbranch_scc1 L_k1_cok
    s_cmp_eq_u64 vcc, -1
    s_cbranch_scc1 L_k1_cok
    s_lshl_b32 s43, s33, 11
    s_add_u32 s43, s43, 41943040
    buffer_load_dwordx4 v[176:179], v72, s[8:11], s43 offen offset:0 sc1
    buffer_load_dwordx4 v[180:183], v72, s[8:11], s43 offen offset:256 sc1
    buffer_load_dwordx4 v[184:187], v72, s[8:11], s43 offen offset:512 sc1
    buffer_load_dwordx4 v[188:191], v72, s[8:11], s43 offen offset:768 sc1
    buffer_load_dwordx4 v[192:195], v72, s[8:11], s43 offen offset:1024 sc1
    buffer_load_dwordx4 v[196:199], v72, s[8:11], s43 offen offset:1280 sc1
    buffer_load_dwordx4 v[200:203], v72, s[8:11], s43 offen offset:1536 sc1
    s_waitcnt vmcnt(0)
    s_branch L_k1_cchk
L_k1_cok:
    v_fma_f32 v68, v252, v64, v176
    v_fma_f32 v69, v252, v65, v177
    v_fma_f32 v70, v254, v66, v178
    v_fma_f32 v71, v254, v67, v179
    v_fma_f32 v68, -v253, v65, v68
    v_fma_f32 v65, v253, v64, v69
    v_mov_b32_e64 v64, v68
    v_fma_f32 v70, -v255, v67, v70
    v_fma_f32 v67, v255, v66, v71
    v_mov_b32_e64 v66, v70
    s_cmp_le_u32 s32, 1
    s_cbranch_scc1 L_k1_nocarry
    v_fma_f32 v68, v252, v64, v180
    v_fma_f32 v69, v252, v65, v181
    v_fma_f32 v70, v254, v66, v182
    v_fma_f32 v71, v254, v67, v183
    v_fma_f32 v68, -v253, v65, v68
    v_fma_f32 v65, v253, v64, v69
    v_mov_b32_e64 v64, v68
    v_fma_f32 v70, -v255, v67, v70
    v_fma_f32 v67, v255, v66, v71
    v_mov_b32_e64 v66, v70
    s_cmp_le_u32 s32, 2
    s_cbranch_scc1 L_k1_nocarry
    v_fma_f32 v68, v252, v64, v184
    v_fma_f32 v69, v252, v65, v185
    v_fma_f32 v70, v254, v66, v186
    v_fma_f32 v71, v254, v67, v187
    v_fma_f32 v68, -v253, v65, v68
    v_fma_f32 v65, v253, v64, v69
    v_mov_b32_e64 v64, v68
    v_fma_f32 v70, -v255, v67, v70
    v_fma_f32 v67, v255, v66, v71
    v_mov_b32_e64 v66, v70
    s_cmp_le_u32 s32, 3
    s_cbranch_scc1 L_k1_nocarry
    v_fma_f32 v68, v252, v64, v188
    v_fma_f32 v69, v252, v65, v189
    v_fma_f32 v70, v254, v66, v190
    v_fma_f32 v71, v254, v67, v191
    v_fma_f32 v68, -v253, v65, v68
    v_fma_f32 v65, v253, v64, v69
    v_mov_b32_e64 v64, v68
    v_fma_f32 v70, -v255, v67, v70
    v_fma_f32 v67, v255, v66, v71
    v_mov_b32_e64 v66, v70
    s_cmp_le_u32 s32, 4
    s_cbranch_scc1 L_k1_nocarry
    v_fma_f32 v68, v252, v64, v192
    v_fma_f32 v69, v252, v65, v193
    v_fma_f32 v70, v254, v66, v194
    v_fma_f32 v71, v254, v67, v195
    v_fma_f32 v68, -v253, v65, v68
    v_fma_f32 v65, v253, v64, v69
    v_mov_b32_e64 v64, v68
    v_fma_f32 v70, -v255, v67, v70
    v_fma_f32 v67, v255, v66, v71
    v_mov_b32_e64 v66, v70
    s_cmp_le_u32 s32, 5
    s_cbranch_scc1 L_k1_nocarry
    v_fma_f32 v68, v252, v64, v196
    v_fma_f32 v69, v252, v65, v197
    v_fma_f32 v70, v254, v66, v198
    v_fma_f32 v71, v254, v67, v199
    v_fma_f32 v68, -v253, v65, v68
    v_fma_f32 v65, v253, v64, v69
    v_mov_b32_e64 v64, v68
    v_fma_f32 v70, -v255, v67, v70
    v_fma_f32 v67, v255, v66, v71
    v_mov_b32_e64 v66, v70
    s_cmp_le_u32 s32, 6
    s_cbranch_scc1 L_k1_nocarry
    v_fma_f32 v68, v252, v64, v200
    v_fma_f32 v69, v252, v65, v201
    v_fma_f32 v70, v254, v66, v202
    v_fma_f32 v71, v254, v67, v203
    v_fma_f32 v68, -v253, v65, v68
    v_fma_f32 v65, v253, v64, v69
    v_mov_b32_e64 v64, v68
    v_fma_f32 v70, -v255, v67, v70
    v_fma_f32 v67, v255, v66, v71
    v_mov_b32_e64 v66, v70
L_k1_nocarry:
    v_fma_f32 v74, v248, v64, v74
    v_fma_f32 v75, v248, v65, v75
    v_fma_f32 v74, -v249, v65, v74
    v_fma_f32 v75, v249, v64, v75
    v_fma_f32 v76, v250, v66, v76
    v_fma_f32 v77, v250, v67, v77
    v_fma_f32 v76, -v251, v67, v76
    v_fma_f32 v77, v251, v66, v77
    v_fma_f32 v68, v240, v74, v32
    v_fma_f32 v69, v240, v75, v40
    v_fma_f32 v70, v242, v76, v36
    v_fma_f32 v71, v242, v77, v44
    v_fma_f32 v68, -v241, v75, v68
    v_fma_f32 v75, v241, v74, v69
    v_mov_b32_e64 v74, v68
    v_fma_f32 v70, -v243, v77, v70
    v_fma_f32 v77, v243, v76, v71
    v_mov_b32 v76, v70
    v_mul_f32 v80, v17, v74
    v_mul_f32 v82, -v17, v75
    v_fma_f32 v80, -v18, v75, v80
    v_fma_f32 v82, -v18, v74, v82
    v_mul_f32_e64 v84, v19, v76
    v_mul_f32 v86, -v19, v77
    v_fma_f32 v84, -v20, v77, v84
    v_fma_f32 v86, -v20, v76, v86
    v_fma_f32 v68, v240, v74, v33
    v_fma_f32 v69, v240, v75, v41
    v_fma_f32 v70, v242, v76, v37
    v_fma_f32 v71, v242, v77, v45
    v_fma_f32 v68, -v241, v75, v68
    v_fma_f32 v75, v241, v74, v69
    v_mov_b32_e64 v74, v68
    v_fma_f32 v70, -v243, v77, v70
    v_fma_f32 v77, v243, v76, v71
    v_mov_b32 v76, v70
    v_mul_f32 v81, v17, v74
    v_mul_f32 v83, -v17, v75
    v_fma_f32 v81, -v18, v75, v81
    v_fma_f32 v83, -v18, v74, v83
    v_mul_f32_e64 v85, v19, v76
    v_mul_f32 v87, -v19, v77
    v_fma_f32 v85, -v20, v77, v85
    v_fma_f32 v87, -v20, v76, v87
    v_cvt_pk_bf16_f32 v168, v80, v81
    v_cvt_pk_bf16_f32 v184, v82, v83
    v_cvt_pk_bf16_f32 v176, v84, v85
    v_cvt_pk_bf16_f32 v192, v86, v87
    v_fma_f32 v68, v240, v74, v34
    v_fma_f32 v69, v240, v75, v42
    v_fma_f32 v70, v242, v76, v38
    v_fma_f32 v71, v242, v77, v46
    v_fma_f32 v68, -v241, v75, v68
    v_fma_f32 v75, v241, v74, v69
    v_mov_b32_e64 v74, v68
    v_fma_f32 v70, -v243, v77, v70
    v_fma_f32 v77, v243, v76, v71
    v_mov_b32 v76, v70
    v_mul_f32 v80, v17, v74
    v_mul_f32 v82, -v17, v75
    v_fma_f32 v80, -v18, v75, v80
    v_fma_f32 v82, -v18, v74, v82
    v_mul_f32_e64 v84, v19, v76
    v_mul_f32 v86, -v19, v77
    v_fma_f32 v84, -v20, v77, v84
    v_fma_f32 v86, -v20, v76, v86
    v_fma_f32 v68, v240, v74, v35
    v_fma_f32 v69, v240, v75, v43
    v_fma_f32 v70, v242, v76, v39
    v_fma_f32 v71, v242, v77, v47
    v_fma_f32 v68, -v241, v75, v68
    v_fma_f32 v75, v241, v74, v69
    v_mov_b32_e64 v74, v68
    v_fma_f32 v70, -v243, v77, v70
    v_fma_f32 v77, v243, v76, v71
    v_mov_b32 v76, v70
    v_mul_f32 v81, v17, v74
    v_mul_f32 v83, -v17, v75
    v_fma_f32 v81, -v18, v75, v81
    v_fma_f32 v83, -v18, v74, v83
    v_mul_f32_e64 v85, v19, v76
    v_mul_f32 v87, -v19, v77
    v_fma_f32 v85, -v20, v77, v85
    v_fma_f32 v87, -v20, v76, v87
    v_cvt_pk_bf16_f32 v169, v80, v81
    v_cvt_pk_bf16_f32 v185, v82, v83
    v_cvt_pk_bf16_f32 v177, v84, v85
    v_cvt_pk_bf16_f32 v193, v86, v87
    v_fma_f32 v68, v240, v74, v48
    v_fma_f32 v69, v240, v75, v56
    v_fma_f32 v70, v242, v76, v52
    v_fma_f32 v71, v242, v77, v60
    v_fma_f32 v68, -v241, v75, v68
    v_fma_f32 v75, v241, v74, v69
    v_mov_b32_e64 v74, v68
    v_fma_f32 v70, -v243, v77, v70
    v_fma_f32 v77, v243, v76, v71
    v_mov_b32 v76, v70
    v_mul_f32 v80, v17, v74
    v_mul_f32 v82, -v17, v75
    v_fma_f32 v80, -v18, v75, v80
    v_fma_f32 v82, -v18, v74, v82
    v_mul_f32_e64 v84, v19, v76
    v_mul_f32 v86, -v19, v77
    v_fma_f32 v84, -v20, v77, v84
    v_fma_f32 v86, -v20, v76, v86
    v_fma_f32 v68, v240, v74, v49
    v_fma_f32 v69, v240, v75, v57
    v_fma_f32 v70, v242, v76, v53
    v_fma_f32 v71, v242, v77, v61
    v_fma_f32 v68, -v241, v75, v68
    v_fma_f32 v75, v241, v74, v69
    v_mov_b32_e64 v74, v68
    v_fma_f32 v70, -v243, v77, v70
    v_fma_f32 v77, v243, v76, v71
    v_mov_b32 v76, v70
    v_mul_f32 v81, v17, v74
    v_mul_f32 v83, -v17, v75
    v_fma_f32 v81, -v18, v75, v81
    v_fma_f32 v83, -v18, v74, v83
    v_mul_f32_e64 v85, v19, v76
    v_mul_f32 v87, -v19, v77
    v_fma_f32 v85, -v20, v77, v85
    v_fma_f32 v87, -v20, v76, v87
    v_cvt_pk_bf16_f32 v170, v80, v81
    v_cvt_pk_bf16_f32 v186, v82, v83
    v_cvt_pk_bf16_f32 v178, v84, v85
    v_cvt_pk_bf16_f32 v194, v86, v87
    v_fma_f32 v68, v240, v74, v50
    v_fma_f32 v69, v240, v75, v58
    v_fma_f32 v70, v242, v76, v54
    v_fma_f32 v71, v242, v77, v62
    v_fma_f32 v68, -v241, v75, v68
    v_fma_f32 v75, v241, v74, v69
    v_mov_b32_e64 v74, v68
    v_fma_f32 v70, -v243, v77, v70
    v_fma_f32 v77, v243, v76, v71
    v_mov_b32 v76, v70
    v_mul_f32 v80, v17, v74
    v_mul_f32 v82, -v17, v75
    v_fma_f32 v80, -v18, v75, v80
    v_fma_f32 v82, -v18, v74, v82
    v_mul_f32_e64 v84, v19, v76
    v_mul_f32 v86, -v19, v77
    v_fma_f32 v84, -v20, v77, v84
    v_fma_f32 v86, -v20, v76, v86
    v_fma_f32 v68, v240, v74, v51
    v_fma_f32 v69, v240, v75, v59
    v_fma_f32 v70, v242, v76, v55
    v_fma_f32 v71, v242, v77, v63
    v_fma_f32 v68, -v241, v75, v68
    v_fma_f32 v75, v241, v74, v69
    v_mov_b32_e64 v74, v68
    v_fma_f32 v70, -v243, v77, v70
    v_fma_f32 v77, v243, v76, v71
    v_mov_b32 v76, v70
    v_mul_f32 v81, v17, v74
    v_mul_f32 v83, -v17, v75
    v_fma_f32 v81, -v18, v75, v81
    v_fma_f32 v83, -v18, v74, v83
    v_mul_f32_e64 v85, v19, v76
    v_mul_f32 v87, -v19, v77
    v_fma_f32 v85, -v20, v77, v85
    v_fma_f32 v87, -v20, v76, v87
    v_cvt_pk_bf16_f32 v171, v80, v81
    v_cvt_pk_bf16_f32 v187, v82, v83
    v_cvt_pk_bf16_f32 v179, v84, v85
    v_cvt_pk_bf16_f32 v195, v86, v87
    v_fma_f32 v68, v240, v74, v208
    v_fma_f32 v69, v240, v75, v216
    v_fma_f32 v70, v242, v76, v212
    v_fma_f32 v71, v242, v77, v220
    v_fma_f32 v68, -v241, v75, v68
    v_fma_f32 v75, v241, v74, v69
    v_mov_b32_e64 v74, v68
    v_fma_f32 v70, -v243, v77, v70
    v_fma_f32 v77, v243, v76, v71
    v_mov_b32 v76, v70
    v_mul_f32 v80, v17, v74
    v_mul_f32 v82, -v17, v75
    v_fma_f32 v80, -v18, v75, v80
    v_fma_f32 v82, -v18, v74, v82
    v_mul_f32_e64 v84, v19, v76
    v_mul_f32 v86, -v19, v77
    v_fma_f32 v84, -v20, v77, v84
    v_fma_f32 v86, -v20, v76, v86
    v_fma_f32 v68, v240, v74, v209
    v_fma_f32 v69, v240, v75, v217
    v_fma_f32 v70, v242, v76, v213
    v_fma_f32 v71, v242, v77, v221
    v_fma_f32 v68, -v241, v75, v68
    v_fma_f32 v75, v241, v74, v69
    v_mov_b32_e64 v74, v68
    v_fma_f32 v70, -v243, v77, v70
    v_fma_f32 v77, v243, v76, v71
    v_mov_b32 v76, v70
    v_mul_f32 v81, v17, v74
    v_mul_f32 v83, -v17, v75
    v_fma_f32 v81, -v18, v75, v81
    v_fma_f32 v83, -v18, v74, v83
    v_mul_f32_e64 v85, v19, v76
    v_mul_f32 v87, -v19, v77
    v_fma_f32 v85, -v20, v77, v85
    v_fma_f32 v87, -v20, v76, v87
    v_cvt_pk_bf16_f32 v172, v80, v81
    v_cvt_pk_bf16_f32 v188, v82, v83
    v_cvt_pk_bf16_f32 v180, v84, v85
    v_cvt_pk_bf16_f32 v196, v86, v87
    v_fma_f32 v68, v240, v74, v210
    v_fma_f32 v69, v240, v75, v218
    v_fma_f32 v70, v242, v76, v214
    v_fma_f32 v71, v242, v77, v222
    v_fma_f32 v68, -v241, v75, v68
    v_fma_f32 v75, v241, v74, v69
    v_mov_b32_e64 v74, v68
    v_fma_f32 v70, -v243, v77, v70
    v_fma_f32 v77, v243, v76, v71
    v_mov_b32 v76, v70
    v_mul_f32 v80, v17, v74
    v_mul_f32 v82, -v17, v75
    v_fma_f32 v80, -v18, v75, v80
    v_fma_f32 v82, -v18, v74, v82
    v_mul_f32_e64 v84, v19, v76
    v_mul_f32 v86, -v19, v77
    v_fma_f32 v84, -v20, v77, v84
    v_fma_f32 v86, -v20, v76, v86
    v_fma_f32 v68, v240, v74, v211
    v_fma_f32 v69, v240, v75, v219
    v_fma_f32 v70, v242, v76, v215
    v_fma_f32 v71, v242, v77, v223
    v_fma_f32 v68, -v241, v75, v68
    v_fma_f32 v75, v241, v74, v69
    v_mov_b32_e64 v74, v68
    v_fma_f32 v70, -v243, v77, v70
    v_fma_f32 v77, v243, v76, v71
    v_mov_b32 v76, v70
    v_mul_f32 v81, v17, v74
    v_mul_f32 v83, -v17, v75
    v_fma_f32 v81, -v18, v75, v81
    v_fma_f32 v83, -v18, v74, v83
    v_mul_f32_e64 v85, v19, v76
    v_mul_f32 v87, -v19, v77
    v_fma_f32 v85, -v20, v77, v85
    v_fma_f32 v87, -v20, v76, v87
    v_cvt_pk_bf16_f32 v173, v80, v81
    v_cvt_pk_bf16_f32 v189, v82, v83
    v_cvt_pk_bf16_f32 v181, v84, v85
    v_cvt_pk_bf16_f32 v197, v86, v87
    v_fma_f32 v68, v240, v74, v224
    v_fma_f32 v69, v240, v75, v232
    v_fma_f32 v70, v242, v76, v228
    v_fma_f32 v71, v242, v77, v236
    v_fma_f32 v68, -v241, v75, v68
    v_fma_f32 v75, v241, v74, v69
    v_mov_b32_e64 v74, v68
    v_fma_f32 v70, -v243, v77, v70
    v_fma_f32 v77, v243, v76, v71
    v_mov_b32 v76, v70
    v_mul_f32 v80, v17, v74
    v_mul_f32 v82, -v17, v75
    v_fma_f32 v80, -v18, v75, v80
    v_fma_f32 v82, -v18, v74, v82
    v_mul_f32_e64 v84, v19, v76
    v_mul_f32 v86, -v19, v77
    v_fma_f32 v84, -v20, v77, v84
    v_fma_f32 v86, -v20, v76, v86
    v_fma_f32 v68, v240, v74, v225
    v_fma_f32 v69, v240, v75, v233
    v_fma_f32 v70, v242, v76, v229
    v_fma_f32 v71, v242, v77, v237
    v_fma_f32 v68, -v241, v75, v68
    v_fma_f32 v75, v241, v74, v69
    v_mov_b32_e64 v74, v68
    v_fma_f32 v70, -v243, v77, v70
    v_fma_f32 v77, v243, v76, v71
    v_mov_b32 v76, v70
    v_mul_f32 v81, v17, v74
    v_mul_f32 v83, -v17, v75
    v_fma_f32 v81, -v18, v75, v81
    v_fma_f32 v83, -v18, v74, v83
    v_mul_f32_e64 v85, v19, v76
    v_mul_f32 v87, -v19, v77
    v_fma_f32 v85, -v20, v77, v85
    v_fma_f32 v87, -v20, v76, v87
    v_cvt_pk_bf16_f32 v174, v80, v81
    v_cvt_pk_bf16_f32 v190, v82, v83
    v_cvt_pk_bf16_f32 v182, v84, v85
    v_cvt_pk_bf16_f32 v198, v86, v87
    v_fma_f32 v68, v240, v74, v226
    v_fma_f32 v69, v240, v75, v234
    v_fma_f32 v70, v242, v76, v230
    v_fma_f32 v71, v242, v77, v238
    v_fma_f32 v68, -v241, v75, v68
    v_fma_f32 v75, v241, v74, v69
    v_mov_b32_e64 v74, v68
    v_fma_f32 v70, -v243, v77, v70
    v_fma_f32 v77, v243, v76, v71
    v_mov_b32 v76, v70
    v_mul_f32 v80, v17, v74
    v_mul_f32 v82, -v17, v75
    v_fma_f32 v80, -v18, v75, v80
    v_fma_f32 v82, -v18, v74, v82
    v_mul_f32_e64 v84, v19, v76
    v_mul_f32 v86, -v19, v77
    v_fma_f32 v84, -v20, v77, v84
    v_fma_f32 v86, -v20, v76, v86
    v_fma_f32 v68, v240, v74, v227
    v_fma_f32 v69, v240, v75, v235
    v_fma_f32 v70, v242, v76, v231
    v_fma_f32 v71, v242, v77, v239
    v_fma_f32 v68, -v241, v75, v68
    v_fma_f32 v75, v241, v74, v69
    v_mov_b32_e64 v74, v68
    v_fma_f32 v70, -v243, v77, v70
    v_fma_f32 v77, v243, v76, v71
    v_mov_b32 v76, v70
    v_mul_f32 v81, v17, v74
    v_mul_f32 v83, -v17, v75
    v_fma_f32 v81, -v18, v75, v81
    v_fma_f32 v83, -v18, v74, v83
    v_mul_f32_e64 v85, v19, v76
    v_mul_f32 v87, -v19, v77
    v_fma_f32 v85, -v20, v77, v85
    v_fma_f32 v87, -v20, v76, v87
    v_cvt_pk_bf16_f32 v175, v80, v81
    v_cvt_pk_bf16_f32 v191, v82, v83
    v_cvt_pk_bf16_f32 v183, v84, v85
    v_cvt_pk_bf16_f32 v199, v86, v87
    s_waitcnt vmcnt(0)
    s_barrier
    v_mov_b32 v94, 2
    v_min_u32 v95, 1, v0
    v_lshlrev_b32_e64 v95, 30, v95
    buffer_store_dword v94, v95, s[8:11], s4 offen sc1
    s_and_b32 s5, s2, 4
    s_nop 0
    s_bfe_u32 s6, s2, 0x20003
    s_add_u32 s5, s5, s6
    s_lshl_b32 s5, s5, 12
    s_add_u32 s5, s5, 42467328
    s_and_b32 s6, s2, 3
    s_lshl_b32 s6, s6, 8
    s_add_u32 s6, s6, s5
    v_and_b32 v161, 7, v0
    v_lshlrev_b32_e64 v161, 2, v161
    v_bfe_u32 v160, v0, 3, 2
    v_lshl_add_u32 v160, v160, 8, v161
    buffer_load_dword v162, v161, s[8:11], s6 offen sc1
    v_and_b32_e64 v88, 15, v0
    v_bfe_u32 v89, v0, 4, 2
    s_lshl_b32 s34, s31, 13
    s_nop 0
    s_add_u32 s34, s34, 16384
    v_lshlrev_b32_e64 v90, 7, v88
    v_lshl_add_u32 v90, v89, 5, v90
    v_add_u32_e64 v90, s34, v90
    v_bfe_u32 v91, v0, 1, 2
    v_xor_b32_e64 v92, 0, v91
    v_lshl_add_u32 v96, v92, 3, v90
    v_xor_b32_e64 v92, 1, v91
    v_lshl_add_u32 v97, v92, 3, v90
    v_xor_b32_e64 v92, 2, v91
    v_lshl_add_u32 v98, v92, 3, v90
    v_xor_b32_e64 v92, 3, v91
    v_lshl_add_u32 v99, v92, 3, v90
    ds_write_b64 v96, v[168:169] offset:0
    ds_write_b64 v97, v[170:171] offset:0
    ds_write_b64 v98, v[172:173] offset:0
    ds_write_b64 v99, v[174:175] offset:0
    ds_write_b64 v96, v[176:177] offset:2048
    ds_write_b64 v97, v[178:179] offset:2048
    ds_write_b64 v98, v[180:181] offset:2048
    ds_write_b64 v99, v[182:183] offset:2048
    ds_write_b64 v96, v[184:185] offset:4096
    ds_write_b64 v97, v[186:187] offset:4096
    ds_write_b64 v98, v[188:189] offset:4096
    ds_write_b64 v99, v[190:191] offset:4096
    ds_write_b64 v96, v[192:193] offset:6144
    ds_write_b64 v97, v[194:195] offset:6144
    ds_write_b64 v98, v[196:197] offset:6144
    ds_write_b64 v99, v[198:199] offset:6144
    v_bfe_u32 v91, v0, 2, 2
    v_and_b32_e64 v92, 1, v89
    v_lshl_add_u32 v90, v92, 3, v91
    v_lshlrev_b32 v90, 7, v90
    v_lshrrev_b32 v92, 1, v89
    v_lshl_add_u32 v90, v92, 11, v90
    v_and_b32_e64 v92, 3, v0
    v_lshl_add_u32 v90, v92, 5, v90
    v_add_u32 v90, s34, v90
    v_lshrrev_b32 v91, 1, v91
    v_xor_b32_e64 v92, 0, v91
    v_lshl_add_u32 v100, v92, 3, v90
    v_xor_b32_e64 v92, 1, v91
    v_lshl_add_u32 v101, v92, 3, v90
    v_xor_b32_e64 v92, 2, v91
    v_lshl_add_u32 v102, v92, 3, v90
    v_xor_b32_e64 v92, 3, v91
    v_lshl_add_u32 v103, v92, 3, v90
    v_and_b32 v88, 63, v0
    v_lshlrev_b32_e64 v88, 4, v88
    s_lshl_b32 s34, s33, 17
    s_lshl_b32 s35, s32, 14
    s_add_u32 s34, s34, s35
    s_lshl_b32 s35, s31, 12
    s_add_u32 s34, s34, s35
    s_add_u32 s34, s34, 16777216
    s_add_u32 s35, s34, 4194304
    s_waitcnt lgkmcnt(0)
    s_nop 0
    ds_read_b64_tr_b16 v[32:33], v100 offset:0
    ds_read_b64_tr_b16 v[34:35], v102 offset:512
    ds_read_b64_tr_b16 v[36:37], v101 offset:0
    ds_read_b64_tr_b16 v[38:39], v103 offset:512
    ds_read_b64_tr_b16 v[40:41], v102 offset:0
    ds_read_b64_tr_b16 v[42:43], v100 offset:512
    ds_read_b64_tr_b16 v[44:45], v103 offset:0
    ds_read_b64_tr_b16 v[46:47], v101 offset:512
    ds_read_b64_tr_b16 v[48:49], v100 offset:4096
    ds_read_b64_tr_b16 v[50:51], v102 offset:4608
    ds_read_b64_tr_b16 v[52:53], v101 offset:4096
    ds_read_b64_tr_b16 v[54:55], v103 offset:4608
    ds_read_b64_tr_b16 v[56:57], v102 offset:4096
    ds_read_b64_tr_b16 v[58:59], v100 offset:4608
    ds_read_b64_tr_b16 v[60:61], v103 offset:4096
    ds_read_b64_tr_b16 v[62:63], v101 offset:4608
    s_waitcnt lgkmcnt(14)
    s_nop 0
    buffer_store_dwordx4 v[32:35], v88, s[8:11], s34 offen offset:0 sc1
    s_waitcnt lgkmcnt(12)
    s_nop 0
    buffer_store_dwordx4 v[36:39], v88, s[8:11], s34 offen offset:1024 sc1
    s_waitcnt lgkmcnt(10)
    s_nop 0
    buffer_store_dwordx4 v[40:43], v88, s[8:11], s34 offen offset:2048 sc1
    s_waitcnt lgkmcnt(8)
    s_nop 0
    buffer_store_dwordx4 v[44:47], v88, s[8:11], s34 offen offset:3072 sc1
    s_waitcnt lgkmcnt(6)
    s_nop 0
    buffer_store_dwordx4 v[48:51], v88, s[8:11], s35 offen offset:0 sc1
    s_waitcnt lgkmcnt(4)
    s_nop 0
    buffer_store_dwordx4 v[52:55], v88, s[8:11], s35 offen offset:1024 sc1
    s_waitcnt lgkmcnt(2)
    s_nop 0
    buffer_store_dwordx4 v[56:59], v88, s[8:11], s35 offen offset:2048 sc1
    s_waitcnt lgkmcnt(0)
    s_nop 0
    buffer_store_dwordx4 v[60:63], v88, s[8:11], s35 offen offset:3072 sc1
L_k1_end:
    s_mov_b64 exec, -1
    s_barrier
    s_load_dwordx2 s[40:41], s[0:1], 96
    s_load_dwordx4 s[44:47], s[0:1], 104
    s_load_dwordx2 s[48:49], s[0:1], 120
    s_load_dwordx2 s[50:51], s[0:1], 0
    s_load_dwordx2 s[52:53], s[0:1], 64
    s_load_dwordx4 s[56:59], s[0:1], 40
    s_getpc_b64 s[64:65]
    L_k2_pca:
    s_nop 0
    s_and_b32 s65, s65, 0xffff
    s_mov_b32 s66, L_k2_end-L_k2_pca
    s_mov_b32 s67, 0x20000
    s_and_b32 s68, s2, 56
    s_cmp_eq_u32 s68, 0
    s_cselect_b32 s68, 0, 0x40000000
    v_lshlrev_b32 v222, 7, v0
    s_add_u32 s69, s68, L_k2_loopc-L_k2_pca
    v_lshrrev_b32 v22, 6, v0
    v_and_b32 v23, 63, v0
    s_and_b32 s34, s2, 7
    s_lshr_b32 s35, s2, 3
    v_readfirstlane_b32 s26, v22
    s_and_b32 s29, s34, 3
    s_lshr_b32 s36, s34, 2
    s_lshl_b32 s36, s36, 2
    s_and_b32 s37, s35, 3
    s_add_u32 s27, s36, s37
    s_lshr_b32 s28, s35, 2
    v_lshlrev_b32 v24, 4, v23
    s_add_u32 s36, s29, 0
    s_and_b32 s36, s36, 3
    s_lshl_b32 s36, s36, 10
    v_add_u32 v1, s36, v24
    s_add_u32 s36, s29, 1
    s_and_b32 s36, s36, 3
    s_lshl_b32 s36, s36, 10
    v_add_u32 v2, s36, v24
    s_add_u32 s36, s29, 2
    s_and_b32 s36, s36, 3
    s_lshl_b32 s36, s36, 10
    v_add_u32 v3, s36, v24
    s_add_u32 s36, s29, 3
    s_and_b32 s36, s36, 3
    s_lshl_b32 s36, s36, 10
    v_add_u32 v28, s36, v24
    v_lshrrev_b32_e64 v24, 4, v23
    v_bfe_u32 v25, v23, 1, 3
    v_and_b32 v26, 1, v23
    v_lshlrev_b32 v26, 4, v26
    v_lshl_add_u32 v26, v24, 11, v26
    s_lshl_b32 s36, s28, 8
    s_lshl_b32 s37, s26, 14
    s_add_u32 s36, s36, s37
    v_add_u32 v26, s36, v26
    v_xor_b32_e64 v27, v24, v25
    v_lshl_add_u32 v29, v27, 5, v26
    v_xor_b32_e64 v27, 4, v27
    v_lshl_add_u32 v30, v27, 5, v26
    v_add_u32 v30, 7168, v30
    v_lshrrev_b32 v24, 2, v23
    s_lshl_b32 s36, s28, 7
    s_lshl_b32 s37, s26, 5
    s_add_u32 s36, s36, s37
    v_add_u32 v24, s36, v24
    v_lshlrev_b32 v24, 11, v24
    v_lshrrev_b32 v25, 4, v23
    v_and_b32 v26, 3, v23
    v_xor_b32_e64 v25, v25, v26
    v_lshl_add_u32 v12, v25, 4, v24
    v_add_u32 v13, 31744, v12
    v_lshrrev_b32_e64 v24, 4, v23
    v_bfe_u32 v25, v23, 2, 2
    v_and_b32_e64 v26, 3, v23
    v_lshl_add_u32 v27, v24, 2, v25
    v_and_b32 v25, 7, v27
    v_lshlrev_b32 v27, 8, v27
    v_lshl_add_u32 v27, v26, 3, v27
    v_xor_b32_e64 v26, 0, v25
    v_lshl_add_u32 v4, v26, 5, v27
    v_xor_b32_e64 v26, 1, v25
    v_lshl_add_u32 v5, v26, 5, v27
    v_xor_b32_e64 v26, 2, v25
    v_lshl_add_u32 v6, v26, 5, v27
    v_xor_b32_e64 v26, 3, v25
    v_lshl_add_u32 v7, v26, 5, v27
    v_xor_b32_e64 v26, 4, v25
    v_lshl_add_u32 v8, v26, 5, v27
    v_xor_b32_e64 v26, 5, v25
    v_lshl_add_u32 v9, v26, 5, v27
    v_xor_b32_e64 v26, 6, v25
    v_lshl_add_u32 v10, v26, 5, v27
    v_xor_b32_e64 v26, 7, v25
    v_lshl_add_u32 v11, v26, 5, v27
    v_and_b32 v25, 15, v23
    v_lshrrev_b32 v26, 2, v25
    v_xor_b32 v26, v26, v24
    v_lshlrev_b32 v26, 4, v26
    v_lshl_add_u32 v14, v25, 6, v26
    s_lshl_b32 s24, s26, 11
    s_nop 0
    s_sub_u32 s24, s24, 256
    s_mul_i32 s36, s29, 28
    s_lshl_b32 s22, s36, 16
    s_add_u32 s36, s36, 64
    s_lshl_b32 s20, s36, 17
    s_lshl_b32 s36, s27, 14
    s_add_u32 s20, s20, s36
    s_lshl_b32 s36, s26, 12
    s_add_u32 s20, s20, s36
    s_add_u32 s20, s20, 16777216
    s_mul_i32 s36, s29, 12
    s_nop 0
    s_add_u32 s36, s36, 91
    s_lshl_b32 s36, s36, 17
    s_sub_u32 s21, 0, s36
    s_and_b32 s36, s29, 1
    s_lshl_b32 s23, s36, 10
    v_and_b32 v24, 15, v23
    v_lshrrev_b32 v25, 4, v23
    v_lshrrev_b32 v26, 2, v24
    v_lshlrev_b32 v26, 4, v26
    v_and_b32 v27, 3, v24
    v_add_u32 v26, v26, v27
    s_lshl_b32 s36, s27, 8
    s_lshl_b32 s37, s26, 6
    s_add_u32 s36, s36, s37
    s_lshl_b32 s37, s29, 2
    s_add_u32 s36, s36, s37
    v_add_u32 v31, s36, v26
    s_waitcnt lgkmcnt(0)
    s_mov_b32 s8, s48
    s_and_b32 s9, s49, 0xffff
    s_mov_b32 s10, 0x10000000
    s_mov_b32 s11, 0x20000
    s_mov_b32 s12, s40
    s_nop 0
    s_and_b32 s13, s41, 0xffff
    s_mov_b32 s14, 7340032
    s_mov_b32 s15, 0x20000
    s_cmp_lt_u32 s29, 2
    s_cselect_b32 s16, s56, s58
    s_cselect_b32 s36, s57, s59
    s_nop 0
    s_and_b32 s17, s36, 0xffff
    s_mov_b32 s18, 2097152
    s_mov_b32 s19, 0x20000
    s_add_u32 m0, s24, 256
    s_nop 0
    s_nop 0
    buffer_load_dwordx4 v29, s[12:15], s22 offen lds
    buffer_load_dwordx4 v30, s[12:15], s22 offen offset:1024 lds
    s_add_u32 s22, s22, 65536
    s_add_u32 m0, s24, 8448
    s_nop 0
    s_nop 0
    buffer_load_dwordx4 v29, s[12:15], s22 offen lds
    buffer_load_dwordx4 v30, s[12:15], s22 offen offset:1024 lds
    s_add_u32 s22, s22, 65536
    s_add_u32 m0, s24, 16640
    s_nop 0
    s_nop 0
    buffer_load_dwordx4 v29, s[12:15], s22 offen lds
    buffer_load_dwordx4 v30, s[12:15], s22 offen offset:1024 lds
    s_add_u32 s22, s22, 65536
    s_add_u32 m0, s24, 24832
    s_nop 0
    s_nop 0
    buffer_load_dwordx4 v29, s[12:15], s22 offen lds
    buffer_load_dwordx4 v30, s[12:15], s22 offen offset:1024 lds
    s_add_u32 s22, s22, 65536
    s_waitcnt vmcnt(16)
    s_mov_b32 s96, 2
    s_mov_b32 s97, 0x4000
    s_branch L_k2_fg_chk
L_k2_fg:
    s_nop 0
    buffer_load_dword v162, v161, s[8:11], s6 offen sc1
    s_waitcnt vmcnt(0)
L_k2_fg_chk:
    v_and_b32 v162, s96, v162
    v_cmp_ne_u32 vcc, s96, v162
    s_sub_u32 s97, s97, 1
    s_cbranch_scc1 L_k2_fg_ok
    s_sleep 3
    s_cmp_lg_u64 vcc, 0
    s_cbranch_scc1 L_k2_fg
L_k2_fg_ok:
    buffer_load_dwordx4 v[96:99], v1, s[8:11], s20 offen
    buffer_load_dwordx4 v[100:103], v2, s[8:11], s20 offen
    buffer_load_dwordx4 v[104:107], v3, s[8:11], s20 offen
    buffer_load_dwordx4 v[108:111], v28, s[8:11], s20 offen
    s_add_u32 s20, s20, 131072
    buffer_load_dwordx4 v[112:115], v1, s[8:11], s20 offen
    buffer_load_dwordx4 v[116:119], v2, s[8:11], s20 offen
    buffer_load_dwordx4 v[120:123], v3, s[8:11], s20 offen
    buffer_load_dwordx4 v[124:127], v28, s[8:11], s20 offen
    s_add_u32 s20, s20, 131072
    buffer_load_dwordx4 v[128:131], v1, s[8:11], s20 offen
    buffer_load_dwordx4 v[132:135], v2, s[8:11], s20 offen
    buffer_load_dwordx4 v[136:139], v3, s[8:11], s20 offen
    buffer_load_dwordx4 v[140:143], v28, s[8:11], s20 offen
    s_add_u32 s20, s20, 131072
    buffer_load_dwordx4 v[144:147], v1, s[8:11], s20 offen
    buffer_load_dwordx4 v[148:151], v2, s[8:11], s20 offen
    buffer_load_dwordx4 v[152:155], v3, s[8:11], s20 offen
    buffer_load_dwordx4 v[156:159], v28, s[8:11], s20 offen
    v_accvgpr_write_b32 a0, 0
    v_accvgpr_write_b32 a1, 0
    v_accvgpr_write_b32 a2, 0
    v_accvgpr_write_b32 a3, 0
    v_accvgpr_write_b32 a4, 0
    v_accvgpr_write_b32 a5, 0
    v_accvgpr_write_b32 a6, 0
    v_accvgpr_write_b32 a7, 0
    v_accvgpr_write_b32 a8, 0
    v_accvgpr_write_b32 a9, 0
    v_accvgpr_write_b32 a10, 0
    v_accvgpr_write_b32 a11, 0
    v_accvgpr_write_b32 a12, 0
    v_accvgpr_write_b32 a13, 0
    v_accvgpr_write_b32 a14, 0
    v_accvgpr_write_b32 a15, 0
    v_accvgpr_write_b32 a16, 0
    v_accvgpr_write_b32 a17, 0
    v_accvgpr_write_b32 a18, 0
    v_accvgpr_write_b32 a19, 0
    v_accvgpr_write_b32 a20, 0
    v_accvgpr_write_b32 a21, 0
    v_accvgpr_write_b32 a22, 0
    v_accvgpr_write_b32 a23, 0
    v_accvgpr_write_b32 a24, 0
    v_accvgpr_write_b32 a25, 0
    v_accvgpr_write_b32 a26, 0
    v_accvgpr_write_b32 a27, 0
    v_accvgpr_write_b32 a28, 0
    v_accvgpr_write_b32 a29, 0
    v_accvgpr_write_b32 a30, 0
    v_accvgpr_write_b32 a31, 0
    v_accvgpr_write_b32 a32, 0
    v_accvgpr_write_b32 a33, 0
    v_accvgpr_write_b32 a34, 0
    v_accvgpr_write_b32 a35, 0
    v_accvgpr_write_b32 a36, 0
    v_accvgpr_write_b32 a37, 0
    v_accvgpr_write_b32 a38, 0
    v_accvgpr_write_b32 a39, 0
    v_accvgpr_write_b32 a40, 0
    v_accvgpr_write_b32 a41, 0
    v_accvgpr_write_b32 a42, 0
    v_accvgpr_write_b32 a43, 0
    v_accvgpr_write_b32 a44, 0
    v_accvgpr_write_b32 a45, 0
    v_accvgpr_write_b32 a46, 0
    v_accvgpr_write_b32 a47, 0
    v_accvgpr_write_b32 a48, 0
    v_accvgpr_write_b32 a49, 0
    v_accvgpr_write_b32 a50, 0
    v_accvgpr_write_b32 a51, 0
    v_accvgpr_write_b32 a52, 0
    v_accvgpr_write_b32 a53, 0
    v_accvgpr_write_b32 a54, 0
    v_accvgpr_write_b32 a55, 0
    v_accvgpr_write_b32 a56, 0
    v_accvgpr_write_b32 a57, 0
    v_accvgpr_write_b32 a58, 0
    v_accvgpr_write_b32 a59, 0
    v_accvgpr_write_b32 a60, 0
    v_accvgpr_write_b32 a61, 0
    v_accvgpr_write_b32 a62, 0
    v_accvgpr_write_b32 a63, 0
    v_accvgpr_write_b32 a64, 0
    v_accvgpr_write_b32 a65, 0
    v_accvgpr_write_b32 a66, 0
    v_accvgpr_write_b32 a67, 0
    v_accvgpr_write_b32 a68, 0
    v_accvgpr_write_b32 a69, 0
    v_accvgpr_write_b32 a70, 0
    v_accvgpr_write_b32 a71, 0
    v_accvgpr_write_b32 a72, 0
    v_accvgpr_write_b32 a73, 0
    v_accvgpr_write_b32 a74, 0
    v_accvgpr_write_b32 a75, 0
    v_accvgpr_write_b32 a76, 0
    v_accvgpr_write_b32 a77, 0
    v_accvgpr_write_b32 a78, 0
    v_accvgpr_write_b32 a79, 0
    v_accvgpr_write_b32 a80, 0
    v_accvgpr_write_b32 a81, 0
    v_accvgpr_write_b32 a82, 0
    v_accvgpr_write_b32 a83, 0
    v_accvgpr_write_b32 a84, 0
    v_accvgpr_write_b32 a85, 0
    v_accvgpr_write_b32 a86, 0
    v_accvgpr_write_b32 a87, 0
    v_accvgpr_write_b32 a88, 0
    v_accvgpr_write_b32 a89, 0
    v_accvgpr_write_b32 a90, 0
    v_accvgpr_write_b32 a91, 0
    v_accvgpr_write_b32 a92, 0
    v_accvgpr_write_b32 a93, 0
    v_accvgpr_write_b32 a94, 0
    v_accvgpr_write_b32 a95, 0
    v_accvgpr_write_b32 a96, 0
    v_accvgpr_write_b32 a97, 0
    v_accvgpr_write_b32 a98, 0
    v_accvgpr_write_b32 a99, 0
    v_accvgpr_write_b32 a100, 0
    v_accvgpr_write_b32 a101, 0
    v_accvgpr_write_b32 a102, 0
    v_accvgpr_write_b32 a103, 0
    v_accvgpr_write_b32 a104, 0
    v_accvgpr_write_b32 a105, 0
    v_accvgpr_write_b32 a106, 0
    v_accvgpr_write_b32 a107, 0
    v_accvgpr_write_b32 a108, 0
    v_accvgpr_write_b32 a109, 0
    v_accvgpr_write_b32 a110, 0
    v_accvgpr_write_b32 a111, 0
    v_accvgpr_write_b32 a112, 0
    v_accvgpr_write_b32 a113, 0
    v_accvgpr_write_b32 a114, 0
    v_accvgpr_write_b32 a115, 0
    v_accvgpr_write_b32 a116, 0
    v_accvgpr_write_b32 a117, 0
    v_accvgpr_write_b32 a118, 0
    v_accvgpr_write_b32 a119, 0
    v_accvgpr_write_b32 a120, 0
    v_accvgpr_write_b32 a121, 0
    v_accvgpr_write_b32 a122, 0
    v_accvgpr_write_b32 a123, 0
    v_accvgpr_write_b32 a124, 0
    v_accvgpr_write_b32 a125, 0
    v_accvgpr_write_b32 a126, 0
    v_accvgpr_write_b32 a127, 0
    s_waitcnt vmcnt(16)
    s_barrier
    v_mov_b32 v225, 6
    v_min_u32 v227, 1, v0
    v_lshlrev_b32_e64 v227, 30, v227
    buffer_store_dword v225, v227, s[8:11], s4 offen sc1
    ds_read_b64_tr_b16 v[32:33], v4 offset:0
    ds_read_b64_tr_b16 v[34:35], v4 offset:4096
    ds_read_b64_tr_b16 v[36:37], v5 offset:0
    ds_read_b64_tr_b16 v[38:39], v5 offset:4096
    ds_read_b64_tr_b16 v[40:41], v6 offset:0
    ds_read_b64_tr_b16 v[42:43], v6 offset:4096
    ds_read_b64_tr_b16 v[44:45], v7 offset:0
    ds_read_b64_tr_b16 v[46:47], v7 offset:4096
    ds_read_b64_tr_b16 v[48:49], v8 offset:0
    ds_read_b64_tr_b16 v[50:51], v8 offset:4096
    ds_read_b64_tr_b16 v[52:53], v9 offset:0
    ds_read_b64_tr_b16 v[54:55], v9 offset:4096
    ds_read_b64_tr_b16 v[56:57], v10 offset:0
    ds_read_b64_tr_b16 v[58:59], v10 offset:4096
    ds_read_b64_tr_b16 v[60:61], v11 offset:0
    ds_read_b64_tr_b16 v[62:63], v11 offset:4096
    s_waitcnt vmcnt(9)
    s_nop 0
    s_add_u32 s98, s5, 1342177280
    s_mov_b32 s25, 5
.p2align 6
L_k2_loopw:
    s_waitcnt vmcnt(16) lgkmcnt(0)
    s_barrier
    v_mfma_f32_16x16x32_bf16 a[0:3], v[32:35], v[96:99], a[0:3]
    s_add_u32 s20, s20, 131072
    buffer_load_dword v226, v160, s[8:11], s98 offen sc1
    v_mfma_f32_16x16x32_bf16 a[4:7], v[36:39], v[96:99], a[4:7]
    s_add_u32 m0, s24, 256
    s_sub_u32 s98, s98, 0x10000000
    v_mfma_f32_16x16x32_bf16 a[8:11], v[40:43], v[96:99], a[8:11]
    ds_read_b64_tr_b16 v[64:65], v4 offset:8192
    ds_read_b64_tr_b16 v[66:67], v4 offset:12288
    v_mfma_f32_16x16x32_bf16 a[12:15], v[44:47], v[96:99], a[12:15]
    buffer_load_dwordx4 v29, s[12:15], s22 offen lds
    ds_read_b64_tr_b16 v[68:69], v5 offset:8192
    v_mfma_f32_16x16x32_bf16 a[16:19], v[48:51], v[96:99], a[16:19]
    buffer_load_dwordx4 v30, s[12:15], s22 offen offset:1024 lds
    ds_read_b64_tr_b16 v[70:71], v5 offset:12288
    v_mfma_f32_16x16x32_bf16 a[20:23], v[52:55], v[96:99], a[20:23]
    s_add_u32 s22, s22, 65536
    ds_read_b64_tr_b16 v[72:73], v6 offset:8192
    v_mfma_f32_16x16x32_bf16 a[24:27], v[56:59], v[96:99], a[24:27]
    ds_read_b64_tr_b16 v[74:75], v6 offset:12288
    ds_read_b64_tr_b16 v[76:77], v7 offset:8192
    v_mfma_f32_16x16x32_bf16 a[28:31], v[60:63], v[96:99], a[28:31]
    buffer_load_dwordx4 v[96:99], v1, s[8:11], s20 offen
    ds_read_b64_tr_b16 v[78:79], v7 offset:12288
    v_mfma_f32_16x16x32_bf16 a[32:35], v[32:35], v[100:103], a[32:35]
    ds_read_b64_tr_b16 v[80:81], v8 offset:8192
    v_mfma_f32_16x16x32_bf16 a[36:39], v[36:39], v[100:103], a[36:39]
    ds_read_b64_tr_b16 v[82:83], v8 offset:12288
    v_mfma_f32_16x16x32_bf16 a[40:43], v[40:43], v[100:103], a[40:43]
    ds_read_b64_tr_b16 v[84:85], v9 offset:8192
    v_mfma_f32_16x16x32_bf16 a[44:47], v[44:47], v[100:103], a[44:47]
    ds_read_b64_tr_b16 v[86:87], v9 offset:12288
    v_mfma_f32_16x16x32_bf16 a[48:51], v[48:51], v[100:103], a[48:51]
    ds_read_b64_tr_b16 v[88:89], v10 offset:8192
    v_mfma_f32_16x16x32_bf16 a[52:55], v[52:55], v[100:103], a[52:55]
    ds_read_b64_tr_b16 v[90:91], v10 offset:12288
    v_mfma_f32_16x16x32_bf16 a[56:59], v[56:59], v[100:103], a[56:59]
    ds_read_b64_tr_b16 v[92:93], v11 offset:8192
    v_mfma_f32_16x16x32_bf16 a[60:63], v[60:63], v[100:103], a[60:63]
    buffer_load_dwordx4 v[100:103], v2, s[8:11], s20 offen
    v_mfma_f32_16x16x32_bf16 a[64:67], v[32:35], v[104:107], a[64:67]
    ds_read_b64_tr_b16 v[94:95], v11 offset:12288
    v_mfma_f32_16x16x32_bf16 a[68:71], v[36:39], v[104:107], a[68:71]
    v_mfma_f32_16x16x32_bf16 a[72:75], v[40:43], v[104:107], a[72:75]
    v_mfma_f32_16x16x32_bf16 a[76:79], v[44:47], v[104:107], a[76:79]
    v_mfma_f32_16x16x32_bf16 a[80:83], v[48:51], v[104:107], a[80:83]
    v_mfma_f32_16x16x32_bf16 a[84:87], v[52:55], v[104:107], a[84:87]
    v_mfma_f32_16x16x32_bf16 a[88:91], v[56:59], v[104:107], a[88:91]
    v_mfma_f32_16x16x32_bf16 a[92:95], v[60:63], v[104:107], a[92:95]
    buffer_load_dwordx4 v[104:107], v3, s[8:11], s20 offen
    v_mfma_f32_16x16x32_bf16 a[96:99], v[32:35], v[108:111], a[96:99]
    v_mfma_f32_16x16x32_bf16 a[100:103], v[36:39], v[108:111], a[100:103]
    v_mfma_f32_16x16x32_bf16 a[104:107], v[40:43], v[108:111], a[104:107]
    v_mfma_f32_16x16x32_bf16 a[108:111], v[44:47], v[108:111], a[108:111]
    v_mfma_f32_16x16x32_bf16 a[112:115], v[48:51], v[108:111], a[112:115]
    v_mfma_f32_16x16x32_bf16 a[116:119], v[52:55], v[108:111], a[116:119]
    v_mfma_f32_16x16x32_bf16 a[120:123], v[56:59], v[108:111], a[120:123]
    v_mfma_f32_16x16x32_bf16 a[124:127], v[60:63], v[108:111], a[124:127]
    buffer_load_dwordx4 v[108:111], v28, s[8:11], s20 offen
    s_waitcnt vmcnt(17) lgkmcnt(0)
    s_barrier
    v_mfma_f32_16x16x32_bf16 a[0:3], v[64:67], v[112:115], a[0:3]
    s_add_u32 s20, s20, 131072
    v_mfma_f32_16x16x32_bf16 a[4:7], v[68:71], v[112:115], a[4:7]
    s_add_u32 m0, s24, 8448
    v_mfma_f32_16x16x32_bf16 a[8:11], v[72:75], v[112:115], a[8:11]
    ds_read_b64_tr_b16 v[32:33], v4 offset:16384
    ds_read_b64_tr_b16 v[34:35], v4 offset:20480
    v_mfma_f32_16x16x32_bf16 a[12:15], v[76:79], v[112:115], a[12:15]
    buffer_load_dwordx4 v29, s[12:15], s22 offen lds
    ds_read_b64_tr_b16 v[36:37], v5 offset:16384
    v_mfma_f32_16x16x32_bf16 a[16:19], v[80:83], v[112:115], a[16:19]
    buffer_load_dwordx4 v30, s[12:15], s22 offen offset:1024 lds
    ds_read_b64_tr_b16 v[38:39], v5 offset:20480
    v_mfma_f32_16x16x32_bf16 a[20:23], v[84:87], v[112:115], a[20:23]
    s_add_u32 s22, s22, 65536
    ds_read_b64_tr_b16 v[40:41], v6 offset:16384
    v_mfma_f32_16x16x32_bf16 a[24:27], v[88:91], v[112:115], a[24:27]
    ds_read_b64_tr_b16 v[42:43], v6 offset:20480
    ds_read_b64_tr_b16 v[44:45], v7 offset:16384
    v_mfma_f32_16x16x32_bf16 a[28:31], v[92:95], v[112:115], a[28:31]
    buffer_load_dwordx4 v[112:115], v1, s[8:11], s20 offen
    ds_read_b64_tr_b16 v[46:47], v7 offset:20480
    v_mfma_f32_16x16x32_bf16 a[32:35], v[64:67], v[116:119], a[32:35]
    ds_read_b64_tr_b16 v[48:49], v8 offset:16384
    v_mfma_f32_16x16x32_bf16 a[36:39], v[68:71], v[116:119], a[36:39]
    ds_read_b64_tr_b16 v[50:51], v8 offset:20480
    v_mfma_f32_16x16x32_bf16 a[40:43], v[72:75], v[116:119], a[40:43]
    ds_read_b64_tr_b16 v[52:53], v9 offset:16384
    v_mfma_f32_16x16x32_bf16 a[44:47], v[76:79], v[116:119], a[44:47]
    ds_read_b64_tr_b16 v[54:55], v9 offset:20480
    v_mfma_f32_16x16x32_bf16 a[48:51], v[80:83], v[116:119], a[48:51]
    ds_read_b64_tr_b16 v[56:57], v10 offset:16384
    v_mfma_f32_16x16x32_bf16 a[52:55], v[84:87], v[116:119], a[52:55]
    ds_read_b64_tr_b16 v[58:59], v10 offset:20480
    v_mfma_f32_16x16x32_bf16 a[56:59], v[88:91], v[116:119], a[56:59]
    ds_read_b64_tr_b16 v[60:61], v11 offset:16384
    v_mfma_f32_16x16x32_bf16 a[60:63], v[92:95], v[116:119], a[60:63]
    buffer_load_dwordx4 v[116:119], v2, s[8:11], s20 offen
    v_mfma_f32_16x16x32_bf16 a[64:67], v[64:67], v[120:123], a[64:67]
    ds_read_b64_tr_b16 v[62:63], v11 offset:20480
    v_mfma_f32_16x16x32_bf16 a[68:71], v[68:71], v[120:123], a[68:71]
    v_mfma_f32_16x16x32_bf16 a[72:75], v[72:75], v[120:123], a[72:75]
    v_mfma_f32_16x16x32_bf16 a[76:79], v[76:79], v[120:123], a[76:79]
    v_mfma_f32_16x16x32_bf16 a[80:83], v[80:83], v[120:123], a[80:83]
    v_mfma_f32_16x16x32_bf16 a[84:87], v[84:87], v[120:123], a[84:87]
    v_mfma_f32_16x16x32_bf16 a[88:91], v[88:91], v[120:123], a[88:91]
    v_mfma_f32_16x16x32_bf16 a[92:95], v[92:95], v[120:123], a[92:95]
    buffer_load_dwordx4 v[120:123], v3, s[8:11], s20 offen
    v_mfma_f32_16x16x32_bf16 a[96:99], v[64:67], v[124:127], a[96:99]
    v_mfma_f32_16x16x32_bf16 a[100:103], v[68:71], v[124:127], a[100:103]
    v_mfma_f32_16x16x32_bf16 a[104:107], v[72:75], v[124:127], a[104:107]
    v_mfma_f32_16x16x32_bf16 a[108:111], v[76:79], v[124:127], a[108:111]
    v_mfma_f32_16x16x32_bf16 a[112:115], v[80:83], v[124:127], a[112:115]
    v_mfma_f32_16x16x32_bf16 a[116:119], v[84:87], v[124:127], a[116:119]
    v_mfma_f32_16x16x32_bf16 a[120:123], v[88:91], v[124:127], a[120:123]
    v_mfma_f32_16x16x32_bf16 a[124:127], v[92:95], v[124:127], a[124:127]
    buffer_load_dwordx4 v[124:127], v28, s[8:11], s20 offen
    s_waitcnt vmcnt(17) lgkmcnt(0)
    s_barrier
    v_mfma_f32_16x16x32_bf16 a[0:3], v[32:35], v[128:131], a[0:3]
    s_add_u32 s20, s20, 131072
    v_mfma_f32_16x16x32_bf16 a[4:7], v[36:39], v[128:131], a[4:7]
    s_add_u32 m0, s24, 16640
    v_mfma_f32_16x16x32_bf16 a[8:11], v[40:43], v[128:131], a[8:11]
    ds_read_b64_tr_b16 v[64:65], v4 offset:24576
    ds_read_b64_tr_b16 v[66:67], v4 offset:28672
    v_mfma_f32_16x16x32_bf16 a[12:15], v[44:47], v[128:131], a[12:15]
    buffer_load_dwordx4 v29, s[12:15], s22 offen lds
    ds_read_b64_tr_b16 v[68:69], v5 offset:24576
    v_mfma_f32_16x16x32_bf16 a[16:19], v[48:51], v[128:131], a[16:19]
    buffer_load_dwordx4 v30, s[12:15], s22 offen offset:1024 lds
    ds_read_b64_tr_b16 v[70:71], v5 offset:28672
    v_mfma_f32_16x16x32_bf16 a[20:23], v[52:55], v[128:131], a[20:23]
    s_add_u32 s22, s22, 65536
    ds_read_b64_tr_b16 v[72:73], v6 offset:24576
    v_mfma_f32_16x16x32_bf16 a[24:27], v[56:59], v[128:131], a[24:27]
    ds_read_b64_tr_b16 v[74:75], v6 offset:28672
    ds_read_b64_tr_b16 v[76:77], v7 offset:24576
    v_mfma_f32_16x16x32_bf16 a[28:31], v[60:63], v[128:131], a[28:31]
    buffer_load_dwordx4 v[128:131], v1, s[8:11], s20 offen
    ds_read_b64_tr_b16 v[78:79], v7 offset:28672
    v_mfma_f32_16x16x32_bf16 a[32:35], v[32:35], v[132:135], a[32:35]
    ds_read_b64_tr_b16 v[80:81], v8 offset:24576
    v_mfma_f32_16x16x32_bf16 a[36:39], v[36:39], v[132:135], a[36:39]
    ds_read_b64_tr_b16 v[82:83], v8 offset:28672
    v_mfma_f32_16x16x32_bf16 a[40:43], v[40:43], v[132:135], a[40:43]
    ds_read_b64_tr_b16 v[84:85], v9 offset:24576
    v_mfma_f32_16x16x32_bf16 a[44:47], v[44:47], v[132:135], a[44:47]
    ds_read_b64_tr_b16 v[86:87], v9 offset:28672
    v_mfma_f32_16x16x32_bf16 a[48:51], v[48:51], v[132:135], a[48:51]
    ds_read_b64_tr_b16 v[88:89], v10 offset:24576
    v_mfma_f32_16x16x32_bf16 a[52:55], v[52:55], v[132:135], a[52:55]
    ds_read_b64_tr_b16 v[90:91], v10 offset:28672
    v_mfma_f32_16x16x32_bf16 a[56:59], v[56:59], v[132:135], a[56:59]
    ds_read_b64_tr_b16 v[92:93], v11 offset:24576
    v_mfma_f32_16x16x32_bf16 a[60:63], v[60:63], v[132:135], a[60:63]
    buffer_load_dwordx4 v[132:135], v2, s[8:11], s20 offen
    v_mfma_f32_16x16x32_bf16 a[64:67], v[32:35], v[136:139], a[64:67]
    ds_read_b64_tr_b16 v[94:95], v11 offset:28672
    v_mfma_f32_16x16x32_bf16 a[68:71], v[36:39], v[136:139], a[68:71]
    v_mfma_f32_16x16x32_bf16 a[72:75], v[40:43], v[136:139], a[72:75]
    v_mfma_f32_16x16x32_bf16 a[76:79], v[44:47], v[136:139], a[76:79]
    v_mfma_f32_16x16x32_bf16 a[80:83], v[48:51], v[136:139], a[80:83]
    v_mfma_f32_16x16x32_bf16 a[84:87], v[52:55], v[136:139], a[84:87]
    v_mfma_f32_16x16x32_bf16 a[88:91], v[56:59], v[136:139], a[88:91]
    v_mfma_f32_16x16x32_bf16 a[92:95], v[60:63], v[136:139], a[92:95]
    buffer_load_dwordx4 v[136:139], v3, s[8:11], s20 offen
    v_mfma_f32_16x16x32_bf16 a[96:99], v[32:35], v[140:143], a[96:99]
    v_mfma_f32_16x16x32_bf16 a[100:103], v[36:39], v[140:143], a[100:103]
    v_mfma_f32_16x16x32_bf16 a[104:107], v[40:43], v[140:143], a[104:107]
    v_mfma_f32_16x16x32_bf16 a[108:111], v[44:47], v[140:143], a[108:111]
    v_mfma_f32_16x16x32_bf16 a[112:115], v[48:51], v[140:143], a[112:115]
    v_mfma_f32_16x16x32_bf16 a[116:119], v[52:55], v[140:143], a[116:119]
    v_mfma_f32_16x16x32_bf16 a[120:123], v[56:59], v[140:143], a[120:123]
    v_mfma_f32_16x16x32_bf16 a[124:127], v[60:63], v[140:143], a[124:127]
    buffer_load_dwordx4 v[140:143], v28, s[8:11], s20 offen
    s_waitcnt vmcnt(16) lgkmcnt(0)
    s_barrier
    v_mfma_f32_16x16x32_bf16 a[0:3], v[64:67], v[144:147], a[0:3]
    s_add_u32 s20, s20, 131072
    v_mfma_f32_16x16x32_bf16 a[4:7], v[68:71], v[144:147], a[4:7]
    s_add_u32 m0, s24, 24832
    v_mfma_f32_16x16x32_bf16 a[8:11], v[72:75], v[144:147], a[8:11]
    ds_read_b64_tr_b16 v[32:33], v4 offset:0
    ds_read_b64_tr_b16 v[34:35], v4 offset:4096
    v_mfma_f32_16x16x32_bf16 a[12:15], v[76:79], v[144:147], a[12:15]
    buffer_load_dwordx4 v29, s[12:15], s22 offen lds
    ds_read_b64_tr_b16 v[36:37], v5 offset:0
    v_mfma_f32_16x16x32_bf16 a[16:19], v[80:83], v[144:147], a[16:19]
    buffer_load_dwordx4 v30, s[12:15], s22 offen offset:1024 lds
    ds_read_b64_tr_b16 v[38:39], v5 offset:4096
    v_mfma_f32_16x16x32_bf16 a[20:23], v[84:87], v[144:147], a[20:23]
    s_add_u32 s22, s22, 65536
    ds_read_b64_tr_b16 v[40:41], v6 offset:0
    v_mfma_f32_16x16x32_bf16 a[24:27], v[88:91], v[144:147], a[24:27]
    ds_read_b64_tr_b16 v[42:43], v6 offset:4096
    ds_read_b64_tr_b16 v[44:45], v7 offset:0
    v_mfma_f32_16x16x32_bf16 a[28:31], v[92:95], v[144:147], a[28:31]
    buffer_load_dwordx4 v[144:147], v1, s[8:11], s20 offen
    ds_read_b64_tr_b16 v[46:47], v7 offset:4096
    v_mfma_f32_16x16x32_bf16 a[32:35], v[64:67], v[148:151], a[32:35]
    ds_read_b64_tr_b16 v[48:49], v8 offset:0
    v_mfma_f32_16x16x32_bf16 a[36:39], v[68:71], v[148:151], a[36:39]
    ds_read_b64_tr_b16 v[50:51], v8 offset:4096
    v_mfma_f32_16x16x32_bf16 a[40:43], v[72:75], v[148:151], a[40:43]
    ds_read_b64_tr_b16 v[52:53], v9 offset:0
    v_mfma_f32_16x16x32_bf16 a[44:47], v[76:79], v[148:151], a[44:47]
    ds_read_b64_tr_b16 v[54:55], v9 offset:4096
    v_mfma_f32_16x16x32_bf16 a[48:51], v[80:83], v[148:151], a[48:51]
    ds_read_b64_tr_b16 v[56:57], v10 offset:0
    v_mfma_f32_16x16x32_bf16 a[52:55], v[84:87], v[148:151], a[52:55]
    ds_read_b64_tr_b16 v[58:59], v10 offset:4096
    v_mfma_f32_16x16x32_bf16 a[56:59], v[88:91], v[148:151], a[56:59]
    ds_read_b64_tr_b16 v[60:61], v11 offset:0
    v_mfma_f32_16x16x32_bf16 a[60:63], v[92:95], v[148:151], a[60:63]
    buffer_load_dwordx4 v[148:151], v2, s[8:11], s20 offen
    v_mfma_f32_16x16x32_bf16 a[64:67], v[64:67], v[152:155], a[64:67]
    ds_read_b64_tr_b16 v[62:63], v11 offset:4096
    v_mfma_f32_16x16x32_bf16 a[68:71], v[68:71], v[152:155], a[68:71]
    v_mfma_f32_16x16x32_bf16 a[72:75], v[72:75], v[152:155], a[72:75]
    v_mfma_f32_16x16x32_bf16 a[76:79], v[76:79], v[152:155], a[76:79]
    v_mfma_f32_16x16x32_bf16 a[80:83], v[80:83], v[152:155], a[80:83]
    v_mfma_f32_16x16x32_bf16 a[84:87], v[84:87], v[152:155], a[84:87]
    v_mfma_f32_16x16x32_bf16 a[88:91], v[88:91], v[152:155], a[88:91]
    v_mfma_f32_16x16x32_bf16 a[92:95], v[92:95], v[152:155], a[92:95]
    buffer_load_dwordx4 v[152:155], v3, s[8:11], s20 offen
    v_mfma_f32_16x16x32_bf16 a[96:99], v[64:67], v[156:159], a[96:99]
    v_mfma_f32_16x16x32_bf16 a[100:103], v[68:71], v[156:159], a[100:103]
    v_mfma_f32_16x16x32_bf16 a[104:107], v[72:75], v[156:159], a[104:107]
    v_mfma_f32_16x16x32_bf16 a[108:111], v[76:79], v[156:159], a[108:111]
    v_mfma_f32_16x16x32_bf16 a[112:115], v[80:83], v[156:159], a[112:115]
    v_mfma_f32_16x16x32_bf16 a[116:119], v[84:87], v[156:159], a[116:119]
    v_mfma_f32_16x16x32_bf16 a[120:123], v[88:91], v[156:159], a[120:123]
    v_mfma_f32_16x16x32_bf16 a[124:127], v[92:95], v[156:159], a[124:127]
    buffer_load_dwordx4 v[156:159], v28, s[8:11], s20 offen
    s_sub_u32 s25, s25, 1
    s_cbranch_scc0 L_k2_loopw
    s_mov_b32 s96, 4
    s_nop 0
    s_mov_b32 s97, 0x4000
    s_branch L_k2_fs_chk
L_k2_fs:
    s_nop 0
    buffer_load_dword v226, v160, s[8:11], s5 offen sc1
    s_waitcnt vmcnt(0)
L_k2_fs_chk:
    v_and_b32 v226, s96, v226
    v_cmp_ne_u32 vcc, s96, v226
    s_sub_u32 s97, s97, 1
    s_cbranch_scc1 L_k2_fs_ok
    s_sleep 3
    s_cmp_lg_u64 vcc, 0
    s_cbranch_scc1 L_k2_fs
L_k2_fs_ok:
    s_waitcnt vmcnt(16) lgkmcnt(0)
    s_barrier
    v_mfma_f32_16x16x32_bf16 a[0:3], v[32:35], v[96:99], a[0:3]
    s_add_u32 s20, s20, s21
    s_nop 0
    v_mfma_f32_16x16x32_bf16 a[4:7], v[36:39], v[96:99], a[4:7]
    s_add_u32 m0, s24, 256
    buffer_load_dword v223, v222, s[64:67], s69 offen
    v_mfma_f32_16x16x32_bf16 a[8:11], v[40:43], v[96:99], a[8:11]
    ds_read_b64_tr_b16 v[64:65], v4 offset:8192
    ds_read_b64_tr_b16 v[66:67], v4 offset:12288
    v_mfma_f32_16x16x32_bf16 a[12:15], v[44:47], v[96:99], a[12:15]
    buffer_load_dwordx4 v12, s[16:19], s23 offen lds
    ds_read_b64_tr_b16 v[68:69], v5 offset:8192
    v_mfma_f32_16x16x32_bf16 a[16:19], v[48:51], v[96:99], a[16:19]
    buffer_load_dwordx4 v13, s[16:19], s23 offen offset:1024 lds
    ds_read_b64_tr_b16 v[70:71], v5 offset:12288
    v_mfma_f32_16x16x32_bf16 a[20:23], v[52:55], v[96:99], a[20:23]
    s_sub_u32 s23, s23, -64
    ds_read_b64_tr_b16 v[72:73], v6 offset:8192
    v_mfma_f32_16x16x32_bf16 a[24:27], v[56:59], v[96:99], a[24:27]
    ds_read_b64_tr_b16 v[74:75], v6 offset:12288
    ds_read_b64_tr_b16 v[76:77], v7 offset:8192
    v_mfma_f32_16x16x32_bf16 a[28:31], v[60:63], v[96:99], a[28:31]
    buffer_load_dwordx4 v[96:99], v1, s[8:11], s20 offen
    ds_read_b64_tr_b16 v[78:79], v7 offset:12288
    v_mfma_f32_16x16x32_bf16 a[32:35], v[32:35], v[100:103], a[32:35]
    ds_read_b64_tr_b16 v[80:81], v8 offset:8192
    v_mfma_f32_16x16x32_bf16 a[36:39], v[36:39], v[100:103], a[36:39]
    ds_read_b64_tr_b16 v[82:83], v8 offset:12288
    v_mfma_f32_16x16x32_bf16 a[40:43], v[40:43], v[100:103], a[40:43]
    ds_read_b64_tr_b16 v[84:85], v9 offset:8192
    v_mfma_f32_16x16x32_bf16 a[44:47], v[44:47], v[100:103], a[44:47]
    ds_read_b64_tr_b16 v[86:87], v9 offset:12288
    v_mfma_f32_16x16x32_bf16 a[48:51], v[48:51], v[100:103], a[48:51]
    ds_read_b64_tr_b16 v[88:89], v10 offset:8192
    v_mfma_f32_16x16x32_bf16 a[52:55], v[52:55], v[100:103], a[52:55]
    ds_read_b64_tr_b16 v[90:91], v10 offset:12288
    v_mfma_f32_16x16x32_bf16 a[56:59], v[56:59], v[100:103], a[56:59]
    ds_read_b64_tr_b16 v[92:93], v11 offset:8192
    v_mfma_f32_16x16x32_bf16 a[60:63], v[60:63], v[100:103], a[60:63]
    buffer_load_dwordx4 v[100:103], v2, s[8:11], s20 offen
    v_mfma_f32_16x16x32_bf16 a[64:67], v[32:35], v[104:107], a[64:67]
    ds_read_b64_tr_b16 v[94:95], v11 offset:12288
    v_mfma_f32_16x16x32_bf16 a[68:71], v[36:39], v[104:107], a[68:71]
    v_mfma_f32_16x16x32_bf16 a[72:75], v[40:43], v[104:107], a[72:75]
    v_mfma_f32_16x16x32_bf16 a[76:79], v[44:47], v[104:107], a[76:79]
    v_mfma_f32_16x16x32_bf16 a[80:83], v[48:51], v[104:107], a[80:83]
    v_mfma_f32_16x16x32_bf16 a[84:87], v[52:55], v[104:107], a[84:87]
    v_mfma_f32_16x16x32_bf16 a[88:91], v[56:59], v[104:107], a[88:91]
    v_mfma_f32_16x16x32_bf16 a[92:95], v[60:63], v[104:107], a[92:95]
    buffer_load_dwordx4 v[104:107], v3, s[8:11], s20 offen
    v_mfma_f32_16x16x32_bf16 a[96:99], v[32:35], v[108:111], a[96:99]
    v_mfma_f32_16x16x32_bf16 a[100:103], v[36:39], v[108:111], a[100:103]
    v_mfma_f32_16x16x32_bf16 a[104:107], v[40:43], v[108:111], a[104:107]
    v_mfma_f32_16x16x32_bf16 a[108:111], v[44:47], v[108:111], a[108:111]
    v_mfma_f32_16x16x32_bf16 a[112:115], v[48:51], v[108:111], a[112:115]
    v_mfma_f32_16x16x32_bf16 a[116:119], v[52:55], v[108:111], a[116:119]
    v_mfma_f32_16x16x32_bf16 a[120:123], v[56:59], v[108:111], a[120:123]
    v_mfma_f32_16x16x32_bf16 a[124:127], v[60:63], v[108:111], a[124:127]
    buffer_load_dwordx4 v[108:111], v28, s[8:11], s20 offen
    s_waitcnt vmcnt(17) lgkmcnt(0)
    s_barrier
    v_mfma_f32_16x16x32_bf16 a[0:3], v[64:67], v[112:115], a[0:3]
    s_add_u32 s20, s20, 131072
    v_mfma_f32_16x16x32_bf16 a[4:7], v[68:71], v[112:115], a[4:7]
    s_add_u32 m0, s24, 8448
    v_mfma_f32_16x16x32_bf16 a[8:11], v[72:75], v[112:115], a[8:11]
    ds_read_b64_tr_b16 v[32:33], v4 offset:16384
    ds_read_b64_tr_b16 v[34:35], v4 offset:20480
    v_mfma_f32_16x16x32_bf16 a[12:15], v[76:79], v[112:115], a[12:15]
    buffer_load_dwordx4 v12, s[16:19], s23 offen lds
    ds_read_b64_tr_b16 v[36:37], v5 offset:16384
    v_mfma_f32_16x16x32_bf16 a[16:19], v[80:83], v[112:115], a[16:19]
    buffer_load_dwordx4 v13, s[16:19], s23 offen offset:1024 lds
    ds_read_b64_tr_b16 v[38:39], v5 offset:20480
    v_mfma_f32_16x16x32_bf16 a[20:23], v[84:87], v[112:115], a[20:23]
    s_sub_u32 s23, s23, -64
    ds_read_b64_tr_b16 v[40:41], v6 offset:16384
    v_mfma_f32_16x16x32_bf16 a[24:27], v[88:91], v[112:115], a[24:27]
    ds_read_b64_tr_b16 v[42:43], v6 offset:20480
    ds_read_b64_tr_b16 v[44:45], v7 offset:16384
    v_mfma_f32_16x16x32_bf16 a[28:31], v[92:95], v[112:115], a[28:31]
    buffer_load_dwordx4 v[112:115], v1, s[8:11], s20 offen
    ds_read_b64_tr_b16 v[46:47], v7 offset:20480
    v_mfma_f32_16x16x32_bf16 a[32:35], v[64:67], v[116:119], a[32:35]
    ds_read_b64_tr_b16 v[48:49], v8 offset:16384
    v_mfma_f32_16x16x32_bf16 a[36:39], v[68:71], v[116:119], a[36:39]
    ds_read_b64_tr_b16 v[50:51], v8 offset:20480
    v_mfma_f32_16x16x32_bf16 a[40:43], v[72:75], v[116:119], a[40:43]
    ds_read_b64_tr_b16 v[52:53], v9 offset:16384
    v_mfma_f32_16x16x32_bf16 a[44:47], v[76:79], v[116:119], a[44:47]
    ds_read_b64_tr_b16 v[54:55], v9 offset:20480
    v_mfma_f32_16x16x32_bf16 a[48:51], v[80:83], v[116:119], a[48:51]
    ds_read_b64_tr_b16 v[56:57], v10 offset:16384
    v_mfma_f32_16x16x32_bf16 a[52:55], v[84:87], v[116:119], a[52:55]
    ds_read_b64_tr_b16 v[58:59], v10 offset:20480
    v_mfma_f32_16x16x32_bf16 a[56:59], v[88:91], v[116:119], a[56:59]
    ds_read_b64_tr_b16 v[60:61], v11 offset:16384
    v_mfma_f32_16x16x32_bf16 a[60:63], v[92:95], v[116:119], a[60:63]
    buffer_load_dwordx4 v[116:119], v2, s[8:11], s20 offen
    v_mfma_f32_16x16x32_bf16 a[64:67], v[64:67], v[120:123], a[64:67]
    ds_read_b64_tr_b16 v[62:63], v11 offset:20480
    v_mfma_f32_16x16x32_bf16 a[68:71], v[68:71], v[120:123], a[68:71]
    v_mfma_f32_16x16x32_bf16 a[72:75], v[72:75], v[120:123], a[72:75]
    v_mfma_f32_16x16x32_bf16 a[76:79], v[76:79], v[120:123], a[76:79]
    v_mfma_f32_16x16x32_bf16 a[80:83], v[80:83], v[120:123], a[80:83]
    v_mfma_f32_16x16x32_bf16 a[84:87], v[84:87], v[120:123], a[84:87]
    v_mfma_f32_16x16x32_bf16 a[88:91], v[88:91], v[120:123], a[88:91]
    v_mfma_f32_16x16x32_bf16 a[92:95], v[92:95], v[120:123], a[92:95]
    buffer_load_dwordx4 v[120:123], v3, s[8:11], s20 offen
    v_mfma_f32_16x16x32_bf16 a[96:99], v[64:67], v[124:127], a[96:99]
    v_mfma_f32_16x16x32_bf16 a[100:103], v[68:71], v[124:127], a[100:103]
    v_mfma_f32_16x16x32_bf16 a[104:107], v[72:75], v[124:127], a[104:107]
    v_mfma_f32_16x16x32_bf16 a[108:111], v[76:79], v[124:127], a[108:111]
    v_mfma_f32_16x16x32_bf16 a[112:115], v[80:83], v[124:127], a[112:115]
    v_mfma_f32_16x16x32_bf16 a[116:119], v[84:87], v[124:127], a[116:119]
    v_mfma_f32_16x16x32_bf16 a[120:123], v[88:91], v[124:127], a[120:123]
    v_mfma_f32_16x16x32_bf16 a[124:127], v[92:95], v[124:127], a[124:127]
    buffer_load_dwordx4 v[124:127], v28, s[8:11], s20 offen
    s_waitcnt vmcnt(17) lgkmcnt(0)
    s_barrier
    v_mfma_f32_16x16x32_bf16 a[0:3], v[32:35], v[128:131], a[0:3]
    s_add_u32 s20, s20, 131072
    v_mfma_f32_16x16x32_bf16 a[4:7], v[36:39], v[128:131], a[4:7]
    s_add_u32 m0, s24, 16640
    v_mfma_f32_16x16x32_bf16 a[8:11], v[40:43], v[128:131], a[8:11]
    ds_read_b64_tr_b16 v[64:65], v4 offset:24576
    ds_read_b64_tr_b16 v[66:67], v4 offset:28672
    v_mfma_f32_16x16x32_bf16 a[12:15], v[44:47], v[128:131], a[12:15]
    buffer_load_dwordx4 v12, s[16:19], s23 offen lds
    ds_read_b64_tr_b16 v[68:69], v5 offset:24576
    v_mfma_f32_16x16x32_bf16 a[16:19], v[48:51], v[128:131], a[16:19]
    buffer_load_dwordx4 v13, s[16:19], s23 offen offset:1024 lds
    ds_read_b64_tr_b16 v[70:71], v5 offset:28672
    v_mfma_f32_16x16x32_bf16 a[20:23], v[52:55], v[128:131], a[20:23]
    s_sub_u32 s23, s23, -64
    ds_read_b64_tr_b16 v[72:73], v6 offset:24576
    v_mfma_f32_16x16x32_bf16 a[24:27], v[56:59], v[128:131], a[24:27]
    ds_read_b64_tr_b16 v[74:75], v6 offset:28672
    ds_read_b64_tr_b16 v[76:77], v7 offset:24576
    v_mfma_f32_16x16x32_bf16 a[28:31], v[60:63], v[128:131], a[28:31]
    buffer_load_dwordx4 v[128:131], v1, s[8:11], s20 offen
    ds_read_b64_tr_b16 v[78:79], v7 offset:28672
    v_mfma_f32_16x16x32_bf16 a[32:35], v[32:35], v[132:135], a[32:35]
    ds_read_b64_tr_b16 v[80:81], v8 offset:24576
    v_mfma_f32_16x16x32_bf16 a[36:39], v[36:39], v[132:135], a[36:39]
    ds_read_b64_tr_b16 v[82:83], v8 offset:28672
    v_mfma_f32_16x16x32_bf16 a[40:43], v[40:43], v[132:135], a[40:43]
    ds_read_b64_tr_b16 v[84:85], v9 offset:24576
    v_mfma_f32_16x16x32_bf16 a[44:47], v[44:47], v[132:135], a[44:47]
    ds_read_b64_tr_b16 v[86:87], v9 offset:28672
    v_mfma_f32_16x16x32_bf16 a[48:51], v[48:51], v[132:135], a[48:51]
    ds_read_b64_tr_b16 v[88:89], v10 offset:24576
    v_mfma_f32_16x16x32_bf16 a[52:55], v[52:55], v[132:135], a[52:55]
    ds_read_b64_tr_b16 v[90:91], v10 offset:28672
    v_mfma_f32_16x16x32_bf16 a[56:59], v[56:59], v[132:135], a[56:59]
    ds_read_b64_tr_b16 v[92:93], v11 offset:24576
    v_mfma_f32_16x16x32_bf16 a[60:63], v[60:63], v[132:135], a[60:63]
    buffer_load_dwordx4 v[132:135], v2, s[8:11], s20 offen
    v_mfma_f32_16x16x32_bf16 a[64:67], v[32:35], v[136:139], a[64:67]
    ds_read_b64_tr_b16 v[94:95], v11 offset:28672
    v_mfma_f32_16x16x32_bf16 a[68:71], v[36:39], v[136:139], a[68:71]
    v_mfma_f32_16x16x32_bf16 a[72:75], v[40:43], v[136:139], a[72:75]
    v_mfma_f32_16x16x32_bf16 a[76:79], v[44:47], v[136:139], a[76:79]
    v_mfma_f32_16x16x32_bf16 a[80:83], v[48:51], v[136:139], a[80:83]
    v_mfma_f32_16x16x32_bf16 a[84:87], v[52:55], v[136:139], a[84:87]
    v_mfma_f32_16x16x32_bf16 a[88:91], v[56:59], v[136:139], a[88:91]
    v_mfma_f32_16x16x32_bf16 a[92:95], v[60:63], v[136:139], a[92:95]
    buffer_load_dwordx4 v[136:139], v3, s[8:11], s20 offen
    v_mfma_f32_16x16x32_bf16 a[96:99], v[32:35], v[140:143], a[96:99]
    v_mfma_f32_16x16x32_bf16 a[100:103], v[36:39], v[140:143], a[100:103]
    v_mfma_f32_16x16x32_bf16 a[104:107], v[40:43], v[140:143], a[104:107]
    v_mfma_f32_16x16x32_bf16 a[108:111], v[44:47], v[140:143], a[108:111]
    v_mfma_f32_16x16x32_bf16 a[112:115], v[48:51], v[140:143], a[112:115]
    v_mfma_f32_16x16x32_bf16 a[116:119], v[52:55], v[140:143], a[116:119]
    v_mfma_f32_16x16x32_bf16 a[120:123], v[56:59], v[140:143], a[120:123]
    v_mfma_f32_16x16x32_bf16 a[124:127], v[60:63], v[140:143], a[124:127]
    buffer_load_dwordx4 v[140:143], v28, s[8:11], s20 offen
    s_waitcnt vmcnt(16) lgkmcnt(0)
    s_barrier
    v_mfma_f32_16x16x32_bf16 a[0:3], v[64:67], v[144:147], a[0:3]
    s_add_u32 s20, s20, 131072
    v_mfma_f32_16x16x32_bf16 a[4:7], v[68:71], v[144:147], a[4:7]
    s_add_u32 m0, s24, 24832
    v_mfma_f32_16x16x32_bf16 a[8:11], v[72:75], v[144:147], a[8:11]
    ds_read_b128 v[32:35], v14 offset:0
    ds_read_b128 v[36:39], v14 offset:1024
    v_mfma_f32_16x16x32_bf16 a[12:15], v[76:79], v[144:147], a[12:15]
    buffer_load_dwordx4 v12, s[16:19], s23 offen lds
    ds_read_b128 v[40:43], v14 offset:2048
    v_mfma_f32_16x16x32_bf16 a[16:19], v[80:83], v[144:147], a[16:19]
    buffer_load_dwordx4 v13, s[16:19], s23 offen offset:1024 lds
    ds_read_b128 v[44:47], v14 offset:3072
    v_mfma_f32_16x16x32_bf16 a[20:23], v[84:87], v[144:147], a[20:23]
    s_sub_u32 s23, s23, -64
    ds_read_b128 v[48:51], v14 offset:4096
    v_mfma_f32_16x16x32_bf16 a[24:27], v[88:91], v[144:147], a[24:27]
    ds_read_b128 v[52:55], v14 offset:5120
    ds_read_b128 v[56:59], v14 offset:6144
    v_mfma_f32_16x16x32_bf16 a[28:31], v[92:95], v[144:147], a[28:31]
    buffer_load_dwordx4 v[144:147], v1, s[8:11], s20 offen
    ds_read_b128 v[60:63], v14 offset:7168
    v_mfma_f32_16x16x32_bf16 a[32:35], v[64:67], v[148:151], a[32:35]
    v_mfma_f32_16x16x32_bf16 a[36:39], v[68:71], v[148:151], a[36:39]
    v_mfma_f32_16x16x32_bf16 a[40:43], v[72:75], v[148:151], a[40:43]
    v_mfma_f32_16x16x32_bf16 a[44:47], v[76:79], v[148:151], a[44:47]
    v_mfma_f32_16x16x32_bf16 a[48:51], v[80:83], v[148:151], a[48:51]
    v_mfma_f32_16x16x32_bf16 a[52:55], v[84:87], v[148:151], a[52:55]
    v_mfma_f32_16x16x32_bf16 a[56:59], v[88:91], v[148:151], a[56:59]
    v_mfma_f32_16x16x32_bf16 a[60:63], v[92:95], v[148:151], a[60:63]
    buffer_load_dwordx4 v[148:151], v2, s[8:11], s20 offen
    v_mfma_f32_16x16x32_bf16 a[64:67], v[64:67], v[152:155], a[64:67]
    v_mfma_f32_16x16x32_bf16 a[68:71], v[68:71], v[152:155], a[68:71]
    v_mfma_f32_16x16x32_bf16 a[72:75], v[72:75], v[152:155], a[72:75]
    v_mfma_f32_16x16x32_bf16 a[76:79], v[76:79], v[152:155], a[76:79]
    v_mfma_f32_16x16x32_bf16 a[80:83], v[80:83], v[152:155], a[80:83]
    v_mfma_f32_16x16x32_bf16 a[84:87], v[84:87], v[152:155], a[84:87]
    v_mfma_f32_16x16x32_bf16 a[88:91], v[88:91], v[152:155], a[88:91]
    v_mfma_f32_16x16x32_bf16 a[92:95], v[92:95], v[152:155], a[92:95]
    buffer_load_dwordx4 v[152:155], v3, s[8:11], s20 offen
    v_mfma_f32_16x16x32_bf16 a[96:99], v[64:67], v[156:159], a[96:99]
    v_mfma_f32_16x16x32_bf16 a[100:103], v[68:71], v[156:159], a[100:103]
    v_mfma_f32_16x16x32_bf16 a[104:107], v[72:75], v[156:159], a[104:107]
    v_mfma_f32_16x16x32_bf16 a[108:111], v[76:79], v[156:159], a[108:111]
    v_mfma_f32_16x16x32_bf16 a[112:115], v[80:83], v[156:159], a[112:115]
    v_mfma_f32_16x16x32_bf16 a[116:119], v[84:87], v[156:159], a[116:119]
    v_mfma_f32_16x16x32_bf16 a[120:123], v[88:91], v[156:159], a[120:123]
    v_mfma_f32_16x16x32_bf16 a[124:127], v[92:95], v[156:159], a[124:127]
    buffer_load_dwordx4 v[156:159], v28, s[8:11], s20 offen
    s_mov_b32 s25, 2
.p2align 6
L_k2_loopc:
    s_waitcnt vmcnt(16) lgkmcnt(0)
    s_barrier
    v_mfma_f32_16x16x32_bf16 a[0:3], v[32:35], v[96:99], a[0:3]
    s_add_u32 s20, s20, 131072
    v_mfma_f32_16x16x32_bf16 a[4:7], v[36:39], v[96:99], a[4:7]
    s_add_u32 m0, s24, 256
    v_mfma_f32_16x16x32_bf16 a[8:11], v[40:43], v[96:99], a[8:11]
    ds_read_b128 v[64:67], v14 offset:8192
    ds_read_b128 v[68:71], v14 offset:9216
    v_mfma_f32_16x16x32_bf16 a[12:15], v[44:47], v[96:99], a[12:15]
    buffer_load_dwordx4 v12, s[16:19], s23 offen lds
    ds_read_b128 v[72:75], v14 offset:10240
    v_mfma_f32_16x16x32_bf16 a[16:19], v[48:51], v[96:99], a[16:19]
    buffer_load_dwordx4 v13, s[16:19], s23 offen offset:1024 lds
    ds_read_b128 v[76:79], v14 offset:11264
    v_mfma_f32_16x16x32_bf16 a[20:23], v[52:55], v[96:99], a[20:23]
    s_sub_u32 s23, s23, -64
    ds_read_b128 v[80:83], v14 offset:12288
    v_mfma_f32_16x16x32_bf16 a[24:27], v[56:59], v[96:99], a[24:27]
    ds_read_b128 v[84:87], v14 offset:13312
    ds_read_b128 v[88:91], v14 offset:14336
    v_mfma_f32_16x16x32_bf16 a[28:31], v[60:63], v[96:99], a[28:31]
    buffer_load_dwordx4 v[96:99], v1, s[8:11], s20 offen
    ds_read_b128 v[92:95], v14 offset:15360
    v_mfma_f32_16x16x32_bf16 a[32:35], v[32:35], v[100:103], a[32:35]
    v_mfma_f32_16x16x32_bf16 a[36:39], v[36:39], v[100:103], a[36:39]
    v_mfma_f32_16x16x32_bf16 a[40:43], v[40:43], v[100:103], a[40:43]
    v_mfma_f32_16x16x32_bf16 a[44:47], v[44:47], v[100:103], a[44:47]
    v_mfma_f32_16x16x32_bf16 a[48:51], v[48:51], v[100:103], a[48:51]
    v_mfma_f32_16x16x32_bf16 a[52:55], v[52:55], v[100:103], a[52:55]
    v_mfma_f32_16x16x32_bf16 a[56:59], v[56:59], v[100:103], a[56:59]
    v_mfma_f32_16x16x32_bf16 a[60:63], v[60:63], v[100:103], a[60:63]
    buffer_load_dwordx4 v[100:103], v2, s[8:11], s20 offen
    v_mfma_f32_16x16x32_bf16 a[64:67], v[32:35], v[104:107], a[64:67]
    v_mfma_f32_16x16x32_bf16 a[68:71], v[36:39], v[104:107], a[68:71]
    v_mfma_f32_16x16x32_bf16 a[72:75], v[40:43], v[104:107], a[72:75]
    v_mfma_f32_16x16x32_bf16 a[76:79], v[44:47], v[104:107], a[76:79]
    v_mfma_f32_16x16x32_bf16 a[80:83], v[48:51], v[104:107], a[80:83]
    v_mfma_f32_16x16x32_bf16 a[84:87], v[52:55], v[104:107], a[84:87]
    v_mfma_f32_16x16x32_bf16 a[88:91], v[56:59], v[104:107], a[88:91]
    v_mfma_f32_16x16x32_bf16 a[92:95], v[60:63], v[104:107], a[92:95]
    buffer_load_dwordx4 v[104:107], v3, s[8:11], s20 offen
    v_mfma_f32_16x16x32_bf16 a[96:99], v[32:35], v[108:111], a[96:99]
    v_mfma_f32_16x16x32_bf16 a[100:103], v[36:39], v[108:111], a[100:103]
    v_mfma_f32_16x16x32_bf16 a[104:107], v[40:43], v[108:111], a[104:107]
    v_mfma_f32_16x16x32_bf16 a[108:111], v[44:47], v[108:111], a[108:111]
    v_mfma_f32_16x16x32_bf16 a[112:115], v[48:51], v[108:111], a[112:115]
    v_mfma_f32_16x16x32_bf16 a[116:119], v[52:55], v[108:111], a[116:119]
    v_mfma_f32_16x16x32_bf16 a[120:123], v[56:59], v[108:111], a[120:123]
    v_mfma_f32_16x16x32_bf16 a[124:127], v[60:63], v[108:111], a[124:127]
    buffer_load_dwordx4 v[108:111], v28, s[8:11], s20 offen
    s_waitcnt vmcnt(16) lgkmcnt(0)
    s_barrier
    v_mfma_f32_16x16x32_bf16 a[0:3], v[64:67], v[112:115], a[0:3]
    s_add_u32 s20, s20, 131072
    v_mfma_f32_16x16x32_bf16 a[4:7], v[68:71], v[112:115], a[4:7]
    s_add_u32 m0, s24, 8448
    v_mfma_f32_16x16x32_bf16 a[8:11], v[72:75], v[112:115], a[8:11]
    ds_read_b128 v[32:35], v14 offset:16384
    ds_read_b128 v[36:39], v14 offset:17408
    v_mfma_f32_16x16x32_bf16 a[12:15], v[76:79], v[112:115], a[12:15]
    buffer_load_dwordx4 v12, s[16:19], s23 offen lds
    ds_read_b128 v[40:43], v14 offset:18432
    v_mfma_f32_16x16x32_bf16 a[16:19], v[80:83], v[112:115], a[16:19]
    buffer_load_dwordx4 v13, s[16:19], s23 offen offset:1024 lds
    ds_read_b128 v[44:47], v14 offset:19456
    v_mfma_f32_16x16x32_bf16 a[20:23], v[84:87], v[112:115], a[20:23]
    s_sub_u32 s23, s23, -64
    ds_read_b128 v[48:51], v14 offset:20480
    v_mfma_f32_16x16x32_bf16 a[24:27], v[88:91], v[112:115], a[24:27]
    ds_read_b128 v[52:55], v14 offset:21504
    ds_read_b128 v[56:59], v14 offset:22528
    v_mfma_f32_16x16x32_bf16 a[28:31], v[92:95], v[112:115], a[28:31]
    buffer_load_dwordx4 v[112:115], v1, s[8:11], s20 offen
    ds_read_b128 v[60:63], v14 offset:23552
    v_mfma_f32_16x16x32_bf16 a[32:35], v[64:67], v[116:119], a[32:35]
    v_mfma_f32_16x16x32_bf16 a[36:39], v[68:71], v[116:119], a[36:39]
    v_mfma_f32_16x16x32_bf16 a[40:43], v[72:75], v[116:119], a[40:43]
    v_mfma_f32_16x16x32_bf16 a[44:47], v[76:79], v[116:119], a[44:47]
    v_mfma_f32_16x16x32_bf16 a[48:51], v[80:83], v[116:119], a[48:51]
    v_mfma_f32_16x16x32_bf16 a[52:55], v[84:87], v[116:119], a[52:55]
    v_mfma_f32_16x16x32_bf16 a[56:59], v[88:91], v[116:119], a[56:59]
    v_mfma_f32_16x16x32_bf16 a[60:63], v[92:95], v[116:119], a[60:63]
    buffer_load_dwordx4 v[116:119], v2, s[8:11], s20 offen
    v_mfma_f32_16x16x32_bf16 a[64:67], v[64:67], v[120:123], a[64:67]
    v_mfma_f32_16x16x32_bf16 a[68:71], v[68:71], v[120:123], a[68:71]
    v_mfma_f32_16x16x32_bf16 a[72:75], v[72:75], v[120:123], a[72:75]
    v_mfma_f32_16x16x32_bf16 a[76:79], v[76:79], v[120:123], a[76:79]
    v_mfma_f32_16x16x32_bf16 a[80:83], v[80:83], v[120:123], a[80:83]
    v_mfma_f32_16x16x32_bf16 a[84:87], v[84:87], v[120:123], a[84:87]
    v_mfma_f32_16x16x32_bf16 a[88:91], v[88:91], v[120:123], a[88:91]
    v_mfma_f32_16x16x32_bf16 a[92:95], v[92:95], v[120:123], a[92:95]
    buffer_load_dwordx4 v[120:123], v3, s[8:11], s20 offen
    v_mfma_f32_16x16x32_bf16 a[96:99], v[64:67], v[124:127], a[96:99]
    v_mfma_f32_16x16x32_bf16 a[100:103], v[68:71], v[124:127], a[100:103]
    v_mfma_f32_16x16x32_bf16 a[104:107], v[72:75], v[124:127], a[104:107]
    v_mfma_f32_16x16x32_bf16 a[108:111], v[76:79], v[124:127], a[108:111]
    v_mfma_f32_16x16x32_bf16 a[112:115], v[80:83], v[124:127], a[112:115]
    v_mfma_f32_16x16x32_bf16 a[116:119], v[84:87], v[124:127], a[116:119]
    v_mfma_f32_16x16x32_bf16 a[120:123], v[88:91], v[124:127], a[120:123]
    v_mfma_f32_16x16x32_bf16 a[124:127], v[92:95], v[124:127], a[124:127]
    buffer_load_dwordx4 v[124:127], v28, s[8:11], s20 offen
    s_waitcnt vmcnt(16) lgkmcnt(0)
    s_barrier
    v_mfma_f32_16x16x32_bf16 a[0:3], v[32:35], v[128:131], a[0:3]
    s_add_u32 s20, s20, 131072
    v_mfma_f32_16x16x32_bf16 a[4:7], v[36:39], v[128:131], a[4:7]
    s_add_u32 m0, s24, 16640
    v_mfma_f32_16x16x32_bf16 a[8:11], v[40:43], v[128:131], a[8:11]
    ds_read_b128 v[64:67], v14 offset:24576
    ds_read_b128 v[68:71], v14 offset:25600
    v_mfma_f32_16x16x32_bf16 a[12:15], v[44:47], v[128:131], a[12:15]
    buffer_load_dwordx4 v12, s[16:19], s23 offen lds
    ds_read_b128 v[72:75], v14 offset:26624
    v_mfma_f32_16x16x32_bf16 a[16:19], v[48:51], v[128:131], a[16:19]
    buffer_load_dwordx4 v13, s[16:19], s23 offen offset:1024 lds
    ds_read_b128 v[76:79], v14 offset:27648
    v_mfma_f32_16x16x32_bf16 a[20:23], v[52:55], v[128:131], a[20:23]
    s_sub_u32 s23, s23, -64
    ds_read_b128 v[80:83], v14 offset:28672
    v_mfma_f32_16x16x32_bf16 a[24:27], v[56:59], v[128:131], a[24:27]
    ds_read_b128 v[84:87], v14 offset:29696
    ds_read_b128 v[88:91], v14 offset:30720
    v_mfma_f32_16x16x32_bf16 a[28:31], v[60:63], v[128:131], a[28:31]
    buffer_load_dwordx4 v[128:131], v1, s[8:11], s20 offen
    ds_read_b128 v[92:95], v14 offset:31744
    v_mfma_f32_16x16x32_bf16 a[32:35], v[32:35], v[132:135], a[32:35]
    v_mfma_f32_16x16x32_bf16 a[36:39], v[36:39], v[132:135], a[36:39]
    v_mfma_f32_16x16x32_bf16 a[40:43], v[40:43], v[132:135], a[40:43]
    v_mfma_f32_16x16x32_bf16 a[44:47], v[44:47], v[132:135], a[44:47]
    v_mfma_f32_16x16x32_bf16 a[48:51], v[48:51], v[132:135], a[48:51]
    v_mfma_f32_16x16x32_bf16 a[52:55], v[52:55], v[132:135], a[52:55]
    v_mfma_f32_16x16x32_bf16 a[56:59], v[56:59], v[132:135], a[56:59]
    v_mfma_f32_16x16x32_bf16 a[60:63], v[60:63], v[132:135], a[60:63]
    buffer_load_dwordx4 v[132:135], v2, s[8:11], s20 offen
    v_mfma_f32_16x16x32_bf16 a[64:67], v[32:35], v[136:139], a[64:67]
    v_mfma_f32_16x16x32_bf16 a[68:71], v[36:39], v[136:139], a[68:71]
    v_mfma_f32_16x16x32_bf16 a[72:75], v[40:43], v[136:139], a[72:75]
    v_mfma_f32_16x16x32_bf16 a[76:79], v[44:47], v[136:139], a[76:79]
    v_mfma_f32_16x16x32_bf16 a[80:83], v[48:51], v[136:139], a[80:83]
    v_mfma_f32_16x16x32_bf16 a[84:87], v[52:55], v[136:139], a[84:87]
    v_mfma_f32_16x16x32_bf16 a[88:91], v[56:59], v[136:139], a[88:91]
    v_mfma_f32_16x16x32_bf16 a[92:95], v[60:63], v[136:139], a[92:95]
    buffer_load_dwordx4 v[136:139], v3, s[8:11], s20 offen
    v_mfma_f32_16x16x32_bf16 a[96:99], v[32:35], v[140:143], a[96:99]
    v_mfma_f32_16x16x32_bf16 a[100:103], v[36:39], v[140:143], a[100:103]
    v_mfma_f32_16x16x32_bf16 a[104:107], v[40:43], v[140:143], a[104:107]
    v_mfma_f32_16x16x32_bf16 a[108:111], v[44:47], v[140:143], a[108:111]
    v_mfma_f32_16x16x32_bf16 a[112:115], v[48:51], v[140:143], a[112:115]
    v_mfma_f32_16x16x32_bf16 a[116:119], v[52:55], v[140:143], a[116:119]
    v_mfma_f32_16x16x32_bf16 a[120:123], v[56:59], v[140:143], a[120:123]
    v_mfma_f32_16x16x32_bf16 a[124:127], v[60:63], v[140:143], a[124:127]
    buffer_load_dwordx4 v[140:143], v28, s[8:11], s20 offen
    s_waitcnt vmcnt(16) lgkmcnt(0)
    s_barrier
    v_mfma_f32_16x16x32_bf16 a[0:3], v[64:67], v[144:147], a[0:3]
    s_add_u32 s20, s20, 131072
    v_mfma_f32_16x16x32_bf16 a[4:7], v[68:71], v[144:147], a[4:7]
    s_add_u32 m0, s24, 24832
    v_mfma_f32_16x16x32_bf16 a[8:11], v[72:75], v[144:147], a[8:11]
    ds_read_b128 v[32:35], v14 offset:0
    ds_read_b128 v[36:39], v14 offset:1024
    v_mfma_f32_16x16x32_bf16 a[12:15], v[76:79], v[144:147], a[12:15]
    buffer_load_dwordx4 v12, s[16:19], s23 offen lds
    ds_read_b128 v[40:43], v14 offset:2048
    v_mfma_f32_16x16x32_bf16 a[16:19], v[80:83], v[144:147], a[16:19]
    buffer_load_dwordx4 v13, s[16:19], s23 offen offset:1024 lds
    ds_read_b128 v[44:47], v14 offset:3072
    v_mfma_f32_16x16x32_bf16 a[20:23], v[84:87], v[144:147], a[20:23]
    s_sub_u32 s23, s23, -64
    ds_read_b128 v[48:51], v14 offset:4096
    v_mfma_f32_16x16x32_bf16 a[24:27], v[88:91], v[144:147], a[24:27]
    ds_read_b128 v[52:55], v14 offset:5120
    ds_read_b128 v[56:59], v14 offset:6144
    v_mfma_f32_16x16x32_bf16 a[28:31], v[92:95], v[144:147], a[28:31]
    buffer_load_dwordx4 v[144:147], v1, s[8:11], s20 offen
    ds_read_b128 v[60:63], v14 offset:7168
    v_mfma_f32_16x16x32_bf16 a[32:35], v[64:67], v[148:151], a[32:35]
    v_mfma_f32_16x16x32_bf16 a[36:39], v[68:71], v[148:151], a[36:39]
    v_mfma_f32_16x16x32_bf16 a[40:43], v[72:75], v[148:151], a[40:43]
    v_mfma_f32_16x16x32_bf16 a[44:47], v[76:79], v[148:151], a[44:47]
    v_mfma_f32_16x16x32_bf16 a[48:51], v[80:83], v[148:151], a[48:51]
    v_mfma_f32_16x16x32_bf16 a[52:55], v[84:87], v[148:151], a[52:55]
    v_mfma_f32_16x16x32_bf16 a[56:59], v[88:91], v[148:151], a[56:59]
    v_mfma_f32_16x16x32_bf16 a[60:63], v[92:95], v[148:151], a[60:63]
    buffer_load_dwordx4 v[148:151], v2, s[8:11], s20 offen
    v_mfma_f32_16x16x32_bf16 a[64:67], v[64:67], v[152:155], a[64:67]
    v_mfma_f32_16x16x32_bf16 a[68:71], v[68:71], v[152:155], a[68:71]
    v_mfma_f32_16x16x32_bf16 a[72:75], v[72:75], v[152:155], a[72:75]
    v_mfma_f32_16x16x32_bf16 a[76:79], v[76:79], v[152:155], a[76:79]
    v_mfma_f32_16x16x32_bf16 a[80:83], v[80:83], v[152:155], a[80:83]
    v_mfma_f32_16x16x32_bf16 a[84:87], v[84:87], v[152:155], a[84:87]
    v_mfma_f32_16x16x32_bf16 a[88:91], v[88:91], v[152:155], a[88:91]
    v_mfma_f32_16x16x32_bf16 a[92:95], v[92:95], v[152:155], a[92:95]
    buffer_load_dwordx4 v[152:155], v3, s[8:11], s20 offen
    v_mfma_f32_16x16x32_bf16 a[96:99], v[64:67], v[156:159], a[96:99]
    v_mfma_f32_16x16x32_bf16 a[100:103], v[68:71], v[156:159], a[100:103]
    v_mfma_f32_16x16x32_bf16 a[104:107], v[72:75], v[156:159], a[104:107]
    v_mfma_f32_16x16x32_bf16 a[108:111], v[76:79], v[156:159], a[108:111]
    v_mfma_f32_16x16x32_bf16 a[112:115], v[80:83], v[156:159], a[112:115]
    v_mfma_f32_16x16x32_bf16 a[116:119], v[84:87], v[156:159], a[116:119]
    v_mfma_f32_16x16x32_bf16 a[120:123], v[88:91], v[156:159], a[120:123]
    v_mfma_f32_16x16x32_bf16 a[124:127], v[92:95], v[156:159], a[124:127]
    buffer_load_dwordx4 v[156:159], v28, s[8:11], s20 offen
    s_sub_u32 s25, s25, 1
    s_cbranch_scc0 L_k2_loopc
    s_waitcnt vmcnt(16) lgkmcnt(0)
    s_barrier
    v_mfma_f32_16x16x32_bf16 a[0:3], v[32:35], v[96:99], a[0:3]
    buffer_load_dword v223, v222, s[64:67], s69 offen
    v_lshlrev_b32_e64 v24, 3, v25
    v_mfma_f32_16x16x32_bf16 a[4:7], v[36:39], v[96:99], a[4:7]
    s_lshl_b32 s36, s28, 8
    v_lshlrev_b32 v27, 2, v31
    v_mfma_f32_16x16x32_bf16 a[8:11], v[40:43], v[96:99], a[8:11]
    ds_read_b128 v[64:67], v14 offset:8192
    ds_read_b128 v[68:71], v14 offset:9216
    v_mfma_f32_16x16x32_bf16 a[12:15], v[44:47], v[96:99], a[12:15]
    ds_read_b128 v[72:75], v14 offset:10240
    ds_read_b128 v[76:79], v14 offset:11264
    v_mfma_f32_16x16x32_bf16 a[16:19], v[48:51], v[96:99], a[16:19]
    ds_read_b128 v[80:83], v14 offset:12288
    ds_read_b128 v[84:87], v14 offset:13312
    v_mfma_f32_16x16x32_bf16 a[20:23], v[52:55], v[96:99], a[20:23]
    ds_read_b128 v[88:91], v14 offset:14336
    ds_read_b128 v[92:95], v14 offset:15360
    v_mfma_f32_16x16x32_bf16 a[24:27], v[56:59], v[96:99], a[24:27]
    v_add_u32_e64 v24, s36, v24
    v_lshl_add_u32 v26, v31, 11, v24
    v_mfma_f32_16x16x32_bf16 a[28:31], v[60:63], v[96:99], a[28:31]
    s_mov_b32 s37, 42205184
    buffer_load_dword v240, v27, s[8:11], s37 offen sc1
    v_mfma_f32_16x16x32_bf16 a[32:35], v[32:35], v[100:103], a[32:35]
    global_load_dwordx2 v[224:225], v26, s[50:51] offset:0
    global_load_dwordx2 v[226:227], v26, s[50:51] offset:32
    v_mfma_f32_16x16x32_bf16 a[36:39], v[36:39], v[100:103], a[36:39]
    global_load_dwordx2 v[228:229], v26, s[50:51] offset:64
    global_load_dwordx2 v[230:231], v26, s[50:51] offset:96
    v_mfma_f32_16x16x32_bf16 a[40:43], v[40:43], v[100:103], a[40:43]
    global_load_dwordx2 v[232:233], v26, s[50:51] offset:128
    global_load_dwordx2 v[234:235], v26, s[50:51] offset:160
    v_mfma_f32_16x16x32_bf16 a[44:47], v[44:47], v[100:103], a[44:47]
    global_load_dwordx2 v[236:237], v26, s[50:51] offset:192
    global_load_dwordx2 v[238:239], v26, s[50:51] offset:224
    v_mfma_f32_16x16x32_bf16 a[48:51], v[48:51], v[100:103], a[48:51]
    v_mfma_f32_16x16x32_bf16 a[52:55], v[52:55], v[100:103], a[52:55]
    v_mfma_f32_16x16x32_bf16 a[56:59], v[56:59], v[100:103], a[56:59]
    v_mfma_f32_16x16x32_bf16 a[60:63], v[60:63], v[100:103], a[60:63]
    v_mfma_f32_16x16x32_bf16 a[64:67], v[32:35], v[104:107], a[64:67]
    v_mfma_f32_16x16x32_bf16 a[68:71], v[36:39], v[104:107], a[68:71]
    v_mfma_f32_16x16x32_bf16 a[72:75], v[40:43], v[104:107], a[72:75]
    v_mfma_f32_16x16x32_bf16 a[76:79], v[44:47], v[104:107], a[76:79]
    v_mfma_f32_16x16x32_bf16 a[80:83], v[48:51], v[104:107], a[80:83]
    v_mfma_f32_16x16x32_bf16 a[84:87], v[52:55], v[104:107], a[84:87]
    v_mfma_f32_16x16x32_bf16 a[88:91], v[56:59], v[104:107], a[88:91]
    v_mfma_f32_16x16x32_bf16 a[92:95], v[60:63], v[104:107], a[92:95]
    v_mfma_f32_16x16x32_bf16 a[96:99], v[32:35], v[108:111], a[96:99]
    v_mfma_f32_16x16x32_bf16 a[100:103], v[36:39], v[108:111], a[100:103]
    v_mfma_f32_16x16x32_bf16 a[104:107], v[40:43], v[108:111], a[104:107]
    v_mfma_f32_16x16x32_bf16 a[108:111], v[44:47], v[108:111], a[108:111]
    v_mfma_f32_16x16x32_bf16 a[112:115], v[48:51], v[108:111], a[112:115]
    v_mfma_f32_16x16x32_bf16 a[116:119], v[52:55], v[108:111], a[116:119]
    v_mfma_f32_16x16x32_bf16 a[120:123], v[56:59], v[108:111], a[120:123]
    v_mfma_f32_16x16x32_bf16 a[124:127], v[60:63], v[108:111], a[124:127]
    s_waitcnt vmcnt(20) lgkmcnt(0)
    s_barrier
    v_mfma_f32_16x16x32_bf16 a[0:3], v[64:67], v[112:115], a[0:3]
    global_load_dwordx2 v[96:97], v24, s[52:53] offset:0
    global_load_dwordx2 v[98:99], v24, s[52:53] offset:32
    v_mfma_f32_16x16x32_bf16 a[4:7], v[68:71], v[112:115], a[4:7]
    global_load_dwordx2 v[100:101], v24, s[52:53] offset:64
    global_load_dwordx2 v[102:103], v24, s[52:53] offset:96
    v_mfma_f32_16x16x32_bf16 a[8:11], v[72:75], v[112:115], a[8:11]
    ds_read_b128 v[32:35], v14 offset:16384
    ds_read_b128 v[36:39], v14 offset:17408
    v_mfma_f32_16x16x32_bf16 a[12:15], v[76:79], v[112:115], a[12:15]
    ds_read_b128 v[40:43], v14 offset:18432
    ds_read_b128 v[44:47], v14 offset:19456
    v_mfma_f32_16x16x32_bf16 a[16:19], v[80:83], v[112:115], a[16:19]
    ds_read_b128 v[48:51], v14 offset:20480
    ds_read_b128 v[52:55], v14 offset:21504
    v_mfma_f32_16x16x32_bf16 a[20:23], v[84:87], v[112:115], a[20:23]
    ds_read_b128 v[56:59], v14 offset:22528
    ds_read_b128 v[60:63], v14 offset:23552
    v_mfma_f32_16x16x32_bf16 a[24:27], v[88:91], v[112:115], a[24:27]
    global_load_dwordx2 v[104:105], v24, s[52:53] offset:128
    global_load_dwordx2 v[106:107], v24, s[52:53] offset:160
    v_mfma_f32_16x16x32_bf16 a[28:31], v[92:95], v[112:115], a[28:31]
    global_load_dwordx2 v[108:109], v24, s[52:53] offset:192
    global_load_dwordx2 v[110:111], v24, s[52:53] offset:224
    v_mfma_f32_16x16x32_bf16 a[32:35], v[64:67], v[116:119], a[32:35]
    v_mfma_f32_16x16x32_bf16 a[36:39], v[68:71], v[116:119], a[36:39]
    v_mfma_f32_16x16x32_bf16 a[40:43], v[72:75], v[116:119], a[40:43]
    v_mfma_f32_16x16x32_bf16 a[44:47], v[76:79], v[116:119], a[44:47]
    v_mfma_f32_16x16x32_bf16 a[48:51], v[80:83], v[116:119], a[48:51]
    v_mfma_f32_16x16x32_bf16 a[52:55], v[84:87], v[116:119], a[52:55]
    v_mfma_f32_16x16x32_bf16 a[56:59], v[88:91], v[116:119], a[56:59]
    v_mfma_f32_16x16x32_bf16 a[60:63], v[92:95], v[116:119], a[60:63]
    v_mfma_f32_16x16x32_bf16 a[64:67], v[64:67], v[120:123], a[64:67]
    v_mfma_f32_16x16x32_bf16 a[68:71], v[68:71], v[120:123], a[68:71]
    v_mfma_f32_16x16x32_bf16 a[72:75], v[72:75], v[120:123], a[72:75]
    v_mfma_f32_16x16x32_bf16 a[76:79], v[76:79], v[120:123], a[76:79]
    v_mfma_f32_16x16x32_bf16 a[80:83], v[80:83], v[120:123], a[80:83]
    v_mfma_f32_16x16x32_bf16 a[84:87], v[84:87], v[120:123], a[84:87]
    v_mfma_f32_16x16x32_bf16 a[88:91], v[88:91], v[120:123], a[88:91]
    v_mfma_f32_16x16x32_bf16 a[92:95], v[92:95], v[120:123], a[92:95]
    v_mfma_f32_16x16x32_bf16 a[96:99], v[64:67], v[124:127], a[96:99]
    v_mfma_f32_16x16x32_bf16 a[100:103], v[68:71], v[124:127], a[100:103]
    v_mfma_f32_16x16x32_bf16 a[104:107], v[72:75], v[124:127], a[104:107]
    v_mfma_f32_16x16x32_bf16 a[108:111], v[76:79], v[124:127], a[108:111]
    v_mfma_f32_16x16x32_bf16 a[112:115], v[80:83], v[124:127], a[112:115]
    v_mfma_f32_16x16x32_bf16 a[116:119], v[84:87], v[124:127], a[116:119]
    v_mfma_f32_16x16x32_bf16 a[120:123], v[88:91], v[124:127], a[120:123]
    v_mfma_f32_16x16x32_bf16 a[124:127], v[92:95], v[124:127], a[124:127]
    s_waitcnt vmcnt(22) lgkmcnt(0)
    s_barrier
    v_mfma_f32_16x16x32_bf16 a[0:3], v[32:35], v[128:131], a[0:3]
    v_mfma_f32_16x16x32_bf16 a[4:7], v[36:39], v[128:131], a[4:7]
    v_mfma_f32_16x16x32_bf16 a[8:11], v[40:43], v[128:131], a[8:11]
    ds_read_b128 v[64:67], v14 offset:24576
    ds_read_b128 v[68:71], v14 offset:25600
    v_mfma_f32_16x16x32_bf16 a[12:15], v[44:47], v[128:131], a[12:15]
    ds_read_b128 v[72:75], v14 offset:26624
    ds_read_b128 v[76:79], v14 offset:27648
    v_mfma_f32_16x16x32_bf16 a[16:19], v[48:51], v[128:131], a[16:19]
    ds_read_b128 v[80:83], v14 offset:28672
    ds_read_b128 v[84:87], v14 offset:29696
    v_mfma_f32_16x16x32_bf16 a[20:23], v[52:55], v[128:131], a[20:23]
    ds_read_b128 v[88:91], v14 offset:30720
    ds_read_b128 v[92:95], v14 offset:31744
    v_mfma_f32_16x16x32_bf16 a[24:27], v[56:59], v[128:131], a[24:27]
    v_mfma_f32_16x16x32_bf16 a[28:31], v[60:63], v[128:131], a[28:31]
    v_mfma_f32_16x16x32_bf16 a[32:35], v[32:35], v[132:135], a[32:35]
    v_mfma_f32_16x16x32_bf16 a[36:39], v[36:39], v[132:135], a[36:39]
    v_mfma_f32_16x16x32_bf16 a[40:43], v[40:43], v[132:135], a[40:43]
    v_mfma_f32_16x16x32_bf16 a[44:47], v[44:47], v[132:135], a[44:47]
    v_mfma_f32_16x16x32_bf16 a[48:51], v[48:51], v[132:135], a[48:51]
    v_mfma_f32_16x16x32_bf16 a[52:55], v[52:55], v[132:135], a[52:55]
    v_mfma_f32_16x16x32_bf16 a[56:59], v[56:59], v[132:135], a[56:59]
    v_mfma_f32_16x16x32_bf16 a[60:63], v[60:63], v[132:135], a[60:63]
    v_mfma_f32_16x16x32_bf16 a[64:67], v[32:35], v[136:139], a[64:67]
    v_mfma_f32_16x16x32_bf16 a[68:71], v[36:39], v[136:139], a[68:71]
    v_mfma_f32_16x16x32_bf16 a[72:75], v[40:43], v[136:139], a[72:75]
    v_mfma_f32_16x16x32_bf16 a[76:79], v[44:47], v[136:139], a[76:79]
    v_mfma_f32_16x16x32_bf16 a[80:83], v[48:51], v[136:139], a[80:83]
    v_mfma_f32_16x16x32_bf16 a[84:87], v[52:55], v[136:139], a[84:87]
    v_mfma_f32_16x16x32_bf16 a[88:91], v[56:59], v[136:139], a[88:91]
    v_mfma_f32_16x16x32_bf16 a[92:95], v[60:63], v[136:139], a[92:95]
    v_mfma_f32_16x16x32_bf16 a[96:99], v[32:35], v[140:143], a[96:99]
    v_mfma_f32_16x16x32_bf16 a[100:103], v[36:39], v[140:143], a[100:103]
    v_mfma_f32_16x16x32_bf16 a[104:107], v[40:43], v[140:143], a[104:107]
    v_mfma_f32_16x16x32_bf16 a[108:111], v[44:47], v[140:143], a[108:111]
    v_mfma_f32_16x16x32_bf16 a[112:115], v[48:51], v[140:143], a[112:115]
    v_mfma_f32_16x16x32_bf16 a[116:119], v[52:55], v[140:143], a[116:119]
    v_mfma_f32_16x16x32_bf16 a[120:123], v[56:59], v[140:143], a[120:123]
    v_mfma_f32_16x16x32_bf16 a[124:127], v[60:63], v[140:143], a[124:127]
    s_waitcnt vmcnt(18) lgkmcnt(0)
    s_nop 0
    v_mfma_f32_16x16x32_bf16 a[32:35], v[64:67], v[148:151], a[32:35]
    v_mfma_f32_16x16x32_bf16 a[36:39], v[68:71], v[148:151], a[36:39]
    v_mfma_f32_16x16x32_bf16 a[40:43], v[72:75], v[148:151], a[40:43]
    v_mfma_f32_16x16x32_bf16 a[44:47], v[76:79], v[148:151], a[44:47]
    v_mfma_f32_16x16x32_bf16 a[48:51], v[80:83], v[148:151], a[48:51]
    v_mfma_f32_16x16x32_bf16 a[52:55], v[84:87], v[148:151], a[52:55]
    v_mfma_f32_16x16x32_bf16 a[56:59], v[88:91], v[148:151], a[56:59]
    v_mfma_f32_16x16x32_bf16 a[60:63], v[92:95], v[148:151], a[60:63]
    v_mfma_f32_16x16x32_bf16 a[64:67], v[64:67], v[152:155], a[64:67]
    v_mfma_f32_16x16x32_bf16 a[68:71], v[68:71], v[152:155], a[68:71]
    v_mfma_f32_16x16x32_bf16 a[72:75], v[72:75], v[152:155], a[72:75]
    v_mfma_f32_16x16x32_bf16 a[76:79], v[76:79], v[152:155], a[76:79]
    v_mfma_f32_16x16x32_bf16 a[80:83], v[80:83], v[152:155], a[80:83]
    v_mfma_f32_16x16x32_bf16 a[84:87], v[84:87], v[152:155], a[84:87]
    v_mfma_f32_16x16x32_bf16 a[88:91], v[88:91], v[152:155], a[88:91]
    v_mfma_f32_16x16x32_bf16 a[92:95], v[92:95], v[152:155], a[92:95]
    v_mfma_f32_16x16x32_bf16 a[96:99], v[64:67], v[156:159], a[96:99]
    v_mfma_f32_16x16x32_bf16 a[100:103], v[68:71], v[156:159], a[100:103]
    v_mfma_f32_16x16x32_bf16 a[104:107], v[72:75], v[156:159], a[104:107]
    v_mfma_f32_16x16x32_bf16 a[108:111], v[76:79], v[156:159], a[108:111]
    v_mfma_f32_16x16x32_bf16 a[112:115], v[80:83], v[156:159], a[112:115]
    v_mfma_f32_16x16x32_bf16 a[116:119], v[84:87], v[156:159], a[116:119]
    v_mfma_f32_16x16x32_bf16 a[120:123], v[88:91], v[156:159], a[120:123]
    v_mfma_f32_16x16x32_bf16 a[124:127], v[92:95], v[156:159], a[124:127]
    v_mfma_f32_16x16x32_bf16 a[0:3], v[64:67], v[144:147], a[0:3]
    v_mfma_f32_16x16x32_bf16 a[4:7], v[68:71], v[144:147], a[4:7]
    v_mfma_f32_16x16x32_bf16 a[8:11], v[72:75], v[144:147], a[8:11]
    v_mfma_f32_16x16x32_bf16 a[12:15], v[76:79], v[144:147], a[12:15]
    v_mfma_f32_16x16x32_bf16 a[16:19], v[80:83], v[144:147], a[16:19]
    v_mfma_f32_16x16x32_bf16 a[20:23], v[84:87], v[144:147], a[20:23]
    v_mfma_f32_16x16x32_bf16 a[24:27], v[88:91], v[144:147], a[24:27]
    v_mfma_f32_16x16x32_bf16 a[28:31], v[92:95], v[144:147], a[28:31]
    s_lshl_b32 s34, s27, 3
    s_add_u32 s34, s34, s28
    s_mul_i32 s35, s34, 196608
    s_lshl_b32 s36, s26, 12
    s_add_u32 s35, s35, s36
    s_add_u32 s35, s35, 83886080
    v_lshlrev_b32 v20, 4, v23
    s_nop 3
    s_add_u32 s36, s29, 1
    s_and_b32 s36, s36, 3
    s_mul_i32 s36, s36, 49152
    s_add_u32 s36, s36, s35
    s_add_u32 s36, s36, 0
    v_accvgpr_read_b32 v112, a32
    v_accvgpr_read_b32 v113, a33
    v_accvgpr_read_b32 v114, a34
    v_accvgpr_read_b32 v115, a35
    v_accvgpr_read_b32 v116, a36
    v_accvgpr_read_b32 v117, a37
    v_accvgpr_read_b32 v118, a38
    v_accvgpr_read_b32 v119, a39
    v_cvt_pk_bf16_f32 v120, v112, v113
    v_cvt_pk_bf16_f32 v121, v114, v115
    v_cvt_pk_bf16_f32 v122, v116, v117
    v_cvt_pk_bf16_f32 v123, v118, v119
    buffer_store_dwordx4 v[120:123], v20, s[8:11], s36 offen offset:0 sc1
    v_accvgpr_read_b32 v124, a40
    v_accvgpr_read_b32 v125, a41
    v_accvgpr_read_b32 v126, a42
    v_accvgpr_read_b32 v127, a43
    v_accvgpr_read_b32 v128, a44
    v_accvgpr_read_b32 v129, a45
    v_accvgpr_read_b32 v130, a46
    v_accvgpr_read_b32 v131, a47
    v_cvt_pk_bf16_f32 v132, v124, v125
    v_cvt_pk_bf16_f32 v133, v126, v127
    v_cvt_pk_bf16_f32 v134, v128, v129
    v_cvt_pk_bf16_f32 v135, v130, v131
    buffer_store_dwordx4 v[132:135], v20, s[8:11], s36 offen offset:1024 sc1
    v_accvgpr_read_b32 v136, a48
    v_accvgpr_read_b32 v137, a49
    v_accvgpr_read_b32 v138, a50
    v_accvgpr_read_b32 v139, a51
    v_accvgpr_read_b32 v140, a52
    v_accvgpr_read_b32 v141, a53
    v_accvgpr_read_b32 v142, a54
    v_accvgpr_read_b32 v143, a55
    v_cvt_pk_bf16_f32 v144, v136, v137
    v_cvt_pk_bf16_f32 v145, v138, v139
    v_cvt_pk_bf16_f32 v146, v140, v141
    v_cvt_pk_bf16_f32 v147, v142, v143
    buffer_store_dwordx4 v[144:147], v20, s[8:11], s36 offen offset:2048 sc1
    v_accvgpr_read_b32 v148, a56
    v_accvgpr_read_b32 v149, a57
    v_accvgpr_read_b32 v150, a58
    v_accvgpr_read_b32 v151, a59
    v_accvgpr_read_b32 v152, a60
    v_accvgpr_read_b32 v153, a61
    v_accvgpr_read_b32 v154, a62
    v_accvgpr_read_b32 v155, a63
    v_cvt_pk_bf16_f32 v156, v148, v149
    v_cvt_pk_bf16_f32 v157, v150, v151
    v_cvt_pk_bf16_f32 v158, v152, v153
    v_cvt_pk_bf16_f32 v159, v154, v155
    buffer_store_dwordx4 v[156:159], v20, s[8:11], s36 offen offset:3072 sc1
    s_add_u32 s36, s29, 2
    s_and_b32 s36, s36, 3
    s_mul_i32 s36, s36, 49152
    s_add_u32 s36, s36, s35
    s_nop 0
    s_add_u32 s36, s36, 16384
    v_accvgpr_read_b32 v112, a64
    v_accvgpr_read_b32 v113, a65
    v_accvgpr_read_b32 v114, a66
    v_accvgpr_read_b32 v115, a67
    v_accvgpr_read_b32 v116, a68
    v_accvgpr_read_b32 v117, a69
    v_accvgpr_read_b32 v118, a70
    v_accvgpr_read_b32 v119, a71
    v_cvt_pk_bf16_f32 v120, v112, v113
    v_cvt_pk_bf16_f32 v121, v114, v115
    v_cvt_pk_bf16_f32 v122, v116, v117
    v_cvt_pk_bf16_f32 v123, v118, v119
    buffer_store_dwordx4 v[120:123], v20, s[8:11], s36 offen offset:0 sc1
    v_accvgpr_read_b32 v124, a72
    v_accvgpr_read_b32 v125, a73
    v_accvgpr_read_b32 v126, a74
    v_accvgpr_read_b32 v127, a75
    v_accvgpr_read_b32 v128, a76
    v_accvgpr_read_b32 v129, a77
    v_accvgpr_read_b32 v130, a78
    v_accvgpr_read_b32 v131, a79
    v_cvt_pk_bf16_f32 v132, v124, v125
    v_cvt_pk_bf16_f32 v133, v126, v127
    v_cvt_pk_bf16_f32 v134, v128, v129
    v_cvt_pk_bf16_f32 v135, v130, v131
    buffer_store_dwordx4 v[132:135], v20, s[8:11], s36 offen offset:1024 sc1
    v_accvgpr_read_b32 v136, a80
    v_accvgpr_read_b32 v137, a81
    v_accvgpr_read_b32 v138, a82
    v_accvgpr_read_b32 v139, a83
    v_accvgpr_read_b32 v140, a84
    v_accvgpr_read_b32 v141, a85
    v_accvgpr_read_b32 v142, a86
    v_accvgpr_read_b32 v143, a87
    v_cvt_pk_bf16_f32 v144, v136, v137
    v_cvt_pk_bf16_f32 v145, v138, v139
    v_cvt_pk_bf16_f32 v146, v140, v141
    v_cvt_pk_bf16_f32 v147, v142, v143
    buffer_store_dwordx4 v[144:147], v20, s[8:11], s36 offen offset:2048 sc1
    v_accvgpr_read_b32 v148, a88
    v_accvgpr_read_b32 v149, a89
    v_accvgpr_read_b32 v150, a90
    v_accvgpr_read_b32 v151, a91
    v_accvgpr_read_b32 v152, a92
    v_accvgpr_read_b32 v153, a93
    v_accvgpr_read_b32 v154, a94
    v_accvgpr_read_b32 v155, a95
    v_cvt_pk_bf16_f32 v156, v148, v149
    v_cvt_pk_bf16_f32 v157, v150, v151
    v_cvt_pk_bf16_f32 v158, v152, v153
    v_cvt_pk_bf16_f32 v159, v154, v155
    buffer_store_dwordx4 v[156:159], v20, s[8:11], s36 offen offset:3072 sc1
    s_add_u32 s36, s29, 3
    s_and_b32 s36, s36, 3
    s_mul_i32 s36, s36, 49152
    s_add_u32 s36, s36, s35
    s_nop 0
    s_add_u32 s36, s36, 32768
    v_accvgpr_read_b32 v112, a96
    v_accvgpr_read_b32 v113, a97
    v_accvgpr_read_b32 v114, a98
    v_accvgpr_read_b32 v115, a99
    v_accvgpr_read_b32 v116, a100
    v_accvgpr_read_b32 v117, a101
    v_accvgpr_read_b32 v118, a102
    v_accvgpr_read_b32 v119, a103
    v_cvt_pk_bf16_f32 v120, v112, v113
    v_cvt_pk_bf16_f32 v121, v114, v115
    v_cvt_pk_bf16_f32 v122, v116, v117
    v_cvt_pk_bf16_f32 v123, v118, v119
    buffer_store_dwordx4 v[120:123], v20, s[8:11], s36 offen offset:0 sc1
    v_accvgpr_read_b32 v124, a104
    v_accvgpr_read_b32 v125, a105
    v_accvgpr_read_b32 v126, a106
    v_accvgpr_read_b32 v127, a107
    v_accvgpr_read_b32 v128, a108
    v_accvgpr_read_b32 v129, a109
    v_accvgpr_read_b32 v130, a110
    v_accvgpr_read_b32 v131, a111
    v_cvt_pk_bf16_f32 v132, v124, v125
    v_cvt_pk_bf16_f32 v133, v126, v127
    v_cvt_pk_bf16_f32 v134, v128, v129
    v_cvt_pk_bf16_f32 v135, v130, v131
    buffer_store_dwordx4 v[132:135], v20, s[8:11], s36 offen offset:1024 sc1
    v_accvgpr_read_b32 v136, a112
    v_accvgpr_read_b32 v137, a113
    v_accvgpr_read_b32 v138, a114
    v_accvgpr_read_b32 v139, a115
    v_accvgpr_read_b32 v140, a116
    v_accvgpr_read_b32 v141, a117
    v_accvgpr_read_b32 v142, a118
    v_accvgpr_read_b32 v143, a119
    v_cvt_pk_bf16_f32 v144, v136, v137
    v_cvt_pk_bf16_f32 v145, v138, v139
    v_cvt_pk_bf16_f32 v146, v140, v141
    v_cvt_pk_bf16_f32 v147, v142, v143
    buffer_store_dwordx4 v[144:147], v20, s[8:11], s36 offen offset:2048 sc1
    v_accvgpr_read_b32 v148, a120
    v_accvgpr_read_b32 v149, a121
    v_accvgpr_read_b32 v150, a122
    v_accvgpr_read_b32 v151, a123
    v_accvgpr_read_b32 v152, a124
    v_accvgpr_read_b32 v153, a125
    v_accvgpr_read_b32 v154, a126
    v_accvgpr_read_b32 v155, a127
    v_cvt_pk_bf16_f32 v156, v148, v149
    v_cvt_pk_bf16_f32 v157, v150, v151
    v_cvt_pk_bf16_f32 v158, v152, v153
    v_cvt_pk_bf16_f32 v159, v154, v155
    buffer_store_dwordx4 v[156:159], v20, s[8:11], s36 offen offset:3072 sc1
    s_waitcnt vmcnt(12)
    s_nop 0
    v_and_b32 v92, 0xffff0000, v240
    v_rcp_f32 v90, v92
    v_lshlrev_b32 v88, 16, v240
    v_mov_b32_e64 v89, v88
    v_fma_f32 v93, -v92, v90, 1.0
    v_fma_f32 v90, v93, v90, v90
    v_mov_b32 v91, v90
    v_lshlrev_b32 v92, 16, v224
    v_and_b32 v93, 0xffff0000, v224
    v_lshlrev_b32_e64 v94, 16, v225
    v_and_b32 v95, 0xffff0000, v225
    v_pk_add_f32 v[80:81], v[92:93], v[88:89] neg_lo:[0,1] neg_hi:[0,1]
    v_pk_add_f32 v[82:83], v[94:95], v[88:89] neg_lo:[0,1] neg_hi:[0,1]
    v_cvt_pk_bf16_f32 v84, v80, v81
    v_cvt_pk_bf16_f32 v85, v82, v83
    v_lshlrev_b32_e64 v80, 16, v84
    v_and_b32 v81, 0xffff0000, v84
    v_lshlrev_b32_e64 v82, 16, v85
    v_and_b32 v83, 0xffff0000, v85
    v_pk_mul_f32 v[80:81], v[80:81], v[90:91]
    v_pk_mul_f32 v[82:83], v[82:83], v[90:91]
    v_cvt_pk_bf16_f32 v84, v80, v81
    v_cvt_pk_bf16_f32 v85, v82, v83
    v_lshlrev_b32_e64 v80, 16, v84
    v_and_b32 v81, 0xffff0000, v84
    v_lshlrev_b32_e64 v82, 16, v85
    v_and_b32 v83, 0xffff0000, v85
    v_lshlrev_b32_e64 v84, 16, v96
    v_and_b32 v85, 0xffff0000, v96
    v_lshlrev_b32_e64 v86, 16, v97
    v_and_b32 v87, 0xffff0000, v97
    v_pk_mul_f32 v[80:81], v[80:81], v[84:85]
    v_pk_mul_f32 v[82:83], v[82:83], v[86:87]
    v_cvt_pk_bf16_f32 v84, v80, v81
    v_cvt_pk_bf16_f32 v85, v82, v83
    v_lshlrev_b32_e64 v80, 16, v84
    v_and_b32 v81, 0xffff0000, v84
    v_lshlrev_b32_e64 v82, 16, v85
    v_and_b32 v83, 0xffff0000, v85
    v_pk_add_f32 v[80:81], v[80:81], v[92:93]
    v_pk_add_f32 v[82:83], v[82:83], v[94:95]
    v_accvgpr_read_b32 v48, a0
    v_accvgpr_read_b32 v49, a1
    v_accvgpr_read_b32 v50, a2
    v_accvgpr_read_b32 v51, a3
    v_pk_add_f32 v[48:49], v[48:49], v[80:81]
    v_pk_add_f32 v[50:51], v[50:51], v[82:83]
    v_lshlrev_b32_e64 v92, 16, v226
    v_and_b32 v93, 0xffff0000, v226
    v_lshlrev_b32_e64 v94, 16, v227
    v_and_b32 v95, 0xffff0000, v227
    v_pk_add_f32 v[80:81], v[92:93], v[88:89] neg_lo:[0,1] neg_hi:[0,1]
    v_pk_add_f32 v[82:83], v[94:95], v[88:89] neg_lo:[0,1] neg_hi:[0,1]
    v_cvt_pk_bf16_f32 v84, v80, v81
    v_cvt_pk_bf16_f32 v85, v82, v83
    v_lshlrev_b32_e64 v80, 16, v84
    v_and_b32 v81, 0xffff0000, v84
    v_lshlrev_b32_e64 v82, 16, v85
    v_and_b32 v83, 0xffff0000, v85
    v_pk_mul_f32 v[80:81], v[80:81], v[90:91]
    v_pk_mul_f32 v[82:83], v[82:83], v[90:91]
    v_cvt_pk_bf16_f32 v84, v80, v81
    v_cvt_pk_bf16_f32 v85, v82, v83
    v_lshlrev_b32_e64 v80, 16, v84
    v_and_b32 v81, 0xffff0000, v84
    v_lshlrev_b32_e64 v82, 16, v85
    v_and_b32 v83, 0xffff0000, v85
    v_lshlrev_b32_e64 v84, 16, v98
    v_and_b32 v85, 0xffff0000, v98
    v_lshlrev_b32_e64 v86, 16, v99
    v_and_b32 v87, 0xffff0000, v99
    v_pk_mul_f32 v[80:81], v[80:81], v[84:85]
    v_pk_mul_f32 v[82:83], v[82:83], v[86:87]
    v_cvt_pk_bf16_f32 v84, v80, v81
    v_cvt_pk_bf16_f32 v85, v82, v83
    v_lshlrev_b32_e64 v80, 16, v84
    v_and_b32 v81, 0xffff0000, v84
    v_lshlrev_b32_e64 v82, 16, v85
    v_and_b32 v83, 0xffff0000, v85
    v_pk_add_f32 v[80:81], v[80:81], v[92:93]
    v_pk_add_f32 v[82:83], v[82:83], v[94:95]
    v_accvgpr_read_b32 v52, a4
    v_accvgpr_read_b32 v53, a5
    v_accvgpr_read_b32 v54, a6
    v_accvgpr_read_b32 v55, a7
    v_pk_add_f32 v[52:53], v[52:53], v[80:81]
    v_pk_add_f32 v[54:55], v[54:55], v[82:83]
    v_lshlrev_b32_e64 v92, 16, v228
    v_and_b32 v93, 0xffff0000, v228
    v_lshlrev_b32_e64 v94, 16, v229
    v_and_b32 v95, 0xffff0000, v229
    v_pk_add_f32 v[80:81], v[92:93], v[88:89] neg_lo:[0,1] neg_hi:[0,1]
    v_pk_add_f32 v[82:83], v[94:95], v[88:89] neg_lo:[0,1] neg_hi:[0,1]
    v_cvt_pk_bf16_f32 v84, v80, v81
    v_cvt_pk_bf16_f32 v85, v82, v83
    v_lshlrev_b32_e64 v80, 16, v84
    v_and_b32 v81, 0xffff0000, v84
    v_lshlrev_b32_e64 v82, 16, v85
    v_and_b32 v83, 0xffff0000, v85
    v_pk_mul_f32 v[80:81], v[80:81], v[90:91]
    v_pk_mul_f32 v[82:83], v[82:83], v[90:91]
    v_cvt_pk_bf16_f32 v84, v80, v81
    v_cvt_pk_bf16_f32 v85, v82, v83
    v_lshlrev_b32_e64 v80, 16, v84
    v_and_b32 v81, 0xffff0000, v84
    v_lshlrev_b32_e64 v82, 16, v85
    v_and_b32 v83, 0xffff0000, v85
    v_lshlrev_b32_e64 v84, 16, v100
    v_and_b32 v85, 0xffff0000, v100
    v_lshlrev_b32_e64 v86, 16, v101
    v_and_b32 v87, 0xffff0000, v101
    v_pk_mul_f32 v[80:81], v[80:81], v[84:85]
    v_pk_mul_f32 v[82:83], v[82:83], v[86:87]
    v_cvt_pk_bf16_f32 v84, v80, v81
    v_cvt_pk_bf16_f32 v85, v82, v83
    v_lshlrev_b32_e64 v80, 16, v84
    v_and_b32 v81, 0xffff0000, v84
    v_lshlrev_b32_e64 v82, 16, v85
    v_and_b32 v83, 0xffff0000, v85
    v_pk_add_f32 v[80:81], v[80:81], v[92:93]
    v_pk_add_f32 v[82:83], v[82:83], v[94:95]
    v_accvgpr_read_b32 v56, a8
    v_accvgpr_read_b32 v57, a9
    v_accvgpr_read_b32 v58, a10
    v_accvgpr_read_b32 v59, a11
    v_pk_add_f32 v[56:57], v[56:57], v[80:81]
    v_pk_add_f32 v[58:59], v[58:59], v[82:83]
    v_lshlrev_b32_e64 v92, 16, v230
    v_and_b32 v93, 0xffff0000, v230
    v_lshlrev_b32_e64 v94, 16, v231
    v_and_b32 v95, 0xffff0000, v231
    v_pk_add_f32 v[80:81], v[92:93], v[88:89] neg_lo:[0,1] neg_hi:[0,1]
    v_pk_add_f32 v[82:83], v[94:95], v[88:89] neg_lo:[0,1] neg_hi:[0,1]
    v_cvt_pk_bf16_f32 v84, v80, v81
    v_cvt_pk_bf16_f32 v85, v82, v83
    v_lshlrev_b32_e64 v80, 16, v84
    v_and_b32 v81, 0xffff0000, v84
    v_lshlrev_b32_e64 v82, 16, v85
    v_and_b32 v83, 0xffff0000, v85
    v_pk_mul_f32 v[80:81], v[80:81], v[90:91]
    v_pk_mul_f32 v[82:83], v[82:83], v[90:91]
    v_cvt_pk_bf16_f32 v84, v80, v81
    v_cvt_pk_bf16_f32 v85, v82, v83
    v_lshlrev_b32_e64 v80, 16, v84
    v_and_b32 v81, 0xffff0000, v84
    v_lshlrev_b32_e64 v82, 16, v85
    v_and_b32 v83, 0xffff0000, v85
    v_lshlrev_b32_e64 v84, 16, v102
    v_and_b32 v85, 0xffff0000, v102
    v_lshlrev_b32_e64 v86, 16, v103
    v_and_b32 v87, 0xffff0000, v103
    v_pk_mul_f32 v[80:81], v[80:81], v[84:85]
    v_pk_mul_f32 v[82:83], v[82:83], v[86:87]
    v_cvt_pk_bf16_f32 v84, v80, v81
    v_cvt_pk_bf16_f32 v85, v82, v83
    v_lshlrev_b32_e64 v80, 16, v84
    v_and_b32 v81, 0xffff0000, v84
    v_lshlrev_b32_e64 v82, 16, v85
    v_and_b32 v83, 0xffff0000, v85
    v_pk_add_f32 v[80:81], v[80:81], v[92:93]
    v_pk_add_f32 v[82:83], v[82:83], v[94:95]
    v_accvgpr_read_b32 v60, a12
    v_accvgpr_read_b32 v61, a13
    v_accvgpr_read_b32 v62, a14
    v_accvgpr_read_b32 v63, a15
    v_pk_add_f32 v[60:61], v[60:61], v[80:81]
    v_pk_add_f32 v[62:63], v[62:63], v[82:83]
    v_lshlrev_b32_e64 v92, 16, v232
    v_and_b32 v93, 0xffff0000, v232
    v_lshlrev_b32_e64 v94, 16, v233
    v_and_b32 v95, 0xffff0000, v233
    v_pk_add_f32 v[80:81], v[92:93], v[88:89] neg_lo:[0,1] neg_hi:[0,1]
    v_pk_add_f32 v[82:83], v[94:95], v[88:89] neg_lo:[0,1] neg_hi:[0,1]
    v_cvt_pk_bf16_f32 v84, v80, v81
    v_cvt_pk_bf16_f32 v85, v82, v83
    v_lshlrev_b32_e64 v80, 16, v84
    v_and_b32 v81, 0xffff0000, v84
    v_lshlrev_b32_e64 v82, 16, v85
    v_and_b32 v83, 0xffff0000, v85
    v_pk_mul_f32 v[80:81], v[80:81], v[90:91]
    v_pk_mul_f32 v[82:83], v[82:83], v[90:91]
    v_cvt_pk_bf16_f32 v84, v80, v81
    v_cvt_pk_bf16_f32 v85, v82, v83
    v_lshlrev_b32_e64 v80, 16, v84
    v_and_b32 v81, 0xffff0000, v84
    v_lshlrev_b32_e64 v82, 16, v85
    v_and_b32 v83, 0xffff0000, v85
    v_lshlrev_b32_e64 v84, 16, v104
    v_and_b32 v85, 0xffff0000, v104
    v_lshlrev_b32_e64 v86, 16, v105
    v_and_b32 v87, 0xffff0000, v105
    v_pk_mul_f32 v[80:81], v[80:81], v[84:85]
    v_pk_mul_f32 v[82:83], v[82:83], v[86:87]
    v_cvt_pk_bf16_f32 v84, v80, v81
    v_cvt_pk_bf16_f32 v85, v82, v83
    v_lshlrev_b32_e64 v80, 16, v84
    v_and_b32 v81, 0xffff0000, v84
    v_lshlrev_b32_e64 v82, 16, v85
    v_and_b32 v83, 0xffff0000, v85
    v_pk_add_f32 v[80:81], v[80:81], v[92:93]
    v_pk_add_f32 v[82:83], v[82:83], v[94:95]
    v_accvgpr_read_b32 v64, a16
    v_accvgpr_read_b32 v65, a17
    v_accvgpr_read_b32 v66, a18
    v_accvgpr_read_b32 v67, a19
    v_pk_add_f32 v[64:65], v[64:65], v[80:81]
    v_pk_add_f32 v[66:67], v[66:67], v[82:83]
    v_lshlrev_b32_e64 v92, 16, v234
    v_and_b32 v93, 0xffff0000, v234
    v_lshlrev_b32_e64 v94, 16, v235
    v_and_b32 v95, 0xffff0000, v235
    v_pk_add_f32 v[80:81], v[92:93], v[88:89] neg_lo:[0,1] neg_hi:[0,1]
    v_pk_add_f32 v[82:83], v[94:95], v[88:89] neg_lo:[0,1] neg_hi:[0,1]
    v_cvt_pk_bf16_f32 v84, v80, v81
    v_cvt_pk_bf16_f32 v85, v82, v83
    v_lshlrev_b32_e64 v80, 16, v84
    v_and_b32 v81, 0xffff0000, v84
    v_lshlrev_b32_e64 v82, 16, v85
    v_and_b32 v83, 0xffff0000, v85
    v_pk_mul_f32 v[80:81], v[80:81], v[90:91]
    v_pk_mul_f32 v[82:83], v[82:83], v[90:91]
    v_cvt_pk_bf16_f32 v84, v80, v81
    v_cvt_pk_bf16_f32 v85, v82, v83
    v_lshlrev_b32_e64 v80, 16, v84
    v_and_b32 v81, 0xffff0000, v84
    v_lshlrev_b32_e64 v82, 16, v85
    v_and_b32 v83, 0xffff0000, v85
    v_lshlrev_b32_e64 v84, 16, v106
    v_and_b32 v85, 0xffff0000, v106
    v_lshlrev_b32_e64 v86, 16, v107
    v_and_b32 v87, 0xffff0000, v107
    v_pk_mul_f32 v[80:81], v[80:81], v[84:85]
    v_pk_mul_f32 v[82:83], v[82:83], v[86:87]
    v_cvt_pk_bf16_f32 v84, v80, v81
    v_cvt_pk_bf16_f32 v85, v82, v83
    v_lshlrev_b32_e64 v80, 16, v84
    v_and_b32 v81, 0xffff0000, v84
    v_lshlrev_b32_e64 v82, 16, v85
    v_and_b32 v83, 0xffff0000, v85
    v_pk_add_f32 v[80:81], v[80:81], v[92:93]
    v_pk_add_f32 v[82:83], v[82:83], v[94:95]
    v_accvgpr_read_b32 v68, a20
    v_accvgpr_read_b32 v69, a21
    v_accvgpr_read_b32 v70, a22
    v_accvgpr_read_b32 v71, a23
    v_pk_add_f32 v[68:69], v[68:69], v[80:81]
    v_pk_add_f32 v[70:71], v[70:71], v[82:83]
    v_lshlrev_b32_e64 v92, 16, v236
    v_and_b32 v93, 0xffff0000, v236
    v_lshlrev_b32_e64 v94, 16, v237
    v_and_b32 v95, 0xffff0000, v237
    v_pk_add_f32 v[80:81], v[92:93], v[88:89] neg_lo:[0,1] neg_hi:[0,1]
    v_pk_add_f32 v[82:83], v[94:95], v[88:89] neg_lo:[0,1] neg_hi:[0,1]
    v_cvt_pk_bf16_f32 v84, v80, v81
    v_cvt_pk_bf16_f32 v85, v82, v83
    v_lshlrev_b32_e64 v80, 16, v84
    v_and_b32 v81, 0xffff0000, v84
    v_lshlrev_b32_e64 v82, 16, v85
    v_and_b32 v83, 0xffff0000, v85
    v_pk_mul_f32 v[80:81], v[80:81], v[90:91]
    v_pk_mul_f32 v[82:83], v[82:83], v[90:91]
    v_cvt_pk_bf16_f32 v84, v80, v81
    v_cvt_pk_bf16_f32 v85, v82, v83
    v_lshlrev_b32_e64 v80, 16, v84
    v_and_b32 v81, 0xffff0000, v84
    v_lshlrev_b32_e64 v82, 16, v85
    v_and_b32 v83, 0xffff0000, v85
    v_lshlrev_b32_e64 v84, 16, v108
    v_and_b32 v85, 0xffff0000, v108
    v_lshlrev_b32_e64 v86, 16, v109
    v_and_b32 v87, 0xffff0000, v109
    v_pk_mul_f32 v[80:81], v[80:81], v[84:85]
    v_pk_mul_f32 v[82:83], v[82:83], v[86:87]
    v_cvt_pk_bf16_f32 v84, v80, v81
    v_cvt_pk_bf16_f32 v85, v82, v83
    v_lshlrev_b32_e64 v80, 16, v84
    v_and_b32 v81, 0xffff0000, v84
    v_lshlrev_b32_e64 v82, 16, v85
    v_and_b32 v83, 0xffff0000, v85
    v_pk_add_f32 v[80:81], v[80:81], v[92:93]
    v_pk_add_f32 v[82:83], v[82:83], v[94:95]
    v_accvgpr_read_b32 v72, a24
    v_accvgpr_read_b32 v73, a25
    v_accvgpr_read_b32 v74, a26
    v_accvgpr_read_b32 v75, a27
    v_pk_add_f32 v[72:73], v[72:73], v[80:81]
    v_pk_add_f32 v[74:75], v[74:75], v[82:83]
    v_lshlrev_b32_e64 v92, 16, v238
    v_and_b32 v93, 0xffff0000, v238
    v_lshlrev_b32_e64 v94, 16, v239
    v_and_b32 v95, 0xffff0000, v239
    v_pk_add_f32 v[80:81], v[92:93], v[88:89] neg_lo:[0,1] neg_hi:[0,1]
    v_pk_add_f32 v[82:83], v[94:95], v[88:89] neg_lo:[0,1] neg_hi:[0,1]
    v_cvt_pk_bf16_f32 v84, v80, v81
    v_cvt_pk_bf16_f32 v85, v82, v83
    v_lshlrev_b32_e64 v80, 16, v84
    v_and_b32 v81, 0xffff0000, v84
    v_lshlrev_b32_e64 v82, 16, v85
    v_and_b32 v83, 0xffff0000, v85
    v_pk_mul_f32 v[80:81], v[80:81], v[90:91]
    v_pk_mul_f32 v[82:83], v[82:83], v[90:91]
    v_cvt_pk_bf16_f32 v84, v80, v81
    v_cvt_pk_bf16_f32 v85, v82, v83
    v_lshlrev_b32_e64 v80, 16, v84
    v_and_b32 v81, 0xffff0000, v84
    v_lshlrev_b32_e64 v82, 16, v85
    v_and_b32 v83, 0xffff0000, v85
    v_lshlrev_b32_e64 v84, 16, v110
    v_and_b32 v85, 0xffff0000, v110
    v_lshlrev_b32_e64 v86, 16, v111
    v_and_b32 v87, 0xffff0000, v111
    v_pk_mul_f32 v[80:81], v[80:81], v[84:85]
    v_pk_mul_f32 v[82:83], v[82:83], v[86:87]
    v_cvt_pk_bf16_f32 v84, v80, v81
    v_cvt_pk_bf16_f32 v85, v82, v83
    v_lshlrev_b32_e64 v80, 16, v84
    v_and_b32 v81, 0xffff0000, v84
    v_lshlrev_b32_e64 v82, 16, v85
    v_and_b32 v83, 0xffff0000, v85
    v_pk_add_f32 v[80:81], v[80:81], v[92:93]
    v_pk_add_f32 v[82:83], v[82:83], v[94:95]
    v_accvgpr_read_b32 v76, a28
    v_accvgpr_read_b32 v77, a29
    v_accvgpr_read_b32 v78, a30
    v_accvgpr_read_b32 v79, a31
    v_pk_add_f32 v[76:77], v[76:77], v[80:81]
    v_pk_add_f32 v[78:79], v[78:79], v[82:83]
    s_mul_i32 s36, s29, 49152
    s_add_u32 s35, s35, s36
    v_and_b32 v21, 3, v0
    v_min_u32 v21, 2, v21
    v_lshlrev_b32 v21, 14, v21
    v_add_u32 v21, 4092, v21
    s_mov_b32 s42, 0x40000
    s_mov_b32 s43, 64
L_k2_poll:
    s_nop 0
    buffer_load_dword v22, v21, s[8:11], s35 offen sc1
    s_waitcnt vmcnt(0)
    v_cmp_ne_u32 vcc, -1, v22
    s_sub_u32 s42, s42, 1
    s_cbranch_scc1 L_k2_pollx
    s_cmp_eq_u64 vcc, -1
    s_cbranch_scc0 L_k2_poll
L_k2_pollx:
    s_add_u32 s36, s35, 16384
    s_add_u32 s37, s35, 32768
    buffer_load_dwordx4 v[96:99], v20, s[8:11], s35 offen offset:0 sc1
    buffer_load_dwordx4 v[100:103], v20, s[8:11], s36 offen offset:0 sc1
    buffer_load_dwordx4 v[104:107], v20, s[8:11], s37 offen offset:0 sc1
    buffer_load_dwordx4 v[108:111], v20, s[8:11], s35 offen offset:1024 sc1
    buffer_load_dwordx4 v[112:115], v20, s[8:11], s36 offen offset:1024 sc1
    buffer_load_dwordx4 v[116:119], v20, s[8:11], s37 offen offset:1024 sc1
    buffer_load_dwordx4 v[120:123], v20, s[8:11], s35 offen offset:2048 sc1
    buffer_load_dwordx4 v[124:127], v20, s[8:11], s36 offen offset:2048 sc1
    buffer_load_dwordx4 v[128:131], v20, s[8:11], s37 offen offset:2048 sc1
    buffer_load_dwordx4 v[132:135], v20, s[8:11], s35 offen offset:3072 sc1
    buffer_load_dwordx4 v[136:139], v20, s[8:11], s36 offen offset:3072 sc1
    buffer_load_dwordx4 v[140:143], v20, s[8:11], s37 offen offset:3072 sc1
    v_lshlrev_b32_e64 v21, 4, v25
    v_lshl_add_u32 v21, v31, 12, v21
    s_lshl_b32 s38, s28, 9
    v_add_u32 v21, s38, v21
    v_mov_b32 v22, 0
    s_waitcnt vmcnt(9)
    v_max3_u32 v22, v96, v97, v22
    v_max3_u32 v22, v98, v99, v22
    v_lshlrev_b32_e64 v80, 16, v96
    v_and_b32 v81, 0xffff0000, v96
    v_pk_add_f32 v[144:145], v[48:49], v[80:81]
    v_lshlrev_b32_e64 v80, 16, v97
    v_and_b32 v81, 0xffff0000, v97
    v_pk_add_f32 v[146:147], v[50:51], v[80:81]
    v_lshlrev_b32_e64 v80, 16, v98
    v_and_b32 v81, 0xffff0000, v98
    v_pk_add_f32 v[148:149], v[52:53], v[80:81]
    v_lshlrev_b32_e64 v80, 16, v99
    v_and_b32 v81, 0xffff0000, v99
    v_pk_add_f32 v[150:151], v[54:55], v[80:81]
    v_max3_u32 v22, v100, v101, v22
    v_max3_u32 v22, v102, v103, v22
    v_lshlrev_b32_e64 v80, 16, v100
    v_and_b32 v81, 0xffff0000, v100
    v_pk_add_f32 v[144:145], v[144:145], v[80:81]
    v_lshlrev_b32_e64 v80, 16, v101
    v_and_b32 v81, 0xffff0000, v101
    v_pk_add_f32 v[146:147], v[146:147], v[80:81]
    v_lshlrev_b32_e64 v80, 16, v102
    v_and_b32 v81, 0xffff0000, v102
    v_pk_add_f32 v[148:149], v[148:149], v[80:81]
    v_lshlrev_b32_e64 v80, 16, v103
    v_and_b32 v81, 0xffff0000, v103
    v_pk_add_f32 v[150:151], v[150:151], v[80:81]
    v_max3_u32 v22, v104, v105, v22
    v_max3_u32 v22, v106, v107, v22
    v_lshlrev_b32_e64 v80, 16, v104
    v_and_b32 v81, 0xffff0000, v104
    v_pk_add_f32 v[144:145], v[144:145], v[80:81]
    v_lshlrev_b32_e64 v80, 16, v105
    v_and_b32 v81, 0xffff0000, v105
    v_pk_add_f32 v[146:147], v[146:147], v[80:81]
    v_lshlrev_b32_e64 v80, 16, v106
    v_and_b32 v81, 0xffff0000, v106
    v_pk_add_f32 v[148:149], v[148:149], v[80:81]
    v_lshlrev_b32_e64 v80, 16, v107
    v_and_b32 v81, 0xffff0000, v107
    v_pk_add_f32 v[150:151], v[150:151], v[80:81]
    s_waitcnt vmcnt(6)
    s_nop 0
    v_max3_u32 v22, v108, v109, v22
    v_max3_u32 v22, v110, v111, v22
    v_lshlrev_b32_e64 v80, 16, v108
    v_and_b32 v81, 0xffff0000, v108
    v_pk_add_f32 v[152:153], v[56:57], v[80:81]
    v_lshlrev_b32_e64 v80, 16, v109
    v_and_b32 v81, 0xffff0000, v109
    v_pk_add_f32 v[154:155], v[58:59], v[80:81]
    v_lshlrev_b32_e64 v80, 16, v110
    v_and_b32 v81, 0xffff0000, v110
    v_pk_add_f32 v[156:157], v[60:61], v[80:81]
    v_lshlrev_b32_e64 v80, 16, v111
    v_and_b32 v81, 0xffff0000, v111
    v_pk_add_f32 v[158:159], v[62:63], v[80:81]
    v_max3_u32 v22, v112, v113, v22
    v_max3_u32 v22, v114, v115, v22
    v_lshlrev_b32_e64 v80, 16, v112
    v_and_b32 v81, 0xffff0000, v112
    v_pk_add_f32 v[152:153], v[152:153], v[80:81]
    v_lshlrev_b32_e64 v80, 16, v113
    v_and_b32 v81, 0xffff0000, v113
    v_pk_add_f32 v[154:155], v[154:155], v[80:81]
    v_lshlrev_b32_e64 v80, 16, v114
    v_and_b32 v81, 0xffff0000, v114
    v_pk_add_f32 v[156:157], v[156:157], v[80:81]
    v_lshlrev_b32_e64 v80, 16, v115
    v_and_b32 v81, 0xffff0000, v115
    v_pk_add_f32 v[158:159], v[158:159], v[80:81]
    v_max3_u32 v22, v116, v117, v22
    v_max3_u32 v22, v118, v119, v22
    v_lshlrev_b32_e64 v80, 16, v116
    v_and_b32 v81, 0xffff0000, v116
    v_pk_add_f32 v[152:153], v[152:153], v[80:81]
    v_lshlrev_b32_e64 v80, 16, v117
    v_and_b32 v81, 0xffff0000, v117
    v_pk_add_f32 v[154:155], v[154:155], v[80:81]
    v_lshlrev_b32_e64 v80, 16, v118
    v_and_b32 v81, 0xffff0000, v118
    v_pk_add_f32 v[156:157], v[156:157], v[80:81]
    v_lshlrev_b32_e64 v80, 16, v119
    v_and_b32 v81, 0xffff0000, v119
    v_pk_add_f32 v[158:159], v[158:159], v[80:81]
    s_waitcnt vmcnt(3)
    s_nop 0
    v_max3_u32 v22, v120, v121, v22
    v_max3_u32 v22, v122, v123, v22
    v_lshlrev_b32_e64 v80, 16, v120
    v_and_b32 v81, 0xffff0000, v120
    v_pk_add_f32 v[160:161], v[64:65], v[80:81]
    v_lshlrev_b32_e64 v80, 16, v121
    v_and_b32 v81, 0xffff0000, v121
    v_pk_add_f32 v[162:163], v[66:67], v[80:81]
    v_lshlrev_b32_e64 v80, 16, v122
    v_and_b32 v81, 0xffff0000, v122
    v_pk_add_f32 v[164:165], v[68:69], v[80:81]
    v_lshlrev_b32_e64 v80, 16, v123
    v_and_b32 v81, 0xffff0000, v123
    v_pk_add_f32 v[166:167], v[70:71], v[80:81]
    v_max3_u32 v22, v124, v125, v22
    v_max3_u32 v22, v126, v127, v22
    v_lshlrev_b32_e64 v80, 16, v124
    v_and_b32 v81, 0xffff0000, v124
    v_pk_add_f32 v[160:161], v[160:161], v[80:81]
    v_lshlrev_b32_e64 v80, 16, v125
    v_and_b32 v81, 0xffff0000, v125
    v_pk_add_f32 v[162:163], v[162:163], v[80:81]
    v_lshlrev_b32_e64 v80, 16, v126
    v_and_b32 v81, 0xffff0000, v126
    v_pk_add_f32 v[164:165], v[164:165], v[80:81]
    v_lshlrev_b32_e64 v80, 16, v127
    v_and_b32 v81, 0xffff0000, v127
    v_pk_add_f32 v[166:167], v[166:167], v[80:81]
    v_max3_u32 v22, v128, v129, v22
    v_max3_u32 v22, v130, v131, v22
    v_lshlrev_b32_e64 v80, 16, v128
    v_and_b32 v81, 0xffff0000, v128
    v_pk_add_f32 v[160:161], v[160:161], v[80:81]
    v_lshlrev_b32_e64 v80, 16, v129
    v_and_b32 v81, 0xffff0000, v129
    v_pk_add_f32 v[162:163], v[162:163], v[80:81]
    v_lshlrev_b32_e64 v80, 16, v130
    v_and_b32 v81, 0xffff0000, v130
    v_pk_add_f32 v[164:165], v[164:165], v[80:81]
    v_lshlrev_b32_e64 v80, 16, v131
    v_and_b32 v81, 0xffff0000, v131
    v_pk_add_f32 v[166:167], v[166:167], v[80:81]
    s_waitcnt vmcnt(0)
    s_nop 0
    v_max3_u32 v22, v132, v133, v22
    v_max3_u32 v22, v134, v135, v22
    v_lshlrev_b32_e64 v80, 16, v132
    v_and_b32 v81, 0xffff0000, v132
    v_pk_add_f32 v[168:169], v[72:73], v[80:81]
    v_lshlrev_b32_e64 v80, 16, v133
    v_and_b32 v81, 0xffff0000, v133
    v_pk_add_f32 v[170:171], v[74:75], v[80:81]
    v_lshlrev_b32_e64 v80, 16, v134
    v_and_b32 v81, 0xffff0000, v134
    v_pk_add_f32 v[172:173], v[76:77], v[80:81]
    v_lshlrev_b32_e64 v80, 16, v135
    v_and_b32 v81, 0xffff0000, v135
    v_pk_add_f32 v[174:175], v[78:79], v[80:81]
    v_max3_u32 v22, v136, v137, v22
    v_max3_u32 v22, v138, v139, v22
    v_lshlrev_b32_e64 v80, 16, v136
    v_and_b32 v81, 0xffff0000, v136
    v_pk_add_f32 v[168:169], v[168:169], v[80:81]
    v_lshlrev_b32_e64 v80, 16, v137
    v_and_b32 v81, 0xffff0000, v137
    v_pk_add_f32 v[170:171], v[170:171], v[80:81]
    v_lshlrev_b32_e64 v80, 16, v138
    v_and_b32 v81, 0xffff0000, v138
    v_pk_add_f32 v[172:173], v[172:173], v[80:81]
    v_lshlrev_b32_e64 v80, 16, v139
    v_and_b32 v81, 0xffff0000, v139
    v_pk_add_f32 v[174:175], v[174:175], v[80:81]
    v_max3_u32 v22, v140, v141, v22
    v_max3_u32 v22, v142, v143, v22
    v_lshlrev_b32_e64 v80, 16, v140
    v_and_b32 v81, 0xffff0000, v140
    v_pk_add_f32 v[168:169], v[168:169], v[80:81]
    v_lshlrev_b32_e64 v80, 16, v141
    v_and_b32 v81, 0xffff0000, v141
    v_pk_add_f32 v[170:171], v[170:171], v[80:81]
    v_lshlrev_b32_e64 v80, 16, v142
    v_and_b32 v81, 0xffff0000, v142
    v_pk_add_f32 v[172:173], v[172:173], v[80:81]
    v_lshlrev_b32_e64 v80, 16, v143
    v_and_b32 v81, 0xffff0000, v143
    v_pk_add_f32 v[174:175], v[174:175], v[80:81]
    v_cmp_eq_u32_e64 vcc, -1, v22
    s_sub_u32 s43, s43, 1
    s_cbranch_scc1 L_k2_okx
    s_cmp_lg_u64 vcc, 0
    s_cbranch_scc1 L_k2_pollx
L_k2_okx:
    global_store_dwordx4 v21, v[144:147], s[44:45] offset:0
    global_store_dwordx4 v21, v[148:151], s[44:45] offset:64
    global_store_dwordx4 v21, v[152:155], s[44:45] offset:128
    global_store_dwordx4 v21, v[156:159], s[44:45] offset:192
    global_store_dwordx4 v21, v[160:163], s[44:45] offset:256
    global_store_dwordx4 v21, v[164:167], s[44:45] offset:320
    global_store_dwordx4 v21, v[168:171], s[44:45] offset:384
    global_store_dwordx4 v21, v[172:175], s[44:45] offset:448
L_k2_end:
    s_endpgm
.section .rodata,"a"
.p2align 6
.amdhsa_kernel parallel_sum__ssm_conv_s5__glu_gated_glu__prompt_kernel
  .amdhsa_next_free_vgpr 512
  .amdhsa_next_free_sgpr 102
  .amdhsa_accum_offset 256
  .amdhsa_group_segment_fixed_size 0
  .amdhsa_kernarg_size 128
  .amdhsa_user_sgpr_count 2
  .amdhsa_user_sgpr_kernarg_segment_ptr 1
  .amdhsa_system_sgpr_workgroup_id_x 1
  .amdhsa_float_denorm_mode_32 3
  .amdhsa_float_denorm_mode_16_64 3
.end_amdhsa_kernel
```
